```python
import torch

def _softmax(x, axis=-1):
    return torch.softmax(x, dim=axis)
def _gelu(x):
    return torch.nn.functional.gelu(x, approximate="tanh")
def _silu(x):
    return torch.nn.functional.silu(x)
def _sigmoid(x):
    return torch.sigmoid(x)
def _layernorm(x, axis=-1, eps=1e-5):
    m = x.mean(dim=axis, keepdim=True)
    v = x.var(dim=axis, keepdim=True, unbiased=False)
    return (x - m) / torch.sqrt(v + eps)
def _scatter_add(tgt, idx, src, axis=0):
    return tgt.clone().index_add_(axis, idx, src)
def _segment_sum(src, seg, n):
    out = torch.zeros((n,) + src.shape[1:], dtype=src.dtype)
    return out.index_add_(0, seg, src)
def _pad(x, pw):
    flat = tuple(v for pair in reversed(pw) for v in pair)
    return torch.nn.functional.pad(x, flat)

kernel_name = 'concat_heads__gqa_block_cached__gqa_block_cached__near_ridge'

def setup_inputs():

    _w = (lambda a: (lambda t: t.to(torch.bfloat16) if t.is_floating_point() else t)(torch.as_tensor(a)))
    def _A_setup():
        B, Sq, D = 8, 160, 512
        Hq, Hkv, Sk, Dh = 32, 32, 1024, 128
        assert Hq % Hkv == 0, (Hq, Hkv)
        return {
            "x": _w((lambda *s: torch.randn(*s, dtype=torch.bfloat16) * 0.8)(B, Sq, D)),
            "k_cache": _w((lambda *s: torch.randn(*s, dtype=torch.bfloat16) * 0.8)(B, Hkv, Sk, Dh)),
            "v_cache": _w((lambda *s: torch.randn(*s, dtype=torch.bfloat16) * 0.05)(B, Hkv, Sk, Dh)),
            "wq": _w((lambda *s: torch.randn(*s, dtype=torch.bfloat16) * 0.8)(D, Hq * Dh) * (D ** -0.5)),
            "wo": _w((lambda *s: torch.randn(*s, dtype=torch.bfloat16) * 0.05)(Hq * Dh, D) * ((Hq * Dh) ** -0.5)),
        }
    _A_in = _A_setup()

    def _B_setup():
        B, Sq, D = 8, 160, 512
        Hq, Hkv, Sk, Dh = 32, 32, 1024, 128
        assert Hq % Hkv == 0, (Hq, Hkv)
        return {
            "x": _w((lambda *s: torch.randn(*s, dtype=torch.bfloat16) * 0.8)(B, Sq, D)),
            "k_cache": _w((lambda *s: torch.randn(*s, dtype=torch.bfloat16) * 0.8)(B, Hkv, Sk, Dh)),
            "v_cache": _w((lambda *s: torch.randn(*s, dtype=torch.bfloat16) * 0.05)(B, Hkv, Sk, Dh)),
            "wq": _w((lambda *s: torch.randn(*s, dtype=torch.bfloat16) * 0.8)(D, Hq * Dh) * (D ** -0.5)),
            "wo": _w((lambda *s: torch.randn(*s, dtype=torch.bfloat16) * 0.05)(Hq * Dh, D) * ((Hq * Dh) ** -0.5)),
        }
    _B_in = _B_setup()

    return {
        "A_x": _A_in["x"],
        "A_k_cache": _A_in["k_cache"],
        "A_v_cache": _A_in["v_cache"],
        "A_wq": _A_in["wq"],
        "A_wo": _A_in["wo"],
        "B_x": _B_in["x"],
        "B_k_cache": _B_in["k_cache"],
        "B_v_cache": _B_in["v_cache"],
        "B_wq": _B_in["wq"],
        "B_wo": _B_in["wo"],
    }

def reference(A_x, A_k_cache, A_v_cache, A_wq, A_wo, B_x, B_k_cache, B_v_cache, B_wq, B_wo):
    def _A_ref(x, k_cache, v_cache, wq, wo):
        B, Sq, D = x.shape
        Hq, Dh = 32, 128
        Hkv = k_cache.shape[1]
        rep = Hq // Hkv
        q = (lambda x, *d: x.permute(*d))((x @ wq).reshape(B, Sq, Hq, Dh), 0, 2, 1, 3)
        k = (lambda x, n, axis: torch.repeat_interleave(x, n, dim=axis))(k_cache, rep, axis=1)
        v = (lambda x, n, axis: torch.repeat_interleave(x, n, dim=axis))(v_cache, rep, axis=1)
        scores = torch.einsum("bhqd,bhkd->bhqk", q, k) * (Dh ** -0.5)
        p = _softmax(scores, axis=-1)
        o = torch.einsum("bhqk,bhkd->bhqd", p, v)
        return (lambda x, *d: x.permute(*d))(o, 0, 2, 1, 3).reshape(B, Sq, Hq * Dh) @ wo

    def _B_ref(x, k_cache, v_cache, wq, wo):
        B, Sq, D = x.shape
        Hq, Dh = 32, 128
        Hkv = k_cache.shape[1]
        rep = Hq // Hkv
        q = (lambda x, *d: x.permute(*d))((x @ wq).reshape(B, Sq, Hq, Dh), 0, 2, 1, 3)
        k = (lambda x, n, axis: torch.repeat_interleave(x, n, dim=axis))(k_cache, rep, axis=1)
        v = (lambda x, n, axis: torch.repeat_interleave(x, n, dim=axis))(v_cache, rep, axis=1)
        scores = torch.einsum("bhqd,bhkd->bhqk", q, k) * (Dh ** -0.5)
        p = _softmax(scores, axis=-1)
        o = torch.einsum("bhqk,bhkd->bhqd", p, v)
        return (lambda x, *d: x.permute(*d))(o, 0, 2, 1, 3).reshape(B, Sq, Hq * Dh) @ wo

    a = _A_ref(A_x, A_k_cache, A_v_cache, A_wq, A_wo)
    b = _B_ref(B_x, B_k_cache, B_v_cache, B_wq, B_wo)
    return torch.concatenate([a, b], axis=-1)
```

```asm
; @launch grid=(256,1,1) block=(256,1,1) lds=163840
.amdgcn_target "amdgcn-amd-amdhsa--gfx950"
.text
.globl concat_heads__gqa_block_cached__gqa_block_cached__near_ridge_kernel
.p2align 8
.type concat_heads__gqa_block_cached__gqa_block_cached__near_ridge_kernel,@function
concat_heads__gqa_block_cached__gqa_block_cached__near_ridge_kernel:
    s_cmp_ge_u32 s2, 256
    s_cbranch_scc1 L_k1_end
    s_getpc_b64 s[96:97]
    s_and_b32 s38, s2, 7
    s_lshr_b32 s32, s38, 2
    s_and_b32 s59, s38, 3
    s_lshr_b32 s39, s2, 3
    s_and_b32 s31, s39, 7
    s_lshr_b32 s3, s39, 3
    s_lshl_b32 s38, s59, 3
    s_lshl_b32 s40, s3, 1
    s_add_u32 s33, s38, s40
    s_add_u32 s30, s31, s40
    s_and_b32 s30, s30, 7
    s_mul_i32 s38, s32, 40
    s_add_u32 s60, s0, s38
    s_addc_u32 s61, s1, 0
    s_load_dwordx8 s[64:71], s[60:61], 0
    s_load_dwordx4 s[72:75], s[0:1], 88
    s_load_dwordx2 s[92:93], s[60:61], 32
    s_load_dwordx2 s[94:95], s[0:1], 80
    v_lshrrev_b32 v1, 6, v0
    v_and_b32 v26, 63, v0
    v_readfirstlane_b32 s24, v1
    v_and_b32 v1, 31, v26
    v_lshrrev_b32 v2, 5, v26
    v_lshrrev_b32 v3, 4, v26
    v_and_b32 v4, 15, v26
    s_lshl_b32 s25, s24, 12
    s_lshl_b32 s35, s24, 10
    s_lshl_b32 s39, s24, 16
    v_add_u32 v244, 0, v2
    v_and_b32 v245, 3, v244
    v_lshlrev_b32 v245, 2, v245
    v_xor_b32 v245, v245, v1
    v_lshlrev_b32 v245, 4, v245
    v_lshl_add_u32 v245, v244, 13, v245
    v_add_u32 v245, s39, v245
    v_subrev_u32 v54, 0, v245
    v_add_u32 v244, 2, v2
    v_and_b32 v245, 3, v244
    v_lshlrev_b32 v245, 2, v245
    v_xor_b32 v245, v245, v1
    v_lshlrev_b32 v245, 4, v245
    v_lshl_add_u32 v245, v244, 13, v245
    v_add_u32 v245, s39, v245
    v_subrev_u32 v55, 1024, v245
    v_add_u32 v244, 4, v2
    v_and_b32 v245, 3, v244
    v_lshlrev_b32 v245, 2, v245
    v_xor_b32 v245, v245, v1
    v_lshlrev_b32 v245, 4, v245
    v_lshl_add_u32 v245, v244, 13, v245
    v_add_u32 v245, s39, v245
    v_subrev_u32 v56, 2048, v245
    v_add_u32 v244, 6, v2
    v_and_b32 v245, 3, v244
    v_lshlrev_b32 v245, 2, v245
    v_xor_b32 v245, v245, v1
    v_lshlrev_b32 v245, 4, v245
    v_lshl_add_u32 v245, v244, 13, v245
    v_add_u32 v245, s39, v245
    v_subrev_u32 v57, 3072, v245
    s_lshl_b32 s39, s24, 15
    v_lshrrev_b32 v247, 3, v26
    v_and_b32 v248, 7, v26
    s_lshl_b32 s38, s24, 2
    v_add_u32 v244, 0, v3
    v_and_b32 v244, 7, v244
    v_xor_b32 v244, v244, v248
    v_lshlrev_b32 v244, 4, v244
    v_lshl_add_u32 v244, v247, 10, v244
    v_add_u32 v244, 0, v244
    v_add_u32 v58, s39, v244
    v_add_u32 v244, 4, v3
    v_and_b32 v244, 7, v244
    v_xor_b32 v244, v244, v248
    v_lshlrev_b32 v244, 4, v244
    v_lshl_add_u32 v244, v247, 10, v244
    v_add_u32 v244, 7168, v244
    v_add_u32 v59, s39, v244
    v_add_u32 v244, 8, v3
    v_and_b32 v244, 7, v244
    v_xor_b32 v244, v244, v248
    v_lshlrev_b32 v244, 4, v244
    v_lshl_add_u32 v244, v247, 10, v244
    v_add_u32 v244, 14336, v244
    v_add_u32 v60, s39, v244
    v_add_u32 v244, 12, v3
    v_and_b32 v244, 7, v244
    v_xor_b32 v244, v244, v248
    v_lshlrev_b32 v244, 4, v244
    v_lshl_add_u32 v244, v247, 10, v244
    v_add_u32 v244, 21504, v244
    v_add_u32 v61, s39, v244
    s_lshl_b32 s39, s24, 13
    s_add_u32 s39, s39, 131072
    v_add_u32 v244, s38, v3
    v_and_b32 v244, 7, v244
    v_xor_b32 v244, v244, v248
    v_lshlrev_b32 v244, 4, v244
    v_lshl_add_u32 v244, v247, 10, v244
    v_add_u32 v62, s39, v244
    s_waitcnt lgkmcnt(0)
    s_mul_i32 s39, s31, 163840
    s_add_u32 s12, s64, s39
    s_addc_u32 s13, s65, 0
    s_mov_b32 s14, 163840
    s_mov_b32 s15, 0x20000
    s_lshl_b32 s39, s33, 8
    s_add_u32 s16, s70, s39
    s_addc_u32 s17, s71, 0
    s_sub_u32 s18, 4194304, s39
    s_mov_b32 s19, 0x20000
    s_add_u32 s38, s30, 0
    s_and_b32 s38, s38, 7
    s_lshl_b32 s76, s38, 19
    s_add_u32 s77, s76, 262144
    s_add_u32 s38, s30, 1
    s_and_b32 s38, s38, 7
    s_lshl_b32 s78, s38, 19
    s_add_u32 s79, s78, 262144
    s_add_u32 m0, s25, 139264
    s_nop 0
    buffer_load_dwordx4 v54, s[16:19], s76 offen offset:0 lds
    buffer_load_dwordx4 v55, s[16:19], s76 offen offset:1024 lds
    buffer_load_dwordx4 v56, s[16:19], s76 offen offset:2048 lds
    buffer_load_dwordx4 v57, s[16:19], s76 offen offset:3072 lds
    s_lshr_b32 s39, s76, 12
    s_add_u32 m0, s25, 98304
    s_nop 0
    buffer_load_dwordx4 v58, s[12:15], s39 offen offset:0 lds
    buffer_load_dwordx4 v59, s[12:15], s39 offen offset:1024 lds
    buffer_load_dwordx4 v60, s[12:15], s39 offen offset:2048 lds
    buffer_load_dwordx4 v61, s[12:15], s39 offen offset:3072 lds
    s_add_u32 m0, s35, 114688
    s_nop 0
    buffer_load_dwordx4 v62, s[12:15], s39 offen lds
    s_lshr_b32 s38, s2, 3
    s_and_b32 s38, s38, 7
    s_mul_i32 s38, s38, 42
    v_min_u32 v6, 41, v26
    v_add_u32 v6, s38, v6
    v_lshlrev_b32 v6, 7, v6
    v_mov_b32 v7, s97
    v_add_co_u32 v6, vcc, s96, v6
    s_nop 1
    v_addc_co_u32 v7, vcc, 0, v7, vcc
    global_load_dword v63, v[6:7], off
    s_add_u32 s38, s30, 2
    s_and_b32 s38, s38, 7
    s_lshl_b32 s80, s38, 19
    s_add_u32 s81, s80, 262144
    s_add_u32 s38, s30, 3
    s_and_b32 s38, s38, 7
    s_lshl_b32 s82, s38, 19
    s_add_u32 s83, s82, 262144
    s_add_u32 s38, s30, 4
    s_and_b32 s38, s38, 7
    s_lshl_b32 s84, s38, 19
    s_add_u32 s85, s84, 262144
    s_add_u32 s38, s30, 5
    s_and_b32 s38, s38, 7
    s_lshl_b32 s86, s38, 19
    s_add_u32 s87, s86, 262144
    s_add_u32 s38, s30, 6
    s_and_b32 s38, s38, 7
    s_lshl_b32 s88, s38, 19
    s_add_u32 s89, s88, 262144
    s_add_u32 s38, s30, 7
    s_and_b32 s38, s38, 7
    s_lshl_b32 s90, s38, 19
    s_add_u32 s91, s90, 262144
    s_lshr_b32 s41, s24, 1
    s_lshl_b32 s38, s31, 5
    s_add_u32 s38, s38, s33
    s_add_u32 s38, s38, s41
    s_lshl_b32 s39, s38, 18
    s_add_u32 s4, s66, s39
    s_addc_u32 s5, s67, 0
    s_mov_b32 s6, 262144
    s_mov_b32 s7, 0x20000
    s_add_u32 s8, s68, s39
    s_addc_u32 s9, s69, 0
    s_mov_b32 s10, 262144
    s_mov_b32 s11, 0x20000
    s_lshl_b32 s39, s32, 8
    s_add_u32 s38, s38, s39
    s_mul_i32 s39, s38, 40960
    s_and_b32 s40, s24, 1
    s_mul_i32 s38, s40, 5120
    s_add_u32 s39, s39, s38
    s_add_u32 s20, s74, s39
    s_addc_u32 s21, s75, 0
    s_sub_u32 s22, 40960, s38
    s_mov_b32 s23, 0x20000
    s_lshl_b32 s26, s40, 12
    s_mov_b32 s27, s26
    s_add_u32 s44, s74, 0x2a00000
    s_addc_u32 s45, s75, 0
    s_mov_b32 s46, 32768
    s_mov_b32 s47, 0x20000
    s_add_u32 s48, s72, 0
    s_addc_u32 s49, s73, 0
    s_mov_b32 s50, 256
    s_mov_b32 s51, 0x20000
    s_and_b32 s38, s2, 7
    s_lshl_b32 s38, s38, 3
    s_add_u32 s38, s38, s31
    s_lshl_b32 s39, s32, 3
    s_add_u32 s39, s39, s31
    s_lshl_b32 s39, s39, 2
    s_add_u32 s39, s39, s3
    v_and_b32 v5, 1, v26
    v_mov_b32 v6, s38
    v_mov_b32 v7, s39
    v_cmp_eq_u32 vcc, 0, v5
    s_nop 1
    v_cndmask_b32 v6, v7, v6, vcc
    v_lshlrev_b32 v30, 2, v6
    s_lshl_b32 s38, s38, 7
    s_lshl_b32 s39, s39, 7
    s_add_u32 s39, s39, 8192
    v_lshl_add_u32 v28, v4, 2, s38
    v_lshl_add_u32 v29, v4, 2, s39
    s_lshl_b32 s41, s3, 4
    s_add_u32 s38, s38, s41
    s_lshl_b32 s41, s59, 4
    s_add_u32 s39, s39, s41
    v_mov_b32 v6, s38
    v_mov_b32 v7, s39
    v_cndmask_b32 v6, v7, v6, vcc
    v_lshrrev_b32 v7, 1, v0
    v_lshl_add_u32 v6, v7, 16, v6
    v_mov_b32 v244, 0
    v_mov_b32 v245, 0
    v_mov_b32 v246, 0
    v_mov_b32 v247, 0
    buffer_store_dwordx4 v[244:247], v6, s[44:47], 0 offen sc1
    s_mov_b32 s72, s92
    s_mov_b32 s73, s93
    s_and_b32 s98, s24, 1
    s_lshr_b32 s99, s24, 1
    s_lshl_b32 s96, s31, 1
    s_add_u32 s96, s96, s98
    s_mul_i32 s96, s96, 163840
    s_lshl_b32 s97, s32, 2
    s_add_u32 s97, s97, s3
    s_lshl_b32 s97, s97, 1
    s_add_u32 s97, s97, s99
    s_lshl_b32 s97, s97, 2
    s_add_u32 s97, s97, s59
    s_lshl_b32 s97, s97, 5
    s_add_u32 s96, s96, s97
    s_add_u32 s68, s94, s96
    s_addc_u32 s69, s95, 0
    s_sub_u32 s70, 2621440, s96
    s_mov_b32 s71, 0x20000
    s_cmp_lt_u32 s3, 2
    s_cselect_b32 s38, 1, 2
    s_xor_b32 s38, s38, s3
    s_lshl_b32 s38, s38, 2
    s_add_u32 s38, s38, s98
    s_lshl_b32 s42, 5, s38
    s_cmp_lt_u32 s3, 2
    s_cselect_b32 s38, 2, 3
    s_xor_b32 s38, s38, s3
    s_lshl_b32 s38, s38, 2
    s_add_u32 s38, s38, s98
    s_lshl_b32 s60, 5, s38
    s_cmp_lt_u32 s3, 2
    s_cselect_b32 s38, 3, 1
    s_xor_b32 s38, s38, s3
    s_lshl_b32 s38, s38, 2
    s_add_u32 s38, s38, s98
    s_lshl_b32 s61, 5, s38
    s_lshl_b32 s38, 0x1111, s24
    s_lshl_b32 s39, s59, 2
    s_lshl_b32 s39, 15, s39
    s_andn2_b32 s43, s38, s39
    s_lshl_b32 s38, s32, 3
    s_add_u32 s38, s38, s31
    s_lshl_b32 s38, s38, 2
    s_add_u32 s38, s38, s3
    s_mul_i32 s38, s38, 327680
    s_mul_i32 s39, s24, 5120
    s_add_u32 s38, s38, s39
    s_add_u32 s38, s38, 0x1500000
    s_add_u32 s64, s74, s38
    s_addc_u32 s65, s75, 0
    s_sub_u32 s66, 327680, s39
    s_mov_b32 s67, 0x20000
    s_xor_b32 s38, s59, 1
    s_lshl_b32 s39, s38, 2
    s_add_u32 s39, s39, s59
    s_mul_i32 s96, s39, 20480
    s_lshl_b32 s39, s59, 2
    s_add_u32 s39, s39, s38
    s_mul_i32 s99, s39, 20480
    s_xor_b32 s38, s59, 2
    s_lshl_b32 s39, s38, 2
    s_add_u32 s39, s39, s59
    s_mul_i32 s97, s39, 20480
    s_lshl_b32 s39, s59, 2
    s_add_u32 s39, s39, s38
    s_mul_i32 s100, s39, 20480
    s_xor_b32 s38, s59, 3
    s_lshl_b32 s39, s38, 2
    s_add_u32 s39, s39, s59
    s_mul_i32 s98, s39, 20480
    s_lshl_b32 s39, s59, 2
    s_add_u32 s39, s39, s38
    s_mul_i32 s101, s39, 20480
    s_lshr_b32 s41, s24, 1
    v_bfe_u32 v5, v26, 2, 2
    v_and_b32 v6, 3, v26
    v_add_u32 v244, 0, v3
    v_xor_b32 v244, v244, v4
    v_lshlrev_b32 v244, 4, v244
    v_lshl_add_u32 v20, v3, 8, v244
    v_add_u32 v244, 4, v3
    v_xor_b32 v244, v244, v4
    v_lshlrev_b32 v244, 4, v244
    v_lshl_add_u32 v21, v3, 8, v244
    v_add_u32 v244, 8, v3
    v_xor_b32 v244, v244, v4
    v_lshlrev_b32 v244, 4, v244
    v_lshl_add_u32 v22, v3, 8, v244
    v_add_u32 v244, 12, v3
    v_xor_b32 v244, v244, v4
    v_lshlrev_b32 v244, 4, v244
    v_lshl_add_u32 v23, v3, 8, v244
    v_add_u32 v244, 0, v3
    v_lshlrev_b32 v244, 1, v244
    v_xor_b32 v244, v244, v4
    v_lshlrev_b32 v244, 4, v244
    v_lshl_add_u32 v24, v3, 8, v244
    v_add_u32 v244, 4, v3
    v_lshlrev_b32 v244, 1, v244
    v_xor_b32 v244, v244, v4
    v_lshlrev_b32 v244, 4, v244
    v_lshl_add_u32 v25, v3, 8, v244
    s_lshl_b32 s41, s41, 13
    v_xor_b32 v244, v3, v4
    v_lshlrev_b32 v245, 8, v4
    v_add_u32 v245, s41, v245
    v_xor_b32 v246, 0, v244
    v_lshl_add_u32 v8, v246, 4, v245
    v_xor_b32 v246, 4, v244
    v_lshl_add_u32 v9, v246, 4, v245
    v_xor_b32 v246, 8, v244
    v_lshl_add_u32 v10, v246, 4, v245
    v_xor_b32 v246, 12, v244
    v_lshl_add_u32 v11, v246, 4, v245
    v_lshl_add_u32 v244, v3, 2, v5
    v_lshlrev_b32 v245, 8, v244
    v_lshl_add_u32 v245, v6, 3, v245
    s_add_u32 s41, s41, 65536
    v_add_u32 v245, s41, v245
    v_and_b32 v244, 7, v244
    s_and_b32 s38, s24, 0
    s_lshl_b32 s38, s38, 1
    v_xor_b32 v244, s38, v244
    v_xor_b32 v246, 0, v244
    v_lshl_add_u32 v12, v246, 5, v245
    v_xor_b32 v246, 1, v244
    v_lshl_add_u32 v13, v246, 5, v245
    v_xor_b32 v246, 2, v244
    v_lshl_add_u32 v14, v246, 5, v245
    v_xor_b32 v246, 3, v244
    v_lshl_add_u32 v15, v246, 5, v245
    v_xor_b32 v246, 4, v244
    v_lshl_add_u32 v16, v246, 5, v245
    v_xor_b32 v246, 5, v244
    v_lshl_add_u32 v17, v246, 5, v245
    v_xor_b32 v246, 6, v244
    v_lshl_add_u32 v18, v246, 5, v245
    v_xor_b32 v246, 7, v244
    v_lshl_add_u32 v19, v246, 5, v245
    v_lshl_add_u32 v245, v3, 3, v5
    v_lshlrev_b32 v245, 9, v245
    s_lshr_b32 s41, s24, 1
    s_lshl_b32 s41, s41, 8
    v_add_u32 v245, s41, v245
    v_lshl_add_u32 v244, v5, 2, v6
    v_xor_b32 v246, 0, v244
    v_lshl_add_u32 v48, v246, 4, v245
    v_xor_b32 v246, 4, v244
    v_lshl_add_u32 v49, v246, 4, v245
    v_xor_b32 v246, 8, v244
    v_lshl_add_u32 v50, v246, 4, v245
    v_xor_b32 v246, 12, v244
    v_lshl_add_u32 v51, v246, 4, v245
    v_lshrrev_b32 v244, 1, v4
    v_xor_b32 v244, v244, v3
    s_mul_i32 s41, s40, 10240
    s_add_u32 s41, s41, 98304
    v_lshlrev_b32 v245, 7, v4
    v_add_u32 v245, s41, v245
    v_xor_b32 v246, 0, v244
    v_lshl_add_u32 v52, v246, 4, v245
    v_xor_b32 v246, 4, v244
    v_lshl_add_u32 v53, v246, 4, v245
    s_mov_b32 s36, 0x3e0293ee
    s_mov_b32 s37, 0x3e0293ee
    s_mov_b32 s34, 0x4e800000
    s_mov_b32 s29, 0
    v_lshl_add_u32 v2, v26, 4, s25
    v_add_u32 v3, 0x10000, v2
    v_mov_b32 v244, 0x3f803f80
    v_accvgpr_write_b32 a180, v244
    v_accvgpr_write_b32 a181, v244
    v_accvgpr_write_b32 a182, v244
    v_accvgpr_write_b32 a183, v244
    s_add_u32 m0, s25, 32768
    s_nop 0
    buffer_load_dwordx4 v54, s[16:19], s77 offen offset:0 lds
    buffer_load_dwordx4 v55, s[16:19], s77 offen offset:1024 lds
    buffer_load_dwordx4 v56, s[16:19], s77 offen offset:2048 lds
    buffer_load_dwordx4 v57, s[16:19], s77 offen offset:3072 lds
    s_lshr_b32 s39, s78, 12
    s_add_u32 m0, s25, 118784
    s_nop 0
    buffer_load_dwordx4 v58, s[12:15], s39 offen offset:0 lds
    buffer_load_dwordx4 v59, s[12:15], s39 offen offset:1024 lds
    buffer_load_dwordx4 v60, s[12:15], s39 offen offset:2048 lds
    buffer_load_dwordx4 v61, s[12:15], s39 offen offset:3072 lds
    s_add_u32 m0, s35, 135168
    s_nop 0
    buffer_load_dwordx4 v62, s[12:15], s39 offen lds
    s_waitcnt vmcnt(11)
    s_barrier
    v_add_u32 v48, 0x20000, v48
    ds_read_b64_tr_b16 a[184:185], v48 offset:8192
    ds_read_b64_tr_b16 a[186:187], v48 offset:10240
    ds_read_b128 a[200:203], v52 offset:0
    ds_read_b128 a[204:207], v52 offset:2048
    ds_read_b128 a[208:211], v52 offset:4096
    ds_read_b128 a[212:215], v52 offset:6144
    ds_read_b128 a[216:219], v52 offset:8192
    s_waitcnt lgkmcnt(0)
    ds_read_b64_tr_b16 a[188:189], v48 offset:8200
    ds_read_b64_tr_b16 a[190:191], v48 offset:10248
    v_add_u32 v49, 0x20000, v49
    ds_read_b64_tr_b16 a[192:193], v49 offset:8192
    ds_read_b64_tr_b16 a[194:195], v49 offset:10240
    ds_read_b64_tr_b16 a[196:197], v49 offset:8200
    ds_read_b64_tr_b16 a[198:199], v49 offset:10248
    v_mfma_f32_16x16x32_bf16 v[64:67], a[184:187], a[200:203], 0
    v_mfma_f32_16x16x32_bf16 v[72:75], a[184:187], a[204:207], 0
    v_mfma_f32_16x16x32_bf16 v[80:83], a[184:187], a[208:211], 0
    v_mfma_f32_16x16x32_bf16 v[88:91], a[184:187], a[212:215], 0
    v_add_u32 v50, 0x20000, v50
    v_mfma_f32_16x16x32_bf16 v[96:99], a[184:187], a[216:219], 0
    ds_read_b64_tr_b16 a[184:185], v50 offset:8192
    ds_read_b64_tr_b16 a[186:187], v50 offset:10240
    s_waitcnt lgkmcnt(6)
    v_mfma_f32_16x16x32_bf16 v[68:71], a[188:191], a[200:203], 0
    v_mfma_f32_16x16x32_bf16 v[76:79], a[188:191], a[204:207], 0
    v_mfma_f32_16x16x32_bf16 v[84:87], a[188:191], a[208:211], 0
    v_mfma_f32_16x16x32_bf16 v[92:95], a[188:191], a[212:215], 0
    v_mfma_f32_16x16x32_bf16 v[100:103], a[188:191], a[216:219], 0
    s_waitcnt lgkmcnt(2)
    ds_read_b64_tr_b16 a[188:189], v50 offset:8200
    ds_read_b64_tr_b16 a[190:191], v50 offset:10248
    v_mfma_f32_16x16x32_bf16 v[104:107], a[192:195], a[200:203], 0
    v_mfma_f32_16x16x32_bf16 v[112:115], a[192:195], a[204:207], 0
    v_mfma_f32_16x16x32_bf16 v[120:123], a[192:195], a[208:211], 0
    v_mfma_f32_16x16x32_bf16 v[128:131], a[192:195], a[212:215], 0
    v_add_u32 v51, 0x20000, v51
    v_mfma_f32_16x16x32_bf16 v[136:139], a[192:195], a[216:219], 0
    ds_read_b64_tr_b16 a[192:193], v51 offset:8192
    ds_read_b64_tr_b16 a[194:195], v51 offset:10240
    v_mfma_f32_16x16x32_bf16 v[108:111], a[196:199], a[200:203], 0
    v_mfma_f32_16x16x32_bf16 v[116:119], a[196:199], a[204:207], 0
    v_mfma_f32_16x16x32_bf16 v[124:127], a[196:199], a[208:211], 0
    v_mfma_f32_16x16x32_bf16 v[132:135], a[196:199], a[212:215], 0
    v_mfma_f32_16x16x32_bf16 v[140:143], a[196:199], a[216:219], 0
    s_waitcnt lgkmcnt(2)
    ds_read_b64_tr_b16 a[196:197], v51 offset:8200
    ds_read_b64_tr_b16 a[198:199], v51 offset:10248
    v_mfma_f32_16x16x32_bf16 v[144:147], a[184:187], a[200:203], 0
    v_mfma_f32_16x16x32_bf16 v[152:155], a[184:187], a[204:207], 0
    s_add_u32 m0, s25, 49152
    v_mfma_f32_16x16x32_bf16 v[160:163], a[184:187], a[208:211], 0
    buffer_load_dwordx4 v54, s[16:19], s78 offen offset:0 lds
    v_mfma_f32_16x16x32_bf16 v[168:171], a[184:187], a[212:215], 0
    buffer_load_dwordx4 v55, s[16:19], s78 offen offset:1024 lds
    v_mfma_f32_16x16x32_bf16 v[176:179], a[184:187], a[216:219], 0
    buffer_load_dwordx4 v56, s[16:19], s78 offen offset:2048 lds
    v_mfma_f32_16x16x32_bf16 v[148:151], a[188:191], a[200:203], 0
    buffer_load_dwordx4 v57, s[16:19], s78 offen offset:3072 lds
    v_mfma_f32_16x16x32_bf16 v[156:159], a[188:191], a[204:207], 0
    s_waitcnt lgkmcnt(0)
    s_waitcnt vmcnt(9)
    s_barrier
    v_add_u32 v48, 0xfffe0000, v48
    v_mfma_f32_16x16x32_bf16 v[164:167], a[188:191], a[208:211], 0
    ds_read_b64_tr_b16 a[184:185], v48 offset:32768
    ds_read_b64_tr_b16 a[186:187], v48 offset:34816
    v_mfma_f32_16x16x32_bf16 v[172:175], a[188:191], a[212:215], 0
    ds_read_b128 a[220:223], v53 offset:0
    v_mfma_f32_16x16x32_bf16 v[180:183], a[188:191], a[216:219], 0
    ds_read_b64_tr_b16 a[188:189], v48 offset:32776
    ds_read_b64_tr_b16 a[190:191], v48 offset:34824
    v_mfma_f32_16x16x32_bf16 v[184:187], a[192:195], a[200:203], 0
    ds_read_b128 a[224:227], v53 offset:2048
    v_mfma_f32_16x16x32_bf16 v[192:195], a[192:195], a[204:207], 0
    ds_read_b128 a[228:231], v53 offset:4096
    v_mfma_f32_16x16x32_bf16 v[200:203], a[192:195], a[208:211], 0
    ds_read_b128 a[232:235], v53 offset:6144
    v_mfma_f32_16x16x32_bf16 v[208:211], a[192:195], a[212:215], 0
    ds_read_b128 a[236:239], v53 offset:8192
    v_add_u32 v49, 0xfffe0000, v49
    v_mfma_f32_16x16x32_bf16 v[216:219], a[192:195], a[216:219], 0
    ds_read_b64_tr_b16 a[192:193], v49 offset:32768
    ds_read_b64_tr_b16 a[194:195], v49 offset:34816
    v_mfma_f32_16x16x32_bf16 v[188:191], a[196:199], a[200:203], 0
    v_mfma_f32_16x16x32_bf16 v[196:199], a[196:199], a[204:207], 0
    v_mfma_f32_16x16x32_bf16 v[204:207], a[196:199], a[208:211], 0
    v_mfma_f32_16x16x32_bf16 v[212:215], a[196:199], a[212:215], 0
    v_mfma_f32_16x16x32_bf16 v[220:223], a[196:199], a[216:219], 0
    s_waitcnt lgkmcnt(2)
    ds_read_b64_tr_b16 a[196:197], v49 offset:32776
    ds_read_b64_tr_b16 a[198:199], v49 offset:34824
    v_mfma_f32_16x16x32_bf16 v[64:67], a[184:187], a[220:223], v[64:67]
    v_mfma_f32_16x16x32_bf16 v[72:75], a[184:187], a[224:227], v[72:75]
    v_mfma_f32_16x16x32_bf16 v[80:83], a[184:187], a[228:231], v[80:83]
    s_add_u32 m0, s25, 139264
    v_mfma_f32_16x16x32_bf16 v[88:91], a[184:187], a[232:235], v[88:91]
    v_add_u32 v50, 0xfffe0000, v50
    v_mfma_f32_16x16x32_bf16 v[96:99], a[184:187], a[236:239], v[96:99]
    ds_read_b64_tr_b16 a[184:185], v50 offset:32768
    ds_read_b64_tr_b16 a[186:187], v50 offset:34816
    v_mfma_f32_16x16x32_bf16 v[68:71], a[188:191], a[220:223], v[68:71]
    buffer_load_dwordx4 v54, s[16:19], s79 offen offset:0 lds
    v_mfma_f32_16x16x32_bf16 v[76:79], a[188:191], a[224:227], v[76:79]
    buffer_load_dwordx4 v55, s[16:19], s79 offen offset:1024 lds
    v_mfma_f32_16x16x32_bf16 v[84:87], a[188:191], a[228:231], v[84:87]
    buffer_load_dwordx4 v56, s[16:19], s79 offen offset:2048 lds
    v_mfma_f32_16x16x32_bf16 v[92:95], a[188:191], a[232:235], v[92:95]
    buffer_load_dwordx4 v57, s[16:19], s79 offen offset:3072 lds
    v_mfma_f32_16x16x32_bf16 v[100:103], a[188:191], a[236:239], v[100:103]
    s_waitcnt lgkmcnt(2)
    ds_read_b64_tr_b16 a[188:189], v50 offset:32776
    ds_read_b64_tr_b16 a[190:191], v50 offset:34824
    v_mfma_f32_16x16x32_bf16 v[104:107], a[192:195], a[220:223], v[104:107]
    v_mfma_f32_16x16x32_bf16 v[112:115], a[192:195], a[224:227], v[112:115]
    v_mfma_f32_16x16x32_bf16 v[120:123], a[192:195], a[228:231], v[120:123]
    v_mfma_f32_16x16x32_bf16 v[128:131], a[192:195], a[232:235], v[128:131]
    v_add_u32 v51, 0xfffe0000, v51
    v_mfma_f32_16x16x32_bf16 v[136:139], a[192:195], a[236:239], v[136:139]
    ds_read_b64_tr_b16 a[192:193], v51 offset:32768
    ds_read_b64_tr_b16 a[194:195], v51 offset:34816
    v_mfma_f32_16x16x32_bf16 v[108:111], a[196:199], a[220:223], v[108:111]
    v_mfma_f32_16x16x32_bf16 v[116:119], a[196:199], a[224:227], v[116:119]
    v_mfma_f32_16x16x32_bf16 v[124:127], a[196:199], a[228:231], v[124:127]
    v_mfma_f32_16x16x32_bf16 v[132:135], a[196:199], a[232:235], v[132:135]
    v_mfma_f32_16x16x32_bf16 v[140:143], a[196:199], a[236:239], v[140:143]
    s_waitcnt lgkmcnt(2)
    ds_read_b64_tr_b16 a[196:197], v51 offset:32776
    ds_read_b64_tr_b16 a[198:199], v51 offset:34824
    v_mfma_f32_16x16x32_bf16 v[144:147], a[184:187], a[220:223], v[144:147]
    v_mfma_f32_16x16x32_bf16 v[152:155], a[184:187], a[224:227], v[152:155]
    v_mfma_f32_16x16x32_bf16 v[160:163], a[184:187], a[228:231], v[160:163]
    v_mfma_f32_16x16x32_bf16 v[168:171], a[184:187], a[232:235], v[168:171]
    v_mfma_f32_16x16x32_bf16 v[176:179], a[184:187], a[236:239], v[176:179]
    v_mfma_f32_16x16x32_bf16 v[148:151], a[188:191], a[220:223], v[148:151]
    v_mfma_f32_16x16x32_bf16 v[156:159], a[188:191], a[224:227], v[156:159]
    s_waitcnt lgkmcnt(0)
    s_waitcnt vmcnt(4)
    s_barrier
    v_mfma_f32_16x16x32_bf16 v[164:167], a[188:191], a[228:231], v[164:167]
    ds_read_b64_tr_b16 a[184:185], v48 offset:49152
    ds_read_b64_tr_b16 a[186:187], v48 offset:51200
    v_mfma_f32_16x16x32_bf16 v[172:175], a[188:191], a[232:235], v[172:175]
    ds_read_b128 a[200:203], v52 offset:20480
    v_mfma_f32_16x16x32_bf16 v[180:183], a[188:191], a[236:239], v[180:183]
    ds_read_b64_tr_b16 a[188:189], v48 offset:49160
    ds_read_b64_tr_b16 a[190:191], v48 offset:51208
    v_mfma_f32_16x16x32_bf16 v[184:187], a[192:195], a[220:223], v[184:187]
    ds_read_b128 a[204:207], v52 offset:22528
    v_mfma_f32_16x16x32_bf16 v[192:195], a[192:195], a[224:227], v[192:195]
    ds_read_b128 a[208:211], v52 offset:24576
    v_mfma_f32_16x16x32_bf16 v[200:203], a[192:195], a[228:231], v[200:203]
    ds_read_b128 a[212:215], v52 offset:26624
    v_mfma_f32_16x16x32_bf16 v[208:211], a[192:195], a[232:235], v[208:211]
    ds_read_b128 a[216:219], v52 offset:28672
    v_mfma_f32_16x16x32_bf16 v[216:219], a[192:195], a[236:239], v[216:219]
    ds_read_b64_tr_b16 a[192:193], v49 offset:49152
    ds_read_b64_tr_b16 a[194:195], v49 offset:51200
    v_mfma_f32_16x16x32_bf16 v[188:191], a[196:199], a[220:223], v[188:191]
    s_add_u32 m0, s25, 32768
    v_mfma_f32_16x16x32_bf16 v[196:199], a[196:199], a[224:227], v[196:199]
    buffer_load_dwordx4 v54, s[16:19], s80 offen offset:0 lds
    v_mfma_f32_16x16x32_bf16 v[204:207], a[196:199], a[228:231], v[204:207]
    buffer_load_dwordx4 v55, s[16:19], s80 offen offset:1024 lds
    v_mfma_f32_16x16x32_bf16 v[212:215], a[196:199], a[232:235], v[212:215]
    buffer_load_dwordx4 v56, s[16:19], s80 offen offset:2048 lds
    v_mfma_f32_16x16x32_bf16 v[220:223], a[196:199], a[236:239], v[220:223]
    s_waitcnt lgkmcnt(2)
    ds_read_b64_tr_b16 a[196:197], v49 offset:49160
    ds_read_b64_tr_b16 a[198:199], v49 offset:51208
    v_mfma_f32_16x16x32_bf16 v[64:67], a[184:187], a[200:203], v[64:67]
    buffer_load_dwordx4 v57, s[16:19], s80 offen offset:3072 lds
    v_mfma_f32_16x16x32_bf16 v[72:75], a[184:187], a[204:207], v[72:75]
    s_lshr_b32 s39, s80, 12
    v_mfma_f32_16x16x32_bf16 v[80:83], a[184:187], a[208:211], v[80:83]
    s_add_u32 m0, s25, 98304
    v_mfma_f32_16x16x32_bf16 v[88:91], a[184:187], a[212:215], v[88:91]
    buffer_load_dwordx4 v58, s[12:15], s39 offen offset:0 lds
    v_mfma_f32_16x16x32_bf16 v[96:99], a[184:187], a[216:219], v[96:99]
    ds_read_b64_tr_b16 a[184:185], v50 offset:49152
    ds_read_b64_tr_b16 a[186:187], v50 offset:51200
    v_mfma_f32_16x16x32_bf16 v[68:71], a[188:191], a[200:203], v[68:71]
    buffer_load_dwordx4 v59, s[12:15], s39 offen offset:1024 lds
    v_mfma_f32_16x16x32_bf16 v[76:79], a[188:191], a[204:207], v[76:79]
    buffer_load_dwordx4 v60, s[12:15], s39 offen offset:2048 lds
    v_mfma_f32_16x16x32_bf16 v[84:87], a[188:191], a[208:211], v[84:87]
    buffer_load_dwordx4 v61, s[12:15], s39 offen offset:3072 lds
    v_mfma_f32_16x16x32_bf16 v[92:95], a[188:191], a[212:215], v[92:95]
    s_add_u32 m0, s35, 114688
    v_mfma_f32_16x16x32_bf16 v[100:103], a[188:191], a[216:219], v[100:103]
    s_waitcnt lgkmcnt(2)
    ds_read_b64_tr_b16 a[188:189], v50 offset:49160
    ds_read_b64_tr_b16 a[190:191], v50 offset:51208
    v_mfma_f32_16x16x32_bf16 v[104:107], a[192:195], a[200:203], v[104:107]
    v_mfma_f32_16x16x32_bf16 v[112:115], a[192:195], a[204:207], v[112:115]
    v_mfma_f32_16x16x32_bf16 v[120:123], a[192:195], a[208:211], v[120:123]
    v_mfma_f32_16x16x32_bf16 v[128:131], a[192:195], a[212:215], v[128:131]
    v_mfma_f32_16x16x32_bf16 v[136:139], a[192:195], a[216:219], v[136:139]
    ds_read_b64_tr_b16 a[192:193], v51 offset:49152
    ds_read_b64_tr_b16 a[194:195], v51 offset:51200
    v_mfma_f32_16x16x32_bf16 v[108:111], a[196:199], a[200:203], v[108:111]
    v_mfma_f32_16x16x32_bf16 v[116:119], a[196:199], a[204:207], v[116:119]
    v_mfma_f32_16x16x32_bf16 v[124:127], a[196:199], a[208:211], v[124:127]
    v_accvgpr_write_b32 a0, 0
    v_mfma_f32_16x16x32_bf16 v[132:135], a[196:199], a[212:215], v[132:135]
    v_accvgpr_write_b32 a1, 0
    v_mfma_f32_16x16x32_bf16 v[140:143], a[196:199], a[216:219], v[140:143]
    s_waitcnt lgkmcnt(2)
    ds_read_b64_tr_b16 a[196:197], v51 offset:49160
    ds_read_b64_tr_b16 a[198:199], v51 offset:51208
    v_mfma_f32_16x16x32_bf16 v[144:147], a[184:187], a[200:203], v[144:147]
    v_accvgpr_write_b32 a2, 0
    v_mfma_f32_16x16x32_bf16 v[152:155], a[184:187], a[204:207], v[152:155]
    v_accvgpr_write_b32 a3, 0
    v_mfma_f32_16x16x32_bf16 v[160:163], a[184:187], a[208:211], v[160:163]
    v_accvgpr_write_b32 a4, 0
    v_mfma_f32_16x16x32_bf16 v[168:171], a[184:187], a[212:215], v[168:171]
    v_accvgpr_write_b32 a5, 0
    v_mfma_f32_16x16x32_bf16 v[176:179], a[184:187], a[216:219], v[176:179]
    v_accvgpr_write_b32 a6, 0
    v_mfma_f32_16x16x32_bf16 v[148:151], a[188:191], a[200:203], v[148:151]
    buffer_load_dwordx4 v62, s[12:15], s39 offen lds
    v_mfma_f32_16x16x32_bf16 v[156:159], a[188:191], a[204:207], v[156:159]
    s_waitcnt lgkmcnt(0)
    s_waitcnt vmcnt(9)
    s_barrier
    v_add_u32 v48, 0x20000, v48
    v_mfma_f32_16x16x32_bf16 v[164:167], a[188:191], a[208:211], v[164:167]
    ds_read_b64_tr_b16 a[184:185], v48 offset:8192
    ds_read_b64_tr_b16 a[186:187], v48 offset:10240
    v_mfma_f32_16x16x32_bf16 v[172:175], a[188:191], a[212:215], v[172:175]
    ds_read_b128 a[220:223], v53 offset:20480
    v_mfma_f32_16x16x32_bf16 v[180:183], a[188:191], a[216:219], v[180:183]
    ds_read_b64_tr_b16 a[188:189], v48 offset:8200
    ds_read_b64_tr_b16 a[190:191], v48 offset:10248
    v_mfma_f32_16x16x32_bf16 v[184:187], a[192:195], a[200:203], v[184:187]
    ds_read_b128 a[224:227], v53 offset:22528
    v_mfma_f32_16x16x32_bf16 v[192:195], a[192:195], a[204:207], v[192:195]
    ds_read_b128 a[228:231], v53 offset:24576
    v_mfma_f32_16x16x32_bf16 v[200:203], a[192:195], a[208:211], v[200:203]
    ds_read_b128 a[232:235], v53 offset:26624
    v_mfma_f32_16x16x32_bf16 v[208:211], a[192:195], a[212:215], v[208:211]
    ds_read_b128 a[236:239], v53 offset:28672
    v_add_u32 v49, 0x20000, v49
    v_mfma_f32_16x16x32_bf16 v[216:219], a[192:195], a[216:219], v[216:219]
    ds_read_b64_tr_b16 a[192:193], v49 offset:8192
    ds_read_b64_tr_b16 a[194:195], v49 offset:10240
    v_mfma_f32_16x16x32_bf16 v[188:191], a[196:199], a[200:203], v[188:191]
    v_and_b32 v4, 1, v26
    v_mfma_f32_16x16x32_bf16 v[196:199], a[196:199], a[204:207], v[196:199]
    v_lshlrev_b32 v4, 4, v4
    v_mfma_f32_16x16x32_bf16 v[204:207], a[196:199], a[208:211], v[204:207]
    v_lshlrev_b32 v4, v4, 1
    v_mfma_f32_16x16x32_bf16 v[212:215], a[196:199], a[212:215], v[212:215]
    v_lshrrev_b32 v1, 1, v0
    v_mfma_f32_16x16x32_bf16 v[220:223], a[196:199], a[216:219], v[220:223]
    v_lshl_add_u32 v1, v1, 16, v30
    s_waitcnt lgkmcnt(2)
    ds_read_b64_tr_b16 a[196:197], v49 offset:8200
    ds_read_b64_tr_b16 a[198:199], v49 offset:10248
    v_mfma_f32_16x16x32_bf16 v[64:67], a[184:187], a[220:223], v[64:67]
    buffer_atomic_add v4, v1, s[48:51], 0 offen sc1
    v_mfma_f32_16x16x32_bf16 v[72:75], a[184:187], a[224:227], v[72:75]
    v_accvgpr_write_b32 a7, 0
    v_mfma_f32_16x16x32_bf16 v[80:83], a[184:187], a[228:231], v[80:83]
    v_accvgpr_write_b32 a8, 0
    v_mfma_f32_16x16x32_bf16 v[88:91], a[184:187], a[232:235], v[88:91]
    v_add_u32 v50, 0x20000, v50
    v_mfma_f32_16x16x32_bf16 v[96:99], a[184:187], a[236:239], v[96:99]
    ds_read_b64_tr_b16 a[184:185], v50 offset:8192
    ds_read_b64_tr_b16 a[186:187], v50 offset:10240
    v_mfma_f32_16x16x32_bf16 v[68:71], a[188:191], a[220:223], v[68:71]
    v_accvgpr_write_b32 a9, 0
    v_mfma_f32_16x16x32_bf16 v[76:79], a[188:191], a[224:227], v[76:79]
    v_accvgpr_write_b32 a10, 0
    v_mfma_f32_16x16x32_bf16 v[84:87], a[188:191], a[228:231], v[84:87]
    v_accvgpr_write_b32 a11, 0
    v_mfma_f32_16x16x32_bf16 v[92:95], a[188:191], a[232:235], v[92:95]
    v_accvgpr_write_b32 a12, 0
    v_mfma_f32_16x16x32_bf16 v[100:103], a[188:191], a[236:239], v[100:103]
    s_waitcnt lgkmcnt(2)
    ds_read_b64_tr_b16 a[188:189], v50 offset:8200
    ds_read_b64_tr_b16 a[190:191], v50 offset:10248
    v_mfma_f32_16x16x32_bf16 v[104:107], a[192:195], a[220:223], v[104:107]
    v_accvgpr_write_b32 a13, 0
    v_mfma_f32_16x16x32_bf16 v[112:115], a[192:195], a[224:227], v[112:115]
    v_accvgpr_write_b32 a14, 0
    v_mfma_f32_16x16x32_bf16 v[120:123], a[192:195], a[228:231], v[120:123]
    v_accvgpr_write_b32 a15, 0
    v_mfma_f32_16x16x32_bf16 v[128:131], a[192:195], a[232:235], v[128:131]
    v_add_u32 v51, 0x20000, v51
    v_mfma_f32_16x16x32_bf16 v[136:139], a[192:195], a[236:239], v[136:139]
    ds_read_b64_tr_b16 a[192:193], v51 offset:8192
    ds_read_b64_tr_b16 a[194:195], v51 offset:10240
    v_mfma_f32_16x16x32_bf16 v[108:111], a[196:199], a[220:223], v[108:111]
    v_accvgpr_write_b32 a16, 0
    v_mfma_f32_16x16x32_bf16 v[116:119], a[196:199], a[224:227], v[116:119]
    v_accvgpr_write_b32 a17, 0
    v_mfma_f32_16x16x32_bf16 v[124:127], a[196:199], a[228:231], v[124:127]
    v_accvgpr_write_b32 a18, 0
    v_mfma_f32_16x16x32_bf16 v[132:135], a[196:199], a[232:235], v[132:135]
    v_accvgpr_write_b32 a19, 0
    v_mfma_f32_16x16x32_bf16 v[140:143], a[196:199], a[236:239], v[140:143]
    s_waitcnt lgkmcnt(2)
    ds_read_b64_tr_b16 a[196:197], v51 offset:8200
    ds_read_b64_tr_b16 a[198:199], v51 offset:10248
    v_mfma_f32_16x16x32_bf16 v[144:147], a[184:187], a[220:223], v[144:147]
    v_accvgpr_write_b32 a20, 0
    v_mfma_f32_16x16x32_bf16 v[152:155], a[184:187], a[224:227], v[152:155]
    s_add_u32 m0, s25, 49152
    v_mfma_f32_16x16x32_bf16 v[160:163], a[184:187], a[228:231], v[160:163]
    buffer_load_dwordx4 v54, s[16:19], s81 offen offset:0 lds
    v_mfma_f32_16x16x32_bf16 v[168:171], a[184:187], a[232:235], v[168:171]
    buffer_load_dwordx4 v55, s[16:19], s81 offen offset:1024 lds
    v_mfma_f32_16x16x32_bf16 v[176:179], a[184:187], a[236:239], v[176:179]
    buffer_load_dwordx4 v56, s[16:19], s81 offen offset:2048 lds
    v_mfma_f32_16x16x32_bf16 v[148:151], a[188:191], a[220:223], v[148:151]
    buffer_load_dwordx4 v57, s[16:19], s81 offen offset:3072 lds
    v_mfma_f32_16x16x32_bf16 v[156:159], a[188:191], a[224:227], v[156:159]
    s_waitcnt lgkmcnt(0)
    s_waitcnt vmcnt(5)
    s_barrier
    v_add_u32 v48, 0xfffe0000, v48
    v_mfma_f32_16x16x32_bf16 v[164:167], a[188:191], a[228:231], v[164:167]
    ds_read_b64_tr_b16 a[184:185], v48 offset:32768
    ds_read_b64_tr_b16 a[186:187], v48 offset:34816
    v_mfma_f32_16x16x32_bf16 v[172:175], a[188:191], a[232:235], v[172:175]
    ds_read_b128 a[200:203], v52 offset:0
    v_mfma_f32_16x16x32_bf16 v[180:183], a[188:191], a[236:239], v[180:183]
    ds_read_b64_tr_b16 a[188:189], v48 offset:32776
    ds_read_b64_tr_b16 a[190:191], v48 offset:34824
    v_mfma_f32_16x16x32_bf16 v[184:187], a[192:195], a[220:223], v[184:187]
    ds_read_b128 a[204:207], v52 offset:2048
    v_mfma_f32_16x16x32_bf16 v[192:195], a[192:195], a[224:227], v[192:195]
    ds_read_b128 a[208:211], v52 offset:4096
    v_mfma_f32_16x16x32_bf16 v[200:203], a[192:195], a[228:231], v[200:203]
    ds_read_b128 a[212:215], v52 offset:6144
    v_mfma_f32_16x16x32_bf16 v[208:211], a[192:195], a[232:235], v[208:211]
    ds_read_b128 a[216:219], v52 offset:8192
    v_add_u32 v49, 0xfffe0000, v49
    v_mfma_f32_16x16x32_bf16 v[216:219], a[192:195], a[236:239], v[216:219]
    ds_read_b64_tr_b16 a[192:193], v49 offset:32768
    ds_read_b64_tr_b16 a[194:195], v49 offset:34816
    v_mfma_f32_16x16x32_bf16 v[188:191], a[196:199], a[220:223], v[188:191]
    v_accvgpr_write_b32 a21, 0
    v_mfma_f32_16x16x32_bf16 v[196:199], a[196:199], a[224:227], v[196:199]
    s_add_u32 m0, s25, 139264
    v_mfma_f32_16x16x32_bf16 v[204:207], a[196:199], a[228:231], v[204:207]
    buffer_load_dwordx4 v54, s[16:19], s82 offen offset:0 lds
    v_mfma_f32_16x16x32_bf16 v[212:215], a[196:199], a[232:235], v[212:215]
    buffer_load_dwordx4 v55, s[16:19], s82 offen offset:1024 lds
    v_mfma_f32_16x16x32_bf16 v[220:223], a[196:199], a[236:239], v[220:223]
    s_waitcnt lgkmcnt(2)
    ds_read_b64_tr_b16 a[196:197], v49 offset:32776
    ds_read_b64_tr_b16 a[198:199], v49 offset:34824
    v_mfma_f32_16x16x32_bf16 v[64:67], a[184:187], a[200:203], v[64:67]
    buffer_load_dwordx4 v56, s[16:19], s82 offen offset:2048 lds
    v_mfma_f32_16x16x32_bf16 v[72:75], a[184:187], a[204:207], v[72:75]
    buffer_load_dwordx4 v57, s[16:19], s82 offen offset:3072 lds
    v_mfma_f32_16x16x32_bf16 v[80:83], a[184:187], a[208:211], v[80:83]
    s_lshr_b32 s39, s82, 12
    v_mfma_f32_16x16x32_bf16 v[88:91], a[184:187], a[212:215], v[88:91]
    v_add_u32 v50, 0xfffe0000, v50
    v_mfma_f32_16x16x32_bf16 v[96:99], a[184:187], a[216:219], v[96:99]
    ds_read_b64_tr_b16 a[184:185], v50 offset:32768
    ds_read_b64_tr_b16 a[186:187], v50 offset:34816
    v_mfma_f32_16x16x32_bf16 v[68:71], a[188:191], a[200:203], v[68:71]
    s_add_u32 m0, s25, 118784
    v_mfma_f32_16x16x32_bf16 v[76:79], a[188:191], a[204:207], v[76:79]
    buffer_load_dwordx4 v58, s[12:15], s39 offen offset:0 lds
    v_mfma_f32_16x16x32_bf16 v[84:87], a[188:191], a[208:211], v[84:87]
    buffer_load_dwordx4 v59, s[12:15], s39 offen offset:1024 lds
    v_mfma_f32_16x16x32_bf16 v[92:95], a[188:191], a[212:215], v[92:95]
    buffer_load_dwordx4 v60, s[12:15], s39 offen offset:2048 lds
    v_mfma_f32_16x16x32_bf16 v[100:103], a[188:191], a[216:219], v[100:103]
    s_waitcnt lgkmcnt(2)
    ds_read_b64_tr_b16 a[188:189], v50 offset:32776
    ds_read_b64_tr_b16 a[190:191], v50 offset:34824
    v_mfma_f32_16x16x32_bf16 v[104:107], a[192:195], a[200:203], v[104:107]
    v_accvgpr_write_b32 a22, 0
    v_mfma_f32_16x16x32_bf16 v[112:115], a[192:195], a[204:207], v[112:115]
    v_accvgpr_write_b32 a23, 0
    v_mfma_f32_16x16x32_bf16 v[120:123], a[192:195], a[208:211], v[120:123]
    v_accvgpr_write_b32 a24, 0
    v_mfma_f32_16x16x32_bf16 v[128:131], a[192:195], a[212:215], v[128:131]
    v_add_u32 v51, 0xfffe0000, v51
    v_mfma_f32_16x16x32_bf16 v[136:139], a[192:195], a[216:219], v[136:139]
    ds_read_b64_tr_b16 a[192:193], v51 offset:32768
    ds_read_b64_tr_b16 a[194:195], v51 offset:34816
    v_mfma_f32_16x16x32_bf16 v[108:111], a[196:199], a[200:203], v[108:111]
    v_accvgpr_write_b32 a25, 0
    v_mfma_f32_16x16x32_bf16 v[116:119], a[196:199], a[204:207], v[116:119]
    v_accvgpr_write_b32 a26, 0
    v_mfma_f32_16x16x32_bf16 v[124:127], a[196:199], a[208:211], v[124:127]
    v_accvgpr_write_b32 a27, 0
    v_mfma_f32_16x16x32_bf16 v[132:135], a[196:199], a[212:215], v[132:135]
    v_accvgpr_write_b32 a28, 0
    v_mfma_f32_16x16x32_bf16 v[140:143], a[196:199], a[216:219], v[140:143]
    s_waitcnt lgkmcnt(2)
    ds_read_b64_tr_b16 a[196:197], v51 offset:32776
    ds_read_b64_tr_b16 a[198:199], v51 offset:34824
    v_mfma_f32_16x16x32_bf16 v[144:147], a[184:187], a[200:203], v[144:147]
    v_accvgpr_write_b32 a29, 0
    v_mfma_f32_16x16x32_bf16 v[152:155], a[184:187], a[204:207], v[152:155]
    v_accvgpr_write_b32 a30, 0
    v_mfma_f32_16x16x32_bf16 v[160:163], a[184:187], a[208:211], v[160:163]
    v_accvgpr_write_b32 a31, 0
    v_mfma_f32_16x16x32_bf16 v[168:171], a[184:187], a[212:215], v[168:171]
    buffer_load_dwordx4 v61, s[12:15], s39 offen offset:3072 lds
    v_mfma_f32_16x16x32_bf16 v[176:179], a[184:187], a[216:219], v[176:179]
    s_add_u32 m0, s35, 135168
    v_mfma_f32_16x16x32_bf16 v[148:151], a[188:191], a[200:203], v[148:151]
    buffer_load_dwordx4 v62, s[12:15], s39 offen lds
    v_mfma_f32_16x16x32_bf16 v[156:159], a[188:191], a[204:207], v[156:159]
    s_waitcnt lgkmcnt(0)
    s_waitcnt vmcnt(9)
    s_barrier
    v_mfma_f32_16x16x32_bf16 v[164:167], a[188:191], a[208:211], v[164:167]
    ds_read_b64_tr_b16 a[184:185], v48 offset:49152
    ds_read_b64_tr_b16 a[186:187], v48 offset:51200
    v_mfma_f32_16x16x32_bf16 v[172:175], a[188:191], a[212:215], v[172:175]
    ds_read_b128 a[220:223], v53 offset:0
    v_mfma_f32_16x16x32_bf16 v[180:183], a[188:191], a[216:219], v[180:183]
    ds_read_b64_tr_b16 a[188:189], v48 offset:49160
    ds_read_b64_tr_b16 a[190:191], v48 offset:51208
    v_mfma_f32_16x16x32_bf16 v[184:187], a[192:195], a[200:203], v[184:187]
    ds_read_b128 a[224:227], v53 offset:2048
    v_mfma_f32_16x16x32_bf16 v[192:195], a[192:195], a[204:207], v[192:195]
    ds_read_b128 a[228:231], v53 offset:4096
    v_mfma_f32_16x16x32_bf16 v[200:203], a[192:195], a[208:211], v[200:203]
    ds_read_b128 a[232:235], v53 offset:6144
    v_mfma_f32_16x16x32_bf16 v[208:211], a[192:195], a[212:215], v[208:211]
    ds_read_b128 a[236:239], v53 offset:8192
    v_mfma_f32_16x16x32_bf16 v[216:219], a[192:195], a[216:219], v[216:219]
    ds_read_b64_tr_b16 a[192:193], v49 offset:49152
    ds_read_b64_tr_b16 a[194:195], v49 offset:51200
    v_mfma_f32_16x16x32_bf16 v[188:191], a[196:199], a[200:203], v[188:191]
    v_accvgpr_write_b32 a32, 0
    v_mfma_f32_16x16x32_bf16 v[196:199], a[196:199], a[204:207], v[196:199]
    v_accvgpr_write_b32 a33, 0
    v_mfma_f32_16x16x32_bf16 v[204:207], a[196:199], a[208:211], v[204:207]
    v_accvgpr_write_b32 a34, 0
    v_mfma_f32_16x16x32_bf16 v[212:215], a[196:199], a[212:215], v[212:215]
    v_accvgpr_write_b32 a35, 0
    v_mfma_f32_16x16x32_bf16 v[220:223], a[196:199], a[216:219], v[220:223]
    s_waitcnt lgkmcnt(2)
    ds_read_b64_tr_b16 a[196:197], v49 offset:49160
    ds_read_b64_tr_b16 a[198:199], v49 offset:51208
    v_mfma_f32_16x16x32_bf16 v[64:67], a[184:187], a[220:223], v[64:67]
    v_accvgpr_write_b32 a36, 0
    v_mfma_f32_16x16x32_bf16 v[72:75], a[184:187], a[224:227], v[72:75]
    v_accvgpr_write_b32 a37, 0
    v_mfma_f32_16x16x32_bf16 v[80:83], a[184:187], a[228:231], v[80:83]
    v_accvgpr_write_b32 a38, 0
    v_mfma_f32_16x16x32_bf16 v[88:91], a[184:187], a[232:235], v[88:91]
    v_accvgpr_write_b32 a39, 0
    v_mfma_f32_16x16x32_bf16 v[96:99], a[184:187], a[236:239], v[96:99]
    ds_read_b64_tr_b16 a[184:185], v50 offset:49152
    ds_read_b64_tr_b16 a[186:187], v50 offset:51200
    v_mfma_f32_16x16x32_bf16 v[68:71], a[188:191], a[220:223], v[68:71]
    s_add_u32 m0, s25, 32768
    v_mfma_f32_16x16x32_bf16 v[76:79], a[188:191], a[224:227], v[76:79]
    buffer_load_dwordx4 v54, s[16:19], s83 offen offset:0 lds
    v_mfma_f32_16x16x32_bf16 v[84:87], a[188:191], a[228:231], v[84:87]
    buffer_load_dwordx4 v55, s[16:19], s83 offen offset:1024 lds
    v_mfma_f32_16x16x32_bf16 v[92:95], a[188:191], a[232:235], v[92:95]
    buffer_load_dwordx4 v56, s[16:19], s83 offen offset:2048 lds
    v_mfma_f32_16x16x32_bf16 v[100:103], a[188:191], a[236:239], v[100:103]
    s_waitcnt lgkmcnt(2)
    ds_read_b64_tr_b16 a[188:189], v50 offset:49160
    ds_read_b64_tr_b16 a[190:191], v50 offset:51208
    v_mfma_f32_16x16x32_bf16 v[104:107], a[192:195], a[220:223], v[104:107]
    v_accvgpr_write_b32 a40, 0
    v_mfma_f32_16x16x32_bf16 v[112:115], a[192:195], a[224:227], v[112:115]
    v_accvgpr_write_b32 a41, 0
    v_mfma_f32_16x16x32_bf16 v[120:123], a[192:195], a[228:231], v[120:123]
    v_accvgpr_write_b32 a42, 0
    v_mfma_f32_16x16x32_bf16 v[128:131], a[192:195], a[232:235], v[128:131]
    v_accvgpr_write_b32 a43, 0
    v_mfma_f32_16x16x32_bf16 v[136:139], a[192:195], a[236:239], v[136:139]
    ds_read_b64_tr_b16 a[192:193], v51 offset:49152
    ds_read_b64_tr_b16 a[194:195], v51 offset:51200
    v_mfma_f32_16x16x32_bf16 v[108:111], a[196:199], a[220:223], v[108:111]
    v_accvgpr_write_b32 a44, 0
    v_mfma_f32_16x16x32_bf16 v[116:119], a[196:199], a[224:227], v[116:119]
    v_accvgpr_write_b32 a45, 0
    v_mfma_f32_16x16x32_bf16 v[124:127], a[196:199], a[228:231], v[124:127]
    v_accvgpr_write_b32 a46, 0
    v_mfma_f32_16x16x32_bf16 v[132:135], a[196:199], a[232:235], v[132:135]
    v_accvgpr_write_b32 a47, 0
    v_mfma_f32_16x16x32_bf16 v[140:143], a[196:199], a[236:239], v[140:143]
    s_waitcnt lgkmcnt(2)
    ds_read_b64_tr_b16 a[196:197], v51 offset:49160
    ds_read_b64_tr_b16 a[198:199], v51 offset:51208
    v_mfma_f32_16x16x32_bf16 v[144:147], a[184:187], a[220:223], v[144:147]
    v_accvgpr_write_b32 a48, 0
    v_mfma_f32_16x16x32_bf16 v[152:155], a[184:187], a[224:227], v[152:155]
    v_accvgpr_write_b32 a49, 0
    v_mfma_f32_16x16x32_bf16 v[160:163], a[184:187], a[228:231], v[160:163]
    v_accvgpr_write_b32 a50, 0
    v_mfma_f32_16x16x32_bf16 v[168:171], a[184:187], a[232:235], v[168:171]
    v_accvgpr_write_b32 a51, 0
    v_mfma_f32_16x16x32_bf16 v[176:179], a[184:187], a[236:239], v[176:179]
    v_accvgpr_write_b32 a52, 0
    v_mfma_f32_16x16x32_bf16 v[148:151], a[188:191], a[220:223], v[148:151]
    buffer_load_dwordx4 v57, s[16:19], s83 offen offset:3072 lds
    v_mfma_f32_16x16x32_bf16 v[156:159], a[188:191], a[224:227], v[156:159]
    s_waitcnt lgkmcnt(0)
    s_waitcnt vmcnt(4)
    s_barrier
    v_add_u32 v48, 0x20000, v48
    v_mfma_f32_16x16x32_bf16 v[164:167], a[188:191], a[228:231], v[164:167]
    ds_read_b64_tr_b16 a[184:185], v48 offset:8192
    ds_read_b64_tr_b16 a[186:187], v48 offset:10240
    v_mfma_f32_16x16x32_bf16 v[172:175], a[188:191], a[232:235], v[172:175]
    ds_read_b128 a[200:203], v52 offset:20480
    v_mfma_f32_16x16x32_bf16 v[180:183], a[188:191], a[236:239], v[180:183]
    ds_read_b64_tr_b16 a[188:189], v48 offset:8200
    ds_read_b64_tr_b16 a[190:191], v48 offset:10248
    v_mfma_f32_16x16x32_bf16 v[184:187], a[192:195], a[220:223], v[184:187]
    ds_read_b128 a[204:207], v52 offset:22528
    v_mfma_f32_16x16x32_bf16 v[192:195], a[192:195], a[224:227], v[192:195]
    ds_read_b128 a[208:211], v52 offset:24576
    v_mfma_f32_16x16x32_bf16 v[200:203], a[192:195], a[228:231], v[200:203]
    ds_read_b128 a[212:215], v52 offset:26624
    v_mfma_f32_16x16x32_bf16 v[208:211], a[192:195], a[232:235], v[208:211]
    ds_read_b128 a[216:219], v52 offset:28672
    v_add_u32 v49, 0x20000, v49
    v_mfma_f32_16x16x32_bf16 v[216:219], a[192:195], a[236:239], v[216:219]
    ds_read_b64_tr_b16 a[192:193], v49 offset:8192
    ds_read_b64_tr_b16 a[194:195], v49 offset:10240
    v_mfma_f32_16x16x32_bf16 v[188:191], a[196:199], a[220:223], v[188:191]
    v_accvgpr_write_b32 a53, 0
    v_mfma_f32_16x16x32_bf16 v[196:199], a[196:199], a[224:227], v[196:199]
    s_add_u32 m0, s25, 49152
    v_mfma_f32_16x16x32_bf16 v[204:207], a[196:199], a[228:231], v[204:207]
    buffer_load_dwordx4 v54, s[16:19], s84 offen offset:0 lds
    v_mfma_f32_16x16x32_bf16 v[212:215], a[196:199], a[232:235], v[212:215]
    buffer_load_dwordx4 v55, s[16:19], s84 offen offset:1024 lds
    v_mfma_f32_16x16x32_bf16 v[220:223], a[196:199], a[236:239], v[220:223]
    s_waitcnt lgkmcnt(2)
    ds_read_b64_tr_b16 a[196:197], v49 offset:8200
    ds_read_b64_tr_b16 a[198:199], v49 offset:10248
    v_mfma_f32_16x16x32_bf16 v[64:67], a[184:187], a[200:203], v[64:67]
    buffer_load_dwordx4 v56, s[16:19], s84 offen offset:2048 lds
    v_mfma_f32_16x16x32_bf16 v[72:75], a[184:187], a[204:207], v[72:75]
    buffer_load_dwordx4 v57, s[16:19], s84 offen offset:3072 lds
    v_mfma_f32_16x16x32_bf16 v[80:83], a[184:187], a[208:211], v[80:83]
    s_lshr_b32 s39, s84, 12
    v_mfma_f32_16x16x32_bf16 v[88:91], a[184:187], a[212:215], v[88:91]
    v_add_u32 v50, 0x20000, v50
    v_mfma_f32_16x16x32_bf16 v[96:99], a[184:187], a[216:219], v[96:99]
    ds_read_b64_tr_b16 a[184:185], v50 offset:8192
    ds_read_b64_tr_b16 a[186:187], v50 offset:10240
    v_mfma_f32_16x16x32_bf16 v[68:71], a[188:191], a[200:203], v[68:71]
    s_add_u32 m0, s25, 98304
    v_mfma_f32_16x16x32_bf16 v[76:79], a[188:191], a[204:207], v[76:79]
    buffer_load_dwordx4 v58, s[12:15], s39 offen offset:0 lds
    v_mfma_f32_16x16x32_bf16 v[84:87], a[188:191], a[208:211], v[84:87]
    buffer_load_dwordx4 v59, s[12:15], s39 offen offset:1024 lds
    v_mfma_f32_16x16x32_bf16 v[92:95], a[188:191], a[212:215], v[92:95]
    buffer_load_dwordx4 v60, s[12:15], s39 offen offset:2048 lds
    v_mfma_f32_16x16x32_bf16 v[100:103], a[188:191], a[216:219], v[100:103]
    s_waitcnt lgkmcnt(2)
    ds_read_b64_tr_b16 a[188:189], v50 offset:8200
    ds_read_b64_tr_b16 a[190:191], v50 offset:10248
    v_mfma_f32_16x16x32_bf16 v[104:107], a[192:195], a[200:203], v[104:107]
    v_accvgpr_write_b32 a54, 0
    v_mfma_f32_16x16x32_bf16 v[112:115], a[192:195], a[204:207], v[112:115]
    v_accvgpr_write_b32 a55, 0
    v_mfma_f32_16x16x32_bf16 v[120:123], a[192:195], a[208:211], v[120:123]
    v_accvgpr_write_b32 a56, 0
    v_mfma_f32_16x16x32_bf16 v[128:131], a[192:195], a[212:215], v[128:131]
    v_add_u32 v51, 0x20000, v51
    v_mfma_f32_16x16x32_bf16 v[136:139], a[192:195], a[216:219], v[136:139]
    ds_read_b64_tr_b16 a[192:193], v51 offset:8192
    ds_read_b64_tr_b16 a[194:195], v51 offset:10240
    v_mfma_f32_16x16x32_bf16 v[108:111], a[196:199], a[200:203], v[108:111]
    v_accvgpr_write_b32 a57, 0
    v_mfma_f32_16x16x32_bf16 v[116:119], a[196:199], a[204:207], v[116:119]
    v_accvgpr_write_b32 a58, 0
    v_mfma_f32_16x16x32_bf16 v[124:127], a[196:199], a[208:211], v[124:127]
    v_accvgpr_write_b32 a59, 0
    v_mfma_f32_16x16x32_bf16 v[132:135], a[196:199], a[212:215], v[132:135]
    v_accvgpr_write_b32 a60, 0
    v_mfma_f32_16x16x32_bf16 v[140:143], a[196:199], a[216:219], v[140:143]
    s_waitcnt lgkmcnt(2)
    ds_read_b64_tr_b16 a[196:197], v51 offset:8200
    ds_read_b64_tr_b16 a[198:199], v51 offset:10248
    v_mfma_f32_16x16x32_bf16 v[144:147], a[184:187], a[200:203], v[144:147]
    v_accvgpr_write_b32 a61, 0
    v_mfma_f32_16x16x32_bf16 v[152:155], a[184:187], a[204:207], v[152:155]
    v_accvgpr_write_b32 a62, 0
    v_mfma_f32_16x16x32_bf16 v[160:163], a[184:187], a[208:211], v[160:163]
    v_accvgpr_write_b32 a63, 0
    v_mfma_f32_16x16x32_bf16 v[168:171], a[184:187], a[212:215], v[168:171]
    buffer_load_dwordx4 v61, s[12:15], s39 offen offset:3072 lds
    v_mfma_f32_16x16x32_bf16 v[176:179], a[184:187], a[216:219], v[176:179]
    s_add_u32 m0, s35, 114688
    v_mfma_f32_16x16x32_bf16 v[148:151], a[188:191], a[200:203], v[148:151]
    buffer_load_dwordx4 v62, s[12:15], s39 offen lds
    v_mfma_f32_16x16x32_bf16 v[156:159], a[188:191], a[204:207], v[156:159]
    s_waitcnt lgkmcnt(0)
    s_waitcnt vmcnt(9)
    s_barrier
    v_add_u32 v48, 0xfffe0000, v48
    v_mfma_f32_16x16x32_bf16 v[164:167], a[188:191], a[208:211], v[164:167]
    ds_read_b64_tr_b16 a[184:185], v48 offset:32768
    ds_read_b64_tr_b16 a[186:187], v48 offset:34816
    v_mfma_f32_16x16x32_bf16 v[172:175], a[188:191], a[212:215], v[172:175]
    ds_read_b128 a[220:223], v53 offset:20480
    v_mfma_f32_16x16x32_bf16 v[180:183], a[188:191], a[216:219], v[180:183]
    ds_read_b64_tr_b16 a[188:189], v48 offset:32776
    ds_read_b64_tr_b16 a[190:191], v48 offset:34824
    v_mfma_f32_16x16x32_bf16 v[184:187], a[192:195], a[200:203], v[184:187]
    ds_read_b128 a[224:227], v53 offset:22528
    v_mfma_f32_16x16x32_bf16 v[192:195], a[192:195], a[204:207], v[192:195]
    ds_read_b128 a[228:231], v53 offset:24576
    v_mfma_f32_16x16x32_bf16 v[200:203], a[192:195], a[208:211], v[200:203]
    ds_read_b128 a[232:235], v53 offset:26624
    v_mfma_f32_16x16x32_bf16 v[208:211], a[192:195], a[212:215], v[208:211]
    ds_read_b128 a[236:239], v53 offset:28672
    v_add_u32 v49, 0xfffe0000, v49
    v_mfma_f32_16x16x32_bf16 v[216:219], a[192:195], a[216:219], v[216:219]
    ds_read_b64_tr_b16 a[192:193], v49 offset:32768
    ds_read_b64_tr_b16 a[194:195], v49 offset:34816
    v_mfma_f32_16x16x32_bf16 v[188:191], a[196:199], a[200:203], v[188:191]
    v_accvgpr_write_b32 a64, 0
    v_mfma_f32_16x16x32_bf16 v[196:199], a[196:199], a[204:207], v[196:199]
    v_accvgpr_write_b32 a65, 0
    v_mfma_f32_16x16x32_bf16 v[204:207], a[196:199], a[208:211], v[204:207]
    v_accvgpr_write_b32 a66, 0
    v_mfma_f32_16x16x32_bf16 v[212:215], a[196:199], a[212:215], v[212:215]
    v_accvgpr_write_b32 a67, 0
    v_mfma_f32_16x16x32_bf16 v[220:223], a[196:199], a[216:219], v[220:223]
    s_waitcnt lgkmcnt(2)
    ds_read_b64_tr_b16 a[196:197], v49 offset:32776
    ds_read_b64_tr_b16 a[198:199], v49 offset:34824
    v_mfma_f32_16x16x32_bf16 v[64:67], a[184:187], a[220:223], v[64:67]
    v_accvgpr_write_b32 a68, 0
    v_mfma_f32_16x16x32_bf16 v[72:75], a[184:187], a[224:227], v[72:75]
    v_accvgpr_write_b32 a69, 0
    v_mfma_f32_16x16x32_bf16 v[80:83], a[184:187], a[228:231], v[80:83]
    s_add_u32 m0, s25, 139264
    v_mfma_f32_16x16x32_bf16 v[88:91], a[184:187], a[232:235], v[88:91]
    v_add_u32 v50, 0xfffe0000, v50
    v_mfma_f32_16x16x32_bf16 v[96:99], a[184:187], a[236:239], v[96:99]
    ds_read_b64_tr_b16 a[184:185], v50 offset:32768
    ds_read_b64_tr_b16 a[186:187], v50 offset:34816
    v_mfma_f32_16x16x32_bf16 v[68:71], a[188:191], a[220:223], v[68:71]
    buffer_load_dwordx4 v54, s[16:19], s85 offen offset:0 lds
    v_mfma_f32_16x16x32_bf16 v[76:79], a[188:191], a[224:227], v[76:79]
    buffer_load_dwordx4 v55, s[16:19], s85 offen offset:1024 lds
    v_mfma_f32_16x16x32_bf16 v[84:87], a[188:191], a[228:231], v[84:87]
    buffer_load_dwordx4 v56, s[16:19], s85 offen offset:2048 lds
    v_mfma_f32_16x16x32_bf16 v[92:95], a[188:191], a[232:235], v[92:95]
    buffer_load_dwordx4 v57, s[16:19], s85 offen offset:3072 lds
    v_mfma_f32_16x16x32_bf16 v[100:103], a[188:191], a[236:239], v[100:103]
    s_waitcnt lgkmcnt(2)
    ds_read_b64_tr_b16 a[188:189], v50 offset:32776
    ds_read_b64_tr_b16 a[190:191], v50 offset:34824
    v_mfma_f32_16x16x32_bf16 v[104:107], a[192:195], a[220:223], v[104:107]
    v_accvgpr_write_b32 a70, 0
    v_mfma_f32_16x16x32_bf16 v[112:115], a[192:195], a[224:227], v[112:115]
    v_accvgpr_write_b32 a71, 0
    v_mfma_f32_16x16x32_bf16 v[120:123], a[192:195], a[228:231], v[120:123]
    v_accvgpr_write_b32 a72, 0
    v_mfma_f32_16x16x32_bf16 v[128:131], a[192:195], a[232:235], v[128:131]
    v_add_u32 v51, 0xfffe0000, v51
    v_mfma_f32_16x16x32_bf16 v[136:139], a[192:195], a[236:239], v[136:139]
    ds_read_b64_tr_b16 a[192:193], v51 offset:32768
    ds_read_b64_tr_b16 a[194:195], v51 offset:34816
    v_mfma_f32_16x16x32_bf16 v[108:111], a[196:199], a[220:223], v[108:111]
    v_accvgpr_write_b32 a73, 0
    v_mfma_f32_16x16x32_bf16 v[116:119], a[196:199], a[224:227], v[116:119]
    v_accvgpr_write_b32 a74, 0
    v_mfma_f32_16x16x32_bf16 v[124:127], a[196:199], a[228:231], v[124:127]
    v_accvgpr_write_b32 a75, 0
    v_mfma_f32_16x16x32_bf16 v[132:135], a[196:199], a[232:235], v[132:135]
    v_accvgpr_write_b32 a76, 0
    v_mfma_f32_16x16x32_bf16 v[140:143], a[196:199], a[236:239], v[140:143]
    s_waitcnt lgkmcnt(2)
    ds_read_b64_tr_b16 a[196:197], v51 offset:32776
    ds_read_b64_tr_b16 a[198:199], v51 offset:34824
    v_mfma_f32_16x16x32_bf16 v[144:147], a[184:187], a[220:223], v[144:147]
    v_accvgpr_write_b32 a77, 0
    v_mfma_f32_16x16x32_bf16 v[152:155], a[184:187], a[224:227], v[152:155]
    v_accvgpr_write_b32 a78, 0
    v_mfma_f32_16x16x32_bf16 v[160:163], a[184:187], a[228:231], v[160:163]
    v_accvgpr_write_b32 a79, 0
    v_mfma_f32_16x16x32_bf16 v[168:171], a[184:187], a[232:235], v[168:171]
    v_accvgpr_write_b32 a80, 0
    v_mfma_f32_16x16x32_bf16 v[176:179], a[184:187], a[236:239], v[176:179]
    v_accvgpr_write_b32 a81, 0
    v_mfma_f32_16x16x32_bf16 v[148:151], a[188:191], a[220:223], v[148:151]
    v_accvgpr_write_b32 a82, 0
    v_mfma_f32_16x16x32_bf16 v[156:159], a[188:191], a[224:227], v[156:159]
    s_waitcnt lgkmcnt(0)
    s_waitcnt vmcnt(4)
    s_barrier
    v_mfma_f32_16x16x32_bf16 v[164:167], a[188:191], a[228:231], v[164:167]
    ds_read_b64_tr_b16 a[184:185], v48 offset:49152
    ds_read_b64_tr_b16 a[186:187], v48 offset:51200
    v_mfma_f32_16x16x32_bf16 v[172:175], a[188:191], a[232:235], v[172:175]
    ds_read_b128 a[200:203], v52 offset:0
    v_mfma_f32_16x16x32_bf16 v[180:183], a[188:191], a[236:239], v[180:183]
    ds_read_b64_tr_b16 a[188:189], v48 offset:49160
    ds_read_b64_tr_b16 a[190:191], v48 offset:51208
    v_mfma_f32_16x16x32_bf16 v[184:187], a[192:195], a[220:223], v[184:187]
    ds_read_b128 a[204:207], v52 offset:2048
    v_mfma_f32_16x16x32_bf16 v[192:195], a[192:195], a[224:227], v[192:195]
    ds_read_b128 a[208:211], v52 offset:4096
    v_mfma_f32_16x16x32_bf16 v[200:203], a[192:195], a[228:231], v[200:203]
    ds_read_b128 a[212:215], v52 offset:6144
    v_mfma_f32_16x16x32_bf16 v[208:211], a[192:195], a[232:235], v[208:211]
    ds_read_b128 a[216:219], v52 offset:8192
    v_mfma_f32_16x16x32_bf16 v[216:219], a[192:195], a[236:239], v[216:219]
    ds_read_b64_tr_b16 a[192:193], v49 offset:49152
    ds_read_b64_tr_b16 a[194:195], v49 offset:51200
    v_mfma_f32_16x16x32_bf16 v[188:191], a[196:199], a[220:223], v[188:191]
    s_add_u32 m0, s25, 32768
    v_mfma_f32_16x16x32_bf16 v[196:199], a[196:199], a[224:227], v[196:199]
    buffer_load_dwordx4 v54, s[16:19], s86 offen offset:0 lds
    v_mfma_f32_16x16x32_bf16 v[204:207], a[196:199], a[228:231], v[204:207]
    buffer_load_dwordx4 v55, s[16:19], s86 offen offset:1024 lds
    v_mfma_f32_16x16x32_bf16 v[212:215], a[196:199], a[232:235], v[212:215]
    buffer_load_dwordx4 v56, s[16:19], s86 offen offset:2048 lds
    v_mfma_f32_16x16x32_bf16 v[220:223], a[196:199], a[236:239], v[220:223]
    s_waitcnt lgkmcnt(2)
    ds_read_b64_tr_b16 a[196:197], v49 offset:49160
    ds_read_b64_tr_b16 a[198:199], v49 offset:51208
    v_mfma_f32_16x16x32_bf16 v[64:67], a[184:187], a[200:203], v[64:67]
    buffer_load_dwordx4 v57, s[16:19], s86 offen offset:3072 lds
    v_mfma_f32_16x16x32_bf16 v[72:75], a[184:187], a[204:207], v[72:75]
    s_lshr_b32 s39, s86, 12
    v_mfma_f32_16x16x32_bf16 v[80:83], a[184:187], a[208:211], v[80:83]
    s_add_u32 m0, s25, 118784
    v_mfma_f32_16x16x32_bf16 v[88:91], a[184:187], a[212:215], v[88:91]
    buffer_load_dwordx4 v58, s[12:15], s39 offen offset:0 lds
    v_mfma_f32_16x16x32_bf16 v[96:99], a[184:187], a[216:219], v[96:99]
    ds_read_b64_tr_b16 a[184:185], v50 offset:49152
    ds_read_b64_tr_b16 a[186:187], v50 offset:51200
    v_mfma_f32_16x16x32_bf16 v[68:71], a[188:191], a[200:203], v[68:71]
    buffer_load_dwordx4 v59, s[12:15], s39 offen offset:1024 lds
    v_mfma_f32_16x16x32_bf16 v[76:79], a[188:191], a[204:207], v[76:79]
    buffer_load_dwordx4 v60, s[12:15], s39 offen offset:2048 lds
    v_mfma_f32_16x16x32_bf16 v[84:87], a[188:191], a[208:211], v[84:87]
    buffer_load_dwordx4 v61, s[12:15], s39 offen offset:3072 lds
    v_mfma_f32_16x16x32_bf16 v[92:95], a[188:191], a[212:215], v[92:95]
    s_add_u32 m0, s35, 135168
    v_mfma_f32_16x16x32_bf16 v[100:103], a[188:191], a[216:219], v[100:103]
    s_waitcnt lgkmcnt(2)
    ds_read_b64_tr_b16 a[188:189], v50 offset:49160
    ds_read_b64_tr_b16 a[190:191], v50 offset:51208
    v_mfma_f32_16x16x32_bf16 v[104:107], a[192:195], a[200:203], v[104:107]
    buffer_load_dwordx4 v62, s[12:15], s39 offen lds
    v_mfma_f32_16x16x32_bf16 v[112:115], a[192:195], a[204:207], v[112:115]
    s_lshl_b32 s38, s59, 20
    v_mfma_f32_16x16x32_bf16 v[120:123], a[192:195], a[208:211], v[120:123]
    s_lshl_b32 s39, s3, 8
    v_mfma_f32_16x16x32_bf16 v[128:131], a[192:195], a[212:215], v[128:131]
    s_add_u32 s38, s38, s39
    v_mfma_f32_16x16x32_bf16 v[136:139], a[192:195], a[216:219], v[136:139]
    ds_read_b64_tr_b16 a[192:193], v51 offset:49152
    ds_read_b64_tr_b16 a[194:195], v51 offset:51200
    v_mfma_f32_16x16x32_bf16 v[108:111], a[196:199], a[200:203], v[108:111]
    s_add_u32 s92, s72, s38
    s_addc_u32 s93, s73, 0
    v_mfma_f32_16x16x32_bf16 v[116:119], a[196:199], a[204:207], v[116:119]
    s_sub_u32 s94, 4194304, s38
    v_mfma_f32_16x16x32_bf16 v[124:127], a[196:199], a[208:211], v[124:127]
    s_mov_b32 s95, 0x20000
    v_mfma_f32_16x16x32_bf16 v[132:135], a[196:199], a[212:215], v[132:135]
    s_lshl_b32 s38, s31, 2
    v_mfma_f32_16x16x32_bf16 v[140:143], a[196:199], a[216:219], v[140:143]
    s_waitcnt lgkmcnt(2)
    ds_read_b64_tr_b16 a[196:197], v51 offset:49160
    ds_read_b64_tr_b16 a[198:199], v51 offset:51208
    v_mfma_f32_16x16x32_bf16 v[144:147], a[184:187], a[200:203], v[144:147]
    s_add_u32 s38, s38, s24
    v_mfma_f32_16x16x32_bf16 v[152:155], a[184:187], a[204:207], v[152:155]
    s_lshl_b32 s38, s38, 15
    v_mfma_f32_16x16x32_bf16 v[160:163], a[184:187], a[208:211], v[160:163]
    v_lshrrev_b32 v4, 1, v26
    v_mfma_f32_16x16x32_bf16 v[168:171], a[184:187], a[212:215], v[168:171]
    v_and_b32 v5, 1, v26
    v_mfma_f32_16x16x32_bf16 v[176:179], a[184:187], a[216:219], v[176:179]
    v_lshlrev_b32 v5, 7, v5
    v_mfma_f32_16x16x32_bf16 v[148:151], a[188:191], a[200:203], v[148:151]
    v_lshl_add_u32 v4, v4, 10, v5
    buffer_load_dword v31, v4, s[92:95], s38 offen
    v_mfma_f32_16x16x32_bf16 v[156:159], a[188:191], a[204:207], v[156:159]
    s_waitcnt lgkmcnt(0)
    s_waitcnt vmcnt(10)
    s_barrier
    v_add_u32 v48, 0x20000, v48
    v_mfma_f32_16x16x32_bf16 v[164:167], a[188:191], a[208:211], v[164:167]
    ds_read_b64_tr_b16 a[184:185], v48 offset:8192
    ds_read_b64_tr_b16 a[186:187], v48 offset:10240
    v_mfma_f32_16x16x32_bf16 v[172:175], a[188:191], a[212:215], v[172:175]
    ds_read_b128 a[220:223], v53 offset:0
    v_mfma_f32_16x16x32_bf16 v[180:183], a[188:191], a[216:219], v[180:183]
    ds_read_b64_tr_b16 a[188:189], v48 offset:8200
    ds_read_b64_tr_b16 a[190:191], v48 offset:10248
    v_mfma_f32_16x16x32_bf16 v[184:187], a[192:195], a[200:203], v[184:187]
    ds_read_b128 a[224:227], v53 offset:2048
    v_mfma_f32_16x16x32_bf16 v[192:195], a[192:195], a[204:207], v[192:195]
    ds_read_b128 a[228:231], v53 offset:4096
    v_mfma_f32_16x16x32_bf16 v[200:203], a[192:195], a[208:211], v[200:203]
    ds_read_b128 a[232:235], v53 offset:6144
    v_mfma_f32_16x16x32_bf16 v[208:211], a[192:195], a[212:215], v[208:211]
    ds_read_b128 a[236:239], v53 offset:8192
    v_add_u32 v49, 0x20000, v49
    v_mfma_f32_16x16x32_bf16 v[216:219], a[192:195], a[216:219], v[216:219]
    ds_read_b64_tr_b16 a[192:193], v49 offset:8192
    ds_read_b64_tr_b16 a[194:195], v49 offset:10240
    v_mfma_f32_16x16x32_bf16 v[188:191], a[196:199], a[200:203], v[188:191]
    v_accvgpr_write_b32 a83, 0
    v_mfma_f32_16x16x32_bf16 v[196:199], a[196:199], a[204:207], v[196:199]
    v_accvgpr_write_b32 a84, 0
    v_mfma_f32_16x16x32_bf16 v[204:207], a[196:199], a[208:211], v[204:207]
    v_accvgpr_write_b32 a85, 0
    v_mfma_f32_16x16x32_bf16 v[212:215], a[196:199], a[212:215], v[212:215]
    v_accvgpr_write_b32 a86, 0
    v_mfma_f32_16x16x32_bf16 v[220:223], a[196:199], a[216:219], v[220:223]
    s_waitcnt lgkmcnt(2)
    ds_read_b64_tr_b16 a[196:197], v49 offset:8200
    ds_read_b64_tr_b16 a[198:199], v49 offset:10248
    v_mfma_f32_16x16x32_bf16 v[64:67], a[184:187], a[220:223], v[64:67]
    v_accvgpr_write_b32 a87, 0
    v_mfma_f32_16x16x32_bf16 v[72:75], a[184:187], a[224:227], v[72:75]
    v_accvgpr_write_b32 a88, 0
    v_mfma_f32_16x16x32_bf16 v[80:83], a[184:187], a[228:231], v[80:83]
    s_add_u32 m0, s25, 49152
    v_mfma_f32_16x16x32_bf16 v[88:91], a[184:187], a[232:235], v[88:91]
    v_add_u32 v50, 0x20000, v50
    v_mfma_f32_16x16x32_bf16 v[96:99], a[184:187], a[236:239], v[96:99]
    ds_read_b64_tr_b16 a[184:185], v50 offset:8192
    ds_read_b64_tr_b16 a[186:187], v50 offset:10240
    v_mfma_f32_16x16x32_bf16 v[68:71], a[188:191], a[220:223], v[68:71]
    buffer_load_dwordx4 v54, s[16:19], s87 offen offset:0 lds
    v_mfma_f32_16x16x32_bf16 v[76:79], a[188:191], a[224:227], v[76:79]
    buffer_load_dwordx4 v55, s[16:19], s87 offen offset:1024 lds
    v_mfma_f32_16x16x32_bf16 v[84:87], a[188:191], a[228:231], v[84:87]
    buffer_load_dwordx4 v56, s[16:19], s87 offen offset:2048 lds
    v_mfma_f32_16x16x32_bf16 v[92:95], a[188:191], a[232:235], v[92:95]
    buffer_load_dwordx4 v57, s[16:19], s87 offen offset:3072 lds
    v_mfma_f32_16x16x32_bf16 v[100:103], a[188:191], a[236:239], v[100:103]
    s_waitcnt lgkmcnt(2)
    ds_read_b64_tr_b16 a[188:189], v50 offset:8200
    ds_read_b64_tr_b16 a[190:191], v50 offset:10248
    v_mfma_f32_16x16x32_bf16 v[104:107], a[192:195], a[220:223], v[104:107]
    v_accvgpr_write_b32 a89, 0
    v_mfma_f32_16x16x32_bf16 v[112:115], a[192:195], a[224:227], v[112:115]
    v_accvgpr_write_b32 a90, 0
    v_mfma_f32_16x16x32_bf16 v[120:123], a[192:195], a[228:231], v[120:123]
    v_accvgpr_write_b32 a91, 0
    v_mfma_f32_16x16x32_bf16 v[128:131], a[192:195], a[232:235], v[128:131]
    v_add_u32 v51, 0x20000, v51
    v_mfma_f32_16x16x32_bf16 v[136:139], a[192:195], a[236:239], v[136:139]
    ds_read_b64_tr_b16 a[192:193], v51 offset:8192
    ds_read_b64_tr_b16 a[194:195], v51 offset:10240
    v_mfma_f32_16x16x32_bf16 v[108:111], a[196:199], a[220:223], v[108:111]
    v_accvgpr_write_b32 a92, 0
    v_mfma_f32_16x16x32_bf16 v[116:119], a[196:199], a[224:227], v[116:119]
    v_accvgpr_write_b32 a93, 0
    v_mfma_f32_16x16x32_bf16 v[124:127], a[196:199], a[228:231], v[124:127]
    v_accvgpr_write_b32 a94, 0
    v_mfma_f32_16x16x32_bf16 v[132:135], a[196:199], a[232:235], v[132:135]
    v_accvgpr_write_b32 a95, 0
    v_mfma_f32_16x16x32_bf16 v[140:143], a[196:199], a[236:239], v[140:143]
    s_waitcnt lgkmcnt(2)
    ds_read_b64_tr_b16 a[196:197], v51 offset:8200
    ds_read_b64_tr_b16 a[198:199], v51 offset:10248
    v_mfma_f32_16x16x32_bf16 v[144:147], a[184:187], a[220:223], v[144:147]
    v_accvgpr_write_b32 a96, 0
    v_mfma_f32_16x16x32_bf16 v[152:155], a[184:187], a[224:227], v[152:155]
    v_accvgpr_write_b32 a97, 0
    v_mfma_f32_16x16x32_bf16 v[160:163], a[184:187], a[228:231], v[160:163]
    v_accvgpr_write_b32 a98, 0
    v_mfma_f32_16x16x32_bf16 v[168:171], a[184:187], a[232:235], v[168:171]
    v_accvgpr_write_b32 a99, 0
    v_mfma_f32_16x16x32_bf16 v[176:179], a[184:187], a[236:239], v[176:179]
    v_accvgpr_write_b32 a100, 0
    v_mfma_f32_16x16x32_bf16 v[148:151], a[188:191], a[220:223], v[148:151]
    v_accvgpr_write_b32 a101, 0
    v_mfma_f32_16x16x32_bf16 v[156:159], a[188:191], a[224:227], v[156:159]
    s_waitcnt lgkmcnt(0)
    s_waitcnt vmcnt(5)
    s_barrier
    v_add_u32 v48, 0xfffe0000, v48
    v_mfma_f32_16x16x32_bf16 v[164:167], a[188:191], a[228:231], v[164:167]
    ds_read_b64_tr_b16 a[184:185], v48 offset:32768
    ds_read_b64_tr_b16 a[186:187], v48 offset:34816
    v_mfma_f32_16x16x32_bf16 v[172:175], a[188:191], a[232:235], v[172:175]
    ds_read_b128 a[200:203], v52 offset:20480
    v_mfma_f32_16x16x32_bf16 v[180:183], a[188:191], a[236:239], v[180:183]
    ds_read_b64_tr_b16 a[188:189], v48 offset:32776
    ds_read_b64_tr_b16 a[190:191], v48 offset:34824
    v_mfma_f32_16x16x32_bf16 v[184:187], a[192:195], a[220:223], v[184:187]
    ds_read_b128 a[204:207], v52 offset:22528
    s_add_u32 m0, s25, 139264
    v_mfma_f32_16x16x32_bf16 v[192:195], a[192:195], a[224:227], v[192:195]
    ds_read_b128 a[208:211], v52 offset:24576
    buffer_load_dwordx4 v54, s[16:19], s88 offen offset:0 lds
    v_mfma_f32_16x16x32_bf16 v[200:203], a[192:195], a[228:231], v[200:203]
    ds_read_b128 a[212:215], v52 offset:26624
    buffer_load_dwordx4 v55, s[16:19], s88 offen offset:1024 lds
    v_mfma_f32_16x16x32_bf16 v[208:211], a[192:195], a[232:235], v[208:211]
    ds_read_b128 a[216:219], v52 offset:28672
    v_add_u32 v49, 0xfffe0000, v49
    v_mfma_f32_16x16x32_bf16 v[216:219], a[192:195], a[236:239], v[216:219]
    ds_read_b64_tr_b16 a[192:193], v49 offset:32768
    ds_read_b64_tr_b16 a[194:195], v49 offset:34816
    v_mfma_f32_16x16x32_bf16 v[188:191], a[196:199], a[220:223], v[188:191]
    buffer_load_dwordx4 v56, s[16:19], s88 offen offset:2048 lds
    buffer_load_dwordx4 v57, s[16:19], s88 offen offset:3072 lds
    v_mfma_f32_16x16x32_bf16 v[196:199], a[196:199], a[224:227], v[196:199]
    s_lshr_b32 s39, s88, 12
    s_add_u32 m0, s25, 98304
    v_mfma_f32_16x16x32_bf16 v[204:207], a[196:199], a[228:231], v[204:207]
    buffer_load_dwordx4 v58, s[12:15], s39 offen offset:0 lds
    buffer_load_dwordx4 v59, s[12:15], s39 offen offset:1024 lds
    v_mfma_f32_16x16x32_bf16 v[212:215], a[196:199], a[232:235], v[212:215]
    buffer_load_dwordx4 v60, s[12:15], s39 offen offset:2048 lds
    buffer_load_dwordx4 v61, s[12:15], s39 offen offset:3072 lds
    v_mfma_f32_16x16x32_bf16 v[220:223], a[196:199], a[236:239], v[220:223]
    s_waitcnt lgkmcnt(2)
    ds_read_b64_tr_b16 a[196:197], v49 offset:32776
    ds_read_b64_tr_b16 a[198:199], v49 offset:34824
    v_mfma_f32_16x16x32_bf16 v[64:67], a[184:187], a[200:203], v[64:67]
    s_add_u32 m0, s35, 114688
    s_nop 0
    buffer_load_dwordx4 v62, s[12:15], s39 offen lds
    v_mfma_f32_16x16x32_bf16 v[72:75], a[184:187], a[204:207], v[72:75]
    s_add_u32 m0, s25, 0
    s_nop 0
    buffer_load_dwordx4 v20, s[4:7], s26 offen offset:0 nt lds
    v_mfma_f32_16x16x32_bf16 v[80:83], a[184:187], a[208:211], v[80:83]
    buffer_load_dwordx4 v21, s[4:7], s26 offen offset:1024 nt lds
    buffer_load_dwordx4 v22, s[4:7], s26 offen offset:2048 nt lds
    v_mfma_f32_16x16x32_bf16 v[88:91], a[184:187], a[212:215], v[88:91]
    v_add_u32 v50, 0xfffe0000, v50
    buffer_load_dwordx4 v23, s[4:7], s26 offen offset:3072 nt lds
    s_add_u32 s26, s26, 8192
    v_mfma_f32_16x16x32_bf16 v[96:99], a[184:187], a[216:219], v[96:99]
    ds_read_b64_tr_b16 a[184:185], v50 offset:32768
    ds_read_b64_tr_b16 a[186:187], v50 offset:34816
    v_mfma_f32_16x16x32_bf16 v[68:71], a[188:191], a[200:203], v[68:71]
    s_add_u32 m0, s25, 16384
    s_nop 0
    buffer_load_dwordx4 v20, s[4:7], s26 offen offset:0 nt lds
    v_mfma_f32_16x16x32_bf16 v[76:79], a[188:191], a[204:207], v[76:79]
    buffer_load_dwordx4 v21, s[4:7], s26 offen offset:1024 nt lds
    buffer_load_dwordx4 v22, s[4:7], s26 offen offset:2048 nt lds
    v_mfma_f32_16x16x32_bf16 v[84:87], a[188:191], a[208:211], v[84:87]
    buffer_load_dwordx4 v23, s[4:7], s26 offen offset:3072 nt lds
    s_add_u32 s26, s26, 8192
    v_mfma_f32_16x16x32_bf16 v[92:95], a[188:191], a[212:215], v[92:95]
    v_accvgpr_write_b32 a102, 0
    v_mfma_f32_16x16x32_bf16 v[100:103], a[188:191], a[216:219], v[100:103]
    s_waitcnt lgkmcnt(2)
    ds_read_b64_tr_b16 a[188:189], v50 offset:32776
    ds_read_b64_tr_b16 a[190:191], v50 offset:34824
    v_mfma_f32_16x16x32_bf16 v[104:107], a[192:195], a[200:203], v[104:107]
    v_accvgpr_write_b32 a103, 0
    v_mfma_f32_16x16x32_bf16 v[112:115], a[192:195], a[204:207], v[112:115]
    v_accvgpr_write_b32 a104, 0
    v_mfma_f32_16x16x32_bf16 v[120:123], a[192:195], a[208:211], v[120:123]
    v_accvgpr_write_b32 a105, 0
    v_mfma_f32_16x16x32_bf16 v[128:131], a[192:195], a[212:215], v[128:131]
    v_add_u32 v51, 0xfffe0000, v51
    v_mfma_f32_16x16x32_bf16 v[136:139], a[192:195], a[216:219], v[136:139]
    ds_read_b64_tr_b16 a[192:193], v51 offset:32768
    ds_read_b64_tr_b16 a[194:195], v51 offset:34816
    v_mfma_f32_16x16x32_bf16 v[108:111], a[196:199], a[200:203], v[108:111]
    v_accvgpr_write_b32 a106, 0
    v_mfma_f32_16x16x32_bf16 v[116:119], a[196:199], a[204:207], v[116:119]
    v_accvgpr_write_b32 a107, 0
    v_mfma_f32_16x16x32_bf16 v[124:127], a[196:199], a[208:211], v[124:127]
    v_accvgpr_write_b32 a108, 0
    v_mfma_f32_16x16x32_bf16 v[132:135], a[196:199], a[212:215], v[132:135]
    v_accvgpr_write_b32 a109, 0
    v_mfma_f32_16x16x32_bf16 v[140:143], a[196:199], a[216:219], v[140:143]
    s_waitcnt lgkmcnt(2)
    ds_read_b64_tr_b16 a[196:197], v51 offset:32776
    ds_read_b64_tr_b16 a[198:199], v51 offset:34824
    v_mfma_f32_16x16x32_bf16 v[144:147], a[184:187], a[200:203], v[144:147]
    v_accvgpr_write_b32 a110, 0
    v_mfma_f32_16x16x32_bf16 v[152:155], a[184:187], a[204:207], v[152:155]
    v_accvgpr_write_b32 a111, 0
    v_mfma_f32_16x16x32_bf16 v[160:163], a[184:187], a[208:211], v[160:163]
    v_accvgpr_write_b32 a112, 0
    v_mfma_f32_16x16x32_bf16 v[168:171], a[184:187], a[212:215], v[168:171]
    v_accvgpr_write_b32 a113, 0
    v_mfma_f32_16x16x32_bf16 v[176:179], a[184:187], a[216:219], v[176:179]
    v_accvgpr_write_b32 a114, 0
    v_mfma_f32_16x16x32_bf16 v[148:151], a[188:191], a[200:203], v[148:151]
    v_accvgpr_write_b32 a115, 0
    v_mfma_f32_16x16x32_bf16 v[156:159], a[188:191], a[204:207], v[156:159]
    s_waitcnt lgkmcnt(0)
    s_waitcnt vmcnt(17)
    s_barrier
    v_mfma_f32_16x16x32_bf16 v[164:167], a[188:191], a[208:211], v[164:167]
    ds_read_b64_tr_b16 a[184:185], v48 offset:49152
    ds_read_b64_tr_b16 a[186:187], v48 offset:51200
    v_mfma_f32_16x16x32_bf16 v[172:175], a[188:191], a[212:215], v[172:175]
    ds_read_b128 a[220:223], v53 offset:20480
    v_mfma_f32_16x16x32_bf16 v[180:183], a[188:191], a[216:219], v[180:183]
    ds_read_b64_tr_b16 a[188:189], v48 offset:49160
    ds_read_b64_tr_b16 a[190:191], v48 offset:51208
    v_mfma_f32_16x16x32_bf16 v[184:187], a[192:195], a[200:203], v[184:187]
    ds_read_b128 a[224:227], v53 offset:22528
    v_mfma_f32_16x16x32_bf16 v[192:195], a[192:195], a[204:207], v[192:195]
    ds_read_b128 a[228:231], v53 offset:24576
    v_mfma_f32_16x16x32_bf16 v[200:203], a[192:195], a[208:211], v[200:203]
    ds_read_b128 a[232:235], v53 offset:26624
    v_mfma_f32_16x16x32_bf16 v[208:211], a[192:195], a[212:215], v[208:211]
    ds_read_b128 a[236:239], v53 offset:28672
    v_mfma_f32_16x16x32_bf16 v[216:219], a[192:195], a[216:219], v[216:219]
    ds_read_b64_tr_b16 a[192:193], v49 offset:49152
    ds_read_b64_tr_b16 a[194:195], v49 offset:51200
    v_mfma_f32_16x16x32_bf16 v[188:191], a[196:199], a[200:203], v[188:191]
    v_accvgpr_write_b32 a116, 0
    v_mfma_f32_16x16x32_bf16 v[196:199], a[196:199], a[204:207], v[196:199]
    v_accvgpr_write_b32 a117, 0
    v_mfma_f32_16x16x32_bf16 v[204:207], a[196:199], a[208:211], v[204:207]
    v_accvgpr_write_b32 a118, 0
    v_mfma_f32_16x16x32_bf16 v[212:215], a[196:199], a[212:215], v[212:215]
    v_accvgpr_write_b32 a119, 0
    v_mfma_f32_16x16x32_bf16 v[220:223], a[196:199], a[216:219], v[220:223]
    s_waitcnt lgkmcnt(2)
    ds_read_b64_tr_b16 a[196:197], v49 offset:49160
    ds_read_b64_tr_b16 a[198:199], v49 offset:51208
    v_mfma_f32_16x16x32_bf16 v[64:67], a[184:187], a[220:223], v[64:67]
    v_accvgpr_write_b32 a120, 0
    v_mfma_f32_16x16x32_bf16 v[72:75], a[184:187], a[224:227], v[72:75]
    v_accvgpr_write_b32 a121, 0
    v_mfma_f32_16x16x32_bf16 v[80:83], a[184:187], a[228:231], v[80:83]
    v_accvgpr_write_b32 a122, 0
    v_mfma_f32_16x16x32_bf16 v[88:91], a[184:187], a[232:235], v[88:91]
    v_accvgpr_write_b32 a123, 0
    v_mfma_f32_16x16x32_bf16 v[96:99], a[184:187], a[236:239], v[96:99]
    ds_read_b64_tr_b16 a[184:185], v50 offset:49152
    ds_read_b64_tr_b16 a[186:187], v50 offset:51200
    v_mfma_f32_16x16x32_bf16 v[68:71], a[188:191], a[220:223], v[68:71]
    s_add_u32 m0, s25, 32768
    v_mfma_f32_16x16x32_bf16 v[76:79], a[188:191], a[224:227], v[76:79]
    buffer_load_dwordx4 v54, s[16:19], s89 offen offset:0 lds
    v_mfma_f32_16x16x32_bf16 v[84:87], a[188:191], a[228:231], v[84:87]
    buffer_load_dwordx4 v55, s[16:19], s89 offen offset:1024 lds
    v_mfma_f32_16x16x32_bf16 v[92:95], a[188:191], a[232:235], v[92:95]
    buffer_load_dwordx4 v56, s[16:19], s89 offen offset:2048 lds
    v_mfma_f32_16x16x32_bf16 v[100:103], a[188:191], a[236:239], v[100:103]
    s_waitcnt lgkmcnt(2)
    ds_read_b64_tr_b16 a[188:189], v50 offset:49160
    ds_read_b64_tr_b16 a[190:191], v50 offset:51208
    v_mfma_f32_16x16x32_bf16 v[104:107], a[192:195], a[220:223], v[104:107]
    v_accvgpr_write_b32 a124, 0
    v_mfma_f32_16x16x32_bf16 v[112:115], a[192:195], a[224:227], v[112:115]
    v_accvgpr_write_b32 a125, 0
    v_mfma_f32_16x16x32_bf16 v[120:123], a[192:195], a[228:231], v[120:123]
    v_accvgpr_write_b32 a126, 0
    v_mfma_f32_16x16x32_bf16 v[128:131], a[192:195], a[232:235], v[128:131]
    v_accvgpr_write_b32 a127, 0
    v_mfma_f32_16x16x32_bf16 v[136:139], a[192:195], a[236:239], v[136:139]
    ds_read_b64_tr_b16 a[192:193], v51 offset:49152
    ds_read_b64_tr_b16 a[194:195], v51 offset:51200
    v_mfma_f32_16x16x32_bf16 v[108:111], a[196:199], a[220:223], v[108:111]
    v_accvgpr_write_b32 a128, 0
    v_mfma_f32_16x16x32_bf16 v[116:119], a[196:199], a[224:227], v[116:119]
    v_accvgpr_write_b32 a129, 0
    v_mfma_f32_16x16x32_bf16 v[124:127], a[196:199], a[228:231], v[124:127]
    v_accvgpr_write_b32 a130, 0
    v_mfma_f32_16x16x32_bf16 v[132:135], a[196:199], a[232:235], v[132:135]
    v_accvgpr_write_b32 a131, 0
    v_mfma_f32_16x16x32_bf16 v[140:143], a[196:199], a[236:239], v[140:143]
    s_waitcnt lgkmcnt(2)
    ds_read_b64_tr_b16 a[196:197], v51 offset:49160
    ds_read_b64_tr_b16 a[198:199], v51 offset:51208
    v_mfma_f32_16x16x32_bf16 v[144:147], a[184:187], a[220:223], v[144:147]
    v_accvgpr_write_b32 a132, 0
    v_mfma_f32_16x16x32_bf16 v[152:155], a[184:187], a[224:227], v[152:155]
    v_accvgpr_write_b32 a133, 0
    v_mfma_f32_16x16x32_bf16 v[160:163], a[184:187], a[228:231], v[160:163]
    v_accvgpr_write_b32 a134, 0
    v_mfma_f32_16x16x32_bf16 v[168:171], a[184:187], a[232:235], v[168:171]
    v_accvgpr_write_b32 a135, 0
    v_mfma_f32_16x16x32_bf16 v[176:179], a[184:187], a[236:239], v[176:179]
    v_accvgpr_write_b32 a136, 0
    v_mfma_f32_16x16x32_bf16 v[148:151], a[188:191], a[220:223], v[148:151]
    buffer_load_dwordx4 v57, s[16:19], s89 offen offset:3072 lds
    v_mfma_f32_16x16x32_bf16 v[156:159], a[188:191], a[224:227], v[156:159]
    s_waitcnt lgkmcnt(0)
    s_waitcnt vmcnt(12)
    s_barrier
    v_add_u32 v48, 0x20000, v48
    v_mfma_f32_16x16x32_bf16 v[164:167], a[188:191], a[228:231], v[164:167]
    ds_read_b64_tr_b16 a[184:185], v48 offset:8192
    ds_read_b64_tr_b16 a[186:187], v48 offset:10240
    v_mfma_f32_16x16x32_bf16 v[172:175], a[188:191], a[232:235], v[172:175]
    ds_read_b128 a[200:203], v52 offset:0
    v_mfma_f32_16x16x32_bf16 v[180:183], a[188:191], a[236:239], v[180:183]
    ds_read_b64_tr_b16 a[188:189], v48 offset:8200
    ds_read_b64_tr_b16 a[190:191], v48 offset:10248
    v_mfma_f32_16x16x32_bf16 v[184:187], a[192:195], a[220:223], v[184:187]
    ds_read_b128 a[204:207], v52 offset:2048
    s_add_u32 m0, s25, 49152
    v_mfma_f32_16x16x32_bf16 v[192:195], a[192:195], a[224:227], v[192:195]
    ds_read_b128 a[208:211], v52 offset:4096
    buffer_load_dwordx4 v54, s[16:19], s90 offen offset:0 lds
    v_mfma_f32_16x16x32_bf16 v[200:203], a[192:195], a[228:231], v[200:203]
    ds_read_b128 a[212:215], v52 offset:6144
    buffer_load_dwordx4 v55, s[16:19], s90 offen offset:1024 lds
    v_mfma_f32_16x16x32_bf16 v[208:211], a[192:195], a[232:235], v[208:211]
    ds_read_b128 a[216:219], v52 offset:8192
    v_add_u32 v49, 0x20000, v49
    v_mfma_f32_16x16x32_bf16 v[216:219], a[192:195], a[236:239], v[216:219]
    ds_read_b64_tr_b16 a[192:193], v49 offset:8192
    ds_read_b64_tr_b16 a[194:195], v49 offset:10240
    v_mfma_f32_16x16x32_bf16 v[188:191], a[196:199], a[220:223], v[188:191]
    buffer_load_dwordx4 v56, s[16:19], s90 offen offset:2048 lds
    buffer_load_dwordx4 v57, s[16:19], s90 offen offset:3072 lds
    v_mfma_f32_16x16x32_bf16 v[196:199], a[196:199], a[224:227], v[196:199]
    s_lshr_b32 s39, s90, 12
    s_add_u32 m0, s25, 118784
    v_mfma_f32_16x16x32_bf16 v[204:207], a[196:199], a[228:231], v[204:207]
    buffer_load_dwordx4 v58, s[12:15], s39 offen offset:0 lds
    buffer_load_dwordx4 v59, s[12:15], s39 offen offset:1024 lds
    v_mfma_f32_16x16x32_bf16 v[212:215], a[196:199], a[232:235], v[212:215]
    buffer_load_dwordx4 v60, s[12:15], s39 offen offset:2048 lds
    buffer_load_dwordx4 v61, s[12:15], s39 offen offset:3072 lds
    v_mfma_f32_16x16x32_bf16 v[220:223], a[196:199], a[236:239], v[220:223]
    s_waitcnt lgkmcnt(2)
    ds_read_b64_tr_b16 a[196:197], v49 offset:8200
    ds_read_b64_tr_b16 a[198:199], v49 offset:10248
    v_mfma_f32_16x16x32_bf16 v[64:67], a[184:187], a[200:203], v[64:67]
    s_add_u32 m0, s35, 135168
    s_nop 0
    buffer_load_dwordx4 v62, s[12:15], s39 offen lds
    v_mfma_f32_16x16x32_bf16 v[72:75], a[184:187], a[204:207], v[72:75]
    s_add_u32 m0, s25, 65536
    s_nop 0
    buffer_load_dwordx4 v24, s[8:11], s27 offen offset:0 nt lds
    v_mfma_f32_16x16x32_bf16 v[80:83], a[184:187], a[208:211], v[80:83]
    buffer_load_dwordx4 v25, s[8:11], s27 offen offset:1024 nt lds
    buffer_load_dwordx4 v24, s[8:11], s27 offen offset:2048 nt lds
    v_mfma_f32_16x16x32_bf16 v[88:91], a[184:187], a[212:215], v[88:91]
    v_add_u32 v50, 0x20000, v50
    buffer_load_dwordx4 v25, s[8:11], s27 offen offset:3072 nt lds
    s_add_u32 s27, s27, 8192
    v_mfma_f32_16x16x32_bf16 v[96:99], a[184:187], a[216:219], v[96:99]
    ds_read_b64_tr_b16 a[184:185], v50 offset:8192
    ds_read_b64_tr_b16 a[186:187], v50 offset:10240
    v_mfma_f32_16x16x32_bf16 v[68:71], a[188:191], a[200:203], v[68:71]
    s_add_u32 m0, s25, 81920
    s_nop 0
    buffer_load_dwordx4 v24, s[8:11], s27 offen offset:0 nt lds
    v_mfma_f32_16x16x32_bf16 v[76:79], a[188:191], a[204:207], v[76:79]
    buffer_load_dwordx4 v25, s[8:11], s27 offen offset:1024 nt lds
    buffer_load_dwordx4 v24, s[8:11], s27 offen offset:2048 nt lds
    v_mfma_f32_16x16x32_bf16 v[84:87], a[188:191], a[208:211], v[84:87]
    buffer_load_dwordx4 v25, s[8:11], s27 offen offset:3072 nt lds
    s_add_u32 s27, s27, 8192
    v_mfma_f32_16x16x32_bf16 v[92:95], a[188:191], a[212:215], v[92:95]
    v_accvgpr_write_b32 a137, 0
    v_mfma_f32_16x16x32_bf16 v[100:103], a[188:191], a[216:219], v[100:103]
    s_waitcnt lgkmcnt(2)
    ds_read_b64_tr_b16 a[188:189], v50 offset:8200
    ds_read_b64_tr_b16 a[190:191], v50 offset:10248
    v_mfma_f32_16x16x32_bf16 v[104:107], a[192:195], a[200:203], v[104:107]
    v_accvgpr_write_b32 a138, 0
    v_mfma_f32_16x16x32_bf16 v[112:115], a[192:195], a[204:207], v[112:115]
    v_accvgpr_write_b32 a139, 0
    v_mfma_f32_16x16x32_bf16 v[120:123], a[192:195], a[208:211], v[120:123]
    v_accvgpr_write_b32 a140, 0
    v_mfma_f32_16x16x32_bf16 v[128:131], a[192:195], a[212:215], v[128:131]
    v_add_u32 v51, 0x20000, v51
    v_mfma_f32_16x16x32_bf16 v[136:139], a[192:195], a[216:219], v[136:139]
    ds_read_b64_tr_b16 a[192:193], v51 offset:8192
    ds_read_b64_tr_b16 a[194:195], v51 offset:10240
    v_mfma_f32_16x16x32_bf16 v[108:111], a[196:199], a[200:203], v[108:111]
    v_accvgpr_write_b32 a141, 0
    v_mfma_f32_16x16x32_bf16 v[116:119], a[196:199], a[204:207], v[116:119]
    v_accvgpr_write_b32 a142, 0
    v_mfma_f32_16x16x32_bf16 v[124:127], a[196:199], a[208:211], v[124:127]
    v_accvgpr_write_b32 a143, 0
    v_mfma_f32_16x16x32_bf16 v[132:135], a[196:199], a[212:215], v[132:135]
    v_accvgpr_write_b32 a144, 0
    v_mfma_f32_16x16x32_bf16 v[140:143], a[196:199], a[216:219], v[140:143]
    s_waitcnt lgkmcnt(2)
    ds_read_b64_tr_b16 a[196:197], v51 offset:8200
    ds_read_b64_tr_b16 a[198:199], v51 offset:10248
    v_mfma_f32_16x16x32_bf16 v[144:147], a[184:187], a[200:203], v[144:147]
    v_accvgpr_write_b32 a145, 0
    v_mfma_f32_16x16x32_bf16 v[152:155], a[184:187], a[204:207], v[152:155]
    v_accvgpr_write_b32 a146, 0
    v_mfma_f32_16x16x32_bf16 v[160:163], a[184:187], a[208:211], v[160:163]
    v_accvgpr_write_b32 a147, 0
    v_mfma_f32_16x16x32_bf16 v[168:171], a[184:187], a[212:215], v[168:171]
    v_accvgpr_write_b32 a148, 0
    v_mfma_f32_16x16x32_bf16 v[176:179], a[184:187], a[216:219], v[176:179]
    v_accvgpr_write_b32 a149, 0
    v_mfma_f32_16x16x32_bf16 v[148:151], a[188:191], a[200:203], v[148:151]
    v_accvgpr_write_b32 a150, 0
    v_mfma_f32_16x16x32_bf16 v[156:159], a[188:191], a[204:207], v[156:159]
    s_waitcnt lgkmcnt(0)
    s_waitcnt vmcnt(17)
    s_barrier
    v_add_u32 v48, 0xfffe0000, v48
    v_mfma_f32_16x16x32_bf16 v[164:167], a[188:191], a[208:211], v[164:167]
    ds_read_b64_tr_b16 a[184:185], v48 offset:32768
    ds_read_b64_tr_b16 a[186:187], v48 offset:34816
    v_mfma_f32_16x16x32_bf16 v[172:175], a[188:191], a[212:215], v[172:175]
    ds_read_b128 a[220:223], v53 offset:0
    v_mfma_f32_16x16x32_bf16 v[180:183], a[188:191], a[216:219], v[180:183]
    ds_read_b64_tr_b16 a[188:189], v48 offset:32776
    ds_read_b64_tr_b16 a[190:191], v48 offset:34824
    v_mfma_f32_16x16x32_bf16 v[184:187], a[192:195], a[200:203], v[184:187]
    ds_read_b128 a[224:227], v53 offset:2048
    v_mfma_f32_16x16x32_bf16 v[192:195], a[192:195], a[204:207], v[192:195]
    ds_read_b128 a[228:231], v53 offset:4096
    v_mfma_f32_16x16x32_bf16 v[200:203], a[192:195], a[208:211], v[200:203]
    ds_read_b128 a[232:235], v53 offset:6144
    v_mfma_f32_16x16x32_bf16 v[208:211], a[192:195], a[212:215], v[208:211]
    ds_read_b128 a[236:239], v53 offset:8192
    v_add_u32 v49, 0xfffe0000, v49
    v_mfma_f32_16x16x32_bf16 v[216:219], a[192:195], a[216:219], v[216:219]
    ds_read_b64_tr_b16 a[192:193], v49 offset:32768
    ds_read_b64_tr_b16 a[194:195], v49 offset:34816
    v_mfma_f32_16x16x32_bf16 v[188:191], a[196:199], a[200:203], v[188:191]
    v_accvgpr_write_b32 a151, 0
    v_mfma_f32_16x16x32_bf16 v[196:199], a[196:199], a[204:207], v[196:199]
    v_accvgpr_write_b32 a152, 0
    v_mfma_f32_16x16x32_bf16 v[204:207], a[196:199], a[208:211], v[204:207]
    v_accvgpr_write_b32 a153, 0
    v_mfma_f32_16x16x32_bf16 v[212:215], a[196:199], a[212:215], v[212:215]
    v_accvgpr_write_b32 a154, 0
    v_mfma_f32_16x16x32_bf16 v[220:223], a[196:199], a[216:219], v[220:223]
    s_waitcnt lgkmcnt(2)
    ds_read_b64_tr_b16 a[196:197], v49 offset:32776
    ds_read_b64_tr_b16 a[198:199], v49 offset:34824
    v_mfma_f32_16x16x32_bf16 v[64:67], a[184:187], a[220:223], v[64:67]
    v_accvgpr_write_b32 a155, 0
    v_mfma_f32_16x16x32_bf16 v[72:75], a[184:187], a[224:227], v[72:75]
    v_accvgpr_write_b32 a156, 0
    v_mfma_f32_16x16x32_bf16 v[80:83], a[184:187], a[228:231], v[80:83]
    s_add_u32 m0, s25, 139264
    v_mfma_f32_16x16x32_bf16 v[88:91], a[184:187], a[232:235], v[88:91]
    v_add_u32 v50, 0xfffe0000, v50
    v_mfma_f32_16x16x32_bf16 v[96:99], a[184:187], a[236:239], v[96:99]
    ds_read_b64_tr_b16 a[184:185], v50 offset:32768
    ds_read_b64_tr_b16 a[186:187], v50 offset:34816
    v_mfma_f32_16x16x32_bf16 v[68:71], a[188:191], a[220:223], v[68:71]
    buffer_load_dwordx4 v54, s[16:19], s91 offen offset:0 lds
    v_mfma_f32_16x16x32_bf16 v[76:79], a[188:191], a[224:227], v[76:79]
    buffer_load_dwordx4 v55, s[16:19], s91 offen offset:1024 lds
    v_mfma_f32_16x16x32_bf16 v[84:87], a[188:191], a[228:231], v[84:87]
    buffer_load_dwordx4 v56, s[16:19], s91 offen offset:2048 lds
    v_mfma_f32_16x16x32_bf16 v[92:95], a[188:191], a[232:235], v[92:95]
    buffer_load_dwordx4 v57, s[16:19], s91 offen offset:3072 lds
    v_mfma_f32_16x16x32_bf16 v[100:103], a[188:191], a[236:239], v[100:103]
    s_waitcnt lgkmcnt(2)
    ds_read_b64_tr_b16 a[188:189], v50 offset:32776
    ds_read_b64_tr_b16 a[190:191], v50 offset:34824
    v_mfma_f32_16x16x32_bf16 v[104:107], a[192:195], a[220:223], v[104:107]
    v_accvgpr_write_b32 a157, 0
    v_mfma_f32_16x16x32_bf16 v[112:115], a[192:195], a[224:227], v[112:115]
    v_accvgpr_write_b32 a158, 0
    v_mfma_f32_16x16x32_bf16 v[120:123], a[192:195], a[228:231], v[120:123]
    v_accvgpr_write_b32 a159, 0
    v_mfma_f32_16x16x32_bf16 v[128:131], a[192:195], a[232:235], v[128:131]
    v_add_u32 v51, 0xfffe0000, v51
    v_mfma_f32_16x16x32_bf16 v[136:139], a[192:195], a[236:239], v[136:139]
    ds_read_b64_tr_b16 a[192:193], v51 offset:32768
    ds_read_b64_tr_b16 a[194:195], v51 offset:34816
    v_mfma_f32_16x16x32_bf16 v[108:111], a[196:199], a[220:223], v[108:111]
    v_accvgpr_write_b32 a160, 0
    v_mfma_f32_16x16x32_bf16 v[116:119], a[196:199], a[224:227], v[116:119]
    v_accvgpr_write_b32 a161, 0
    v_mfma_f32_16x16x32_bf16 v[124:127], a[196:199], a[228:231], v[124:127]
    v_accvgpr_write_b32 a162, 0
    v_mfma_f32_16x16x32_bf16 v[132:135], a[196:199], a[232:235], v[132:135]
    v_accvgpr_write_b32 a163, 0
    v_mfma_f32_16x16x32_bf16 v[140:143], a[196:199], a[236:239], v[140:143]
    s_waitcnt lgkmcnt(2)
    ds_read_b64_tr_b16 a[196:197], v51 offset:32776
    ds_read_b64_tr_b16 a[198:199], v51 offset:34824
    v_mfma_f32_16x16x32_bf16 v[144:147], a[184:187], a[220:223], v[144:147]
    v_accvgpr_write_b32 a164, 0
    v_mfma_f32_16x16x32_bf16 v[152:155], a[184:187], a[224:227], v[152:155]
    v_accvgpr_write_b32 a165, 0
    v_mfma_f32_16x16x32_bf16 v[160:163], a[184:187], a[228:231], v[160:163]
    v_accvgpr_write_b32 a166, 0
    v_mfma_f32_16x16x32_bf16 v[168:171], a[184:187], a[232:235], v[168:171]
    v_accvgpr_write_b32 a167, 0
    v_mfma_f32_16x16x32_bf16 v[176:179], a[184:187], a[236:239], v[176:179]
    v_accvgpr_write_b32 a168, 0
    v_mfma_f32_16x16x32_bf16 v[148:151], a[188:191], a[220:223], v[148:151]
    v_accvgpr_write_b32 a169, 0
    v_mfma_f32_16x16x32_bf16 v[156:159], a[188:191], a[224:227], v[156:159]
    s_waitcnt lgkmcnt(0)
    s_waitcnt vmcnt(12)
    s_barrier
    v_mfma_f32_16x16x32_bf16 v[164:167], a[188:191], a[228:231], v[164:167]
    ds_read_b64_tr_b16 a[184:185], v48 offset:49152
    ds_read_b64_tr_b16 a[186:187], v48 offset:51200
    v_mfma_f32_16x16x32_bf16 v[172:175], a[188:191], a[232:235], v[172:175]
    ds_read_b128 a[200:203], v52 offset:20480
    v_mfma_f32_16x16x32_bf16 v[180:183], a[188:191], a[236:239], v[180:183]
    ds_read_b64_tr_b16 a[188:189], v48 offset:49160
    ds_read_b64_tr_b16 a[190:191], v48 offset:51208
    v_mfma_f32_16x16x32_bf16 v[184:187], a[192:195], a[220:223], v[184:187]
    ds_read_b128 a[204:207], v52 offset:22528
    v_mfma_f32_16x16x32_bf16 v[192:195], a[192:195], a[224:227], v[192:195]
    ds_read_b128 a[208:211], v52 offset:24576
    v_mfma_f32_16x16x32_bf16 v[200:203], a[192:195], a[228:231], v[200:203]
    ds_read_b128 a[212:215], v52 offset:26624
    v_mfma_f32_16x16x32_bf16 v[208:211], a[192:195], a[232:235], v[208:211]
    ds_read_b128 a[216:219], v52 offset:28672
    v_mfma_f32_16x16x32_bf16 v[216:219], a[192:195], a[236:239], v[216:219]
    ds_read_b64_tr_b16 a[192:193], v49 offset:49152
    ds_read_b64_tr_b16 a[194:195], v49 offset:51200
    v_mfma_f32_16x16x32_bf16 v[188:191], a[196:199], a[220:223], v[188:191]
    s_add_u32 m0, s25, 32768
    v_mfma_f32_16x16x32_bf16 v[196:199], a[196:199], a[224:227], v[196:199]
    buffer_load_dwordx4 v20, s[4:7], s26 offen offset:0 nt lds
    v_mfma_f32_16x16x32_bf16 v[204:207], a[196:199], a[228:231], v[204:207]
    buffer_load_dwordx4 v21, s[4:7], s26 offen offset:1024 nt lds
    v_mfma_f32_16x16x32_bf16 v[212:215], a[196:199], a[232:235], v[212:215]
    buffer_load_dwordx4 v22, s[4:7], s26 offen offset:2048 nt lds
    v_mfma_f32_16x16x32_bf16 v[220:223], a[196:199], a[236:239], v[220:223]
    s_waitcnt lgkmcnt(2)
    ds_read_b64_tr_b16 a[196:197], v49 offset:49160
    ds_read_b64_tr_b16 a[198:199], v49 offset:51208
    v_mfma_f32_16x16x32_bf16 v[64:67], a[184:187], a[200:203], v[64:67]
    buffer_load_dwordx4 v23, s[4:7], s26 offen offset:3072 nt lds
    v_mfma_f32_16x16x32_bf16 v[72:75], a[184:187], a[204:207], v[72:75]
    s_add_u32 s26, s26, 8192
    v_mfma_f32_16x16x32_bf16 v[80:83], a[184:187], a[208:211], v[80:83]
    s_add_u32 m0, s25, 98304
    v_mfma_f32_16x16x32_bf16 v[88:91], a[184:187], a[212:215], v[88:91]
    buffer_load_dwordx4 v24, s[8:11], s27 offen offset:0 nt lds
    v_mfma_f32_16x16x32_bf16 v[96:99], a[184:187], a[216:219], v[96:99]
    ds_read_b64_tr_b16 a[184:185], v50 offset:49152
    ds_read_b64_tr_b16 a[186:187], v50 offset:51200
    v_mfma_f32_16x16x32_bf16 v[68:71], a[188:191], a[200:203], v[68:71]
    buffer_load_dwordx4 v25, s[8:11], s27 offen offset:1024 nt lds
    buffer_load_dwordx4 v24, s[8:11], s27 offen offset:2048 nt lds
    v_mfma_f32_16x16x32_bf16 v[76:79], a[188:191], a[204:207], v[76:79]
    buffer_load_dwordx4 v25, s[8:11], s27 offen offset:3072 nt lds
    s_add_u32 s27, s27, 8192
    v_mfma_f32_16x16x32_bf16 v[84:87], a[188:191], a[208:211], v[84:87]
    v_accvgpr_write_b32 a170, 0
    v_mfma_f32_16x16x32_bf16 v[92:95], a[188:191], a[212:215], v[92:95]
    v_accvgpr_write_b32 a171, 0
    v_mfma_f32_16x16x32_bf16 v[100:103], a[188:191], a[216:219], v[100:103]
    s_waitcnt lgkmcnt(2)
    ds_read_b64_tr_b16 a[188:189], v50 offset:49160
    ds_read_b64_tr_b16 a[190:191], v50 offset:51208
    v_mfma_f32_16x16x32_bf16 v[104:107], a[192:195], a[200:203], v[104:107]
    v_accvgpr_write_b32 a172, 0
    v_mfma_f32_16x16x32_bf16 v[112:115], a[192:195], a[204:207], v[112:115]
    v_accvgpr_write_b32 a173, 0
    v_mfma_f32_16x16x32_bf16 v[120:123], a[192:195], a[208:211], v[120:123]
    v_accvgpr_write_b32 a174, 0
    v_mfma_f32_16x16x32_bf16 v[128:131], a[192:195], a[212:215], v[128:131]
    v_accvgpr_write_b32 a175, 0
    v_mfma_f32_16x16x32_bf16 v[136:139], a[192:195], a[216:219], v[136:139]
    ds_read_b64_tr_b16 a[192:193], v51 offset:49152
    ds_read_b64_tr_b16 a[194:195], v51 offset:51200
    v_mfma_f32_16x16x32_bf16 v[108:111], a[196:199], a[200:203], v[108:111]
    v_accvgpr_write_b32 a176, 0
    v_mfma_f32_16x16x32_bf16 v[116:119], a[196:199], a[204:207], v[116:119]
    v_accvgpr_write_b32 a177, 0
    v_mfma_f32_16x16x32_bf16 v[124:127], a[196:199], a[208:211], v[124:127]
    v_accvgpr_write_b32 a178, 0
    v_mfma_f32_16x16x32_bf16 v[132:135], a[196:199], a[212:215], v[132:135]
    v_accvgpr_write_b32 a179, 0
    v_mfma_f32_16x16x32_bf16 v[140:143], a[196:199], a[216:219], v[140:143]
    s_waitcnt lgkmcnt(2)
    ds_read_b64_tr_b16 a[196:197], v51 offset:49160
    ds_read_b64_tr_b16 a[198:199], v51 offset:51208
    v_mfma_f32_16x16x32_bf16 v[144:147], a[184:187], a[200:203], v[144:147]
    v_mfma_f32_16x16x32_bf16 v[152:155], a[184:187], a[204:207], v[152:155]
    v_mfma_f32_16x16x32_bf16 v[160:163], a[184:187], a[208:211], v[160:163]
    v_mfma_f32_16x16x32_bf16 v[168:171], a[184:187], a[212:215], v[168:171]
    v_mfma_f32_16x16x32_bf16 v[176:179], a[184:187], a[216:219], v[176:179]
    v_mfma_f32_16x16x32_bf16 v[148:151], a[188:191], a[200:203], v[148:151]
    v_mfma_f32_16x16x32_bf16 v[156:159], a[188:191], a[204:207], v[156:159]
    s_waitcnt lgkmcnt(0)
    s_waitcnt vmcnt(8)
    s_barrier
    v_add_u32 v48, 0x20000, v48
    v_mfma_f32_16x16x32_bf16 v[164:167], a[188:191], a[208:211], v[164:167]
    ds_read_b64_tr_b16 a[184:185], v48 offset:8192
    ds_read_b64_tr_b16 a[186:187], v48 offset:10240
    v_mfma_f32_16x16x32_bf16 v[172:175], a[188:191], a[212:215], v[172:175]
    ds_read_b128 a[220:223], v53 offset:20480
    v_mfma_f32_16x16x32_bf16 v[180:183], a[188:191], a[216:219], v[180:183]
    ds_read_b64_tr_b16 a[188:189], v48 offset:8200
    ds_read_b64_tr_b16 a[190:191], v48 offset:10248
    v_mfma_f32_16x16x32_bf16 v[184:187], a[192:195], a[200:203], v[184:187]
    ds_read_b128 a[224:227], v53 offset:22528
    v_mfma_f32_16x16x32_bf16 v[192:195], a[192:195], a[204:207], v[192:195]
    ds_read_b128 a[228:231], v53 offset:24576
    v_mfma_f32_16x16x32_bf16 v[200:203], a[192:195], a[208:211], v[200:203]
    ds_read_b128 a[232:235], v53 offset:26624
    v_mfma_f32_16x16x32_bf16 v[208:211], a[192:195], a[212:215], v[208:211]
    ds_read_b128 a[236:239], v53 offset:28672
    v_add_u32 v49, 0x20000, v49
    v_mfma_f32_16x16x32_bf16 v[216:219], a[192:195], a[216:219], v[216:219]
    ds_read_b64_tr_b16 a[192:193], v49 offset:8192
    ds_read_b64_tr_b16 a[194:195], v49 offset:10240
    v_mfma_f32_16x16x32_bf16 v[188:191], a[196:199], a[200:203], v[188:191]
    v_mfma_f32_16x16x32_bf16 v[196:199], a[196:199], a[204:207], v[196:199]
    v_mfma_f32_16x16x32_bf16 v[204:207], a[196:199], a[208:211], v[204:207]
    v_mfma_f32_16x16x32_bf16 v[212:215], a[196:199], a[212:215], v[212:215]
    s_add_u32 m0, s25, 49152
    v_mfma_f32_16x16x32_bf16 v[220:223], a[196:199], a[216:219], v[220:223]
    s_waitcnt lgkmcnt(2)
    ds_read_b64_tr_b16 a[196:197], v49 offset:8200
    ds_read_b64_tr_b16 a[198:199], v49 offset:10248
    v_mfma_f32_16x16x32_bf16 v[64:67], a[184:187], a[220:223], v[64:67]
    buffer_load_dwordx4 v20, s[4:7], s26 offen offset:0 nt lds
    v_mfma_f32_16x16x32_bf16 v[72:75], a[184:187], a[224:227], v[72:75]
    buffer_load_dwordx4 v21, s[4:7], s26 offen offset:1024 nt lds
    v_mfma_f32_16x16x32_bf16 v[80:83], a[184:187], a[228:231], v[80:83]
    buffer_load_dwordx4 v22, s[4:7], s26 offen offset:2048 nt lds
    v_mfma_f32_16x16x32_bf16 v[88:91], a[184:187], a[232:235], v[88:91]
    v_add_u32 v50, 0x20000, v50
    v_mfma_f32_16x16x32_bf16 v[96:99], a[184:187], a[236:239], v[96:99]
    ds_read_b64_tr_b16 a[184:185], v50 offset:8192
    ds_read_b64_tr_b16 a[186:187], v50 offset:10240
    v_mfma_f32_16x16x32_bf16 v[68:71], a[188:191], a[220:223], v[68:71]
    buffer_load_dwordx4 v23, s[4:7], s26 offen offset:3072 nt lds
    v_mfma_f32_16x16x32_bf16 v[76:79], a[188:191], a[224:227], v[76:79]
    s_add_u32 s26, s26, 8192
    v_mfma_f32_16x16x32_bf16 v[84:87], a[188:191], a[228:231], v[84:87]
    v_mfma_f32_16x16x32_bf16 v[92:95], a[188:191], a[232:235], v[92:95]
    v_mfma_f32_16x16x32_bf16 v[100:103], a[188:191], a[236:239], v[100:103]
    s_waitcnt lgkmcnt(2)
    ds_read_b64_tr_b16 a[188:189], v50 offset:8200
    ds_read_b64_tr_b16 a[190:191], v50 offset:10248
    v_mfma_f32_16x16x32_bf16 v[104:107], a[192:195], a[220:223], v[104:107]
    v_mfma_f32_16x16x32_bf16 v[112:115], a[192:195], a[224:227], v[112:115]
    v_mfma_f32_16x16x32_bf16 v[120:123], a[192:195], a[228:231], v[120:123]
    v_mfma_f32_16x16x32_bf16 v[128:131], a[192:195], a[232:235], v[128:131]
    v_add_u32 v51, 0x20000, v51
    v_mul_f32 v64, s36, v64
    v_mul_f32 v65, s36, v65
    v_mul_f32 v66, s36, v66
    v_mfma_f32_16x16x32_bf16 v[136:139], a[192:195], a[236:239], v[136:139]
    ds_read_b64_tr_b16 a[192:193], v51 offset:8192
    ds_read_b64_tr_b16 a[194:195], v51 offset:10240
    v_mul_f32 v67, s36, v67
    v_mul_f32 v68, s36, v68
    v_mul_f32 v69, s36, v69
    v_mfma_f32_16x16x32_bf16 v[108:111], a[196:199], a[220:223], v[108:111]
    v_mul_f32 v70, s36, v70
    v_mul_f32 v71, s36, v71
    v_cvt_pk_bf16_f32 v64, v64, v65
    v_cvt_pk_bf16_f32 v65, v66, v67
    v_cvt_pk_bf16_f32 v66, v68, v69
    v_mfma_f32_16x16x32_bf16 v[116:119], a[196:199], a[224:227], v[116:119]
    v_cvt_pk_bf16_f32 v67, v70, v71
    v_mul_f32 v72, s36, v72
    v_mul_f32 v73, s36, v73
    v_mul_f32 v74, s36, v74
    v_mul_f32 v75, s36, v75
    v_mfma_f32_16x16x32_bf16 v[124:127], a[196:199], a[228:231], v[124:127]
    v_mul_f32 v76, s36, v76
    v_mul_f32 v77, s36, v77
    v_mul_f32 v78, s36, v78
    v_mul_f32 v79, s36, v79
    v_mfma_f32_16x16x32_bf16 v[132:135], a[196:199], a[232:235], v[132:135]
    v_cvt_pk_bf16_f32 v72, v72, v73
    v_cvt_pk_bf16_f32 v73, v74, v75
    v_cvt_pk_bf16_f32 v74, v76, v77
    v_cvt_pk_bf16_f32 v75, v78, v79
    v_mfma_f32_16x16x32_bf16 v[140:143], a[196:199], a[236:239], v[140:143]
    s_waitcnt lgkmcnt(2)
    ds_read_b64_tr_b16 a[196:197], v51 offset:8200
    ds_read_b64_tr_b16 a[198:199], v51 offset:10248
    v_mul_f32 v80, s36, v80
    v_mul_f32 v81, s36, v81
    v_mfma_f32_16x16x32_bf16 v[144:147], a[184:187], a[220:223], v[144:147]
    v_mul_f32 v82, s36, v82
    v_mul_f32 v83, s36, v83
    v_mul_f32 v84, s36, v84
    v_mul_f32 v85, s36, v85
    v_mul_f32 v86, s36, v86
    v_mfma_f32_16x16x32_bf16 v[152:155], a[184:187], a[224:227], v[152:155]
    v_mul_f32 v87, s36, v87
    v_cvt_pk_bf16_f32 v80, v80, v81
    v_cvt_pk_bf16_f32 v81, v82, v83
    v_cvt_pk_bf16_f32 v82, v84, v85
    v_cvt_pk_bf16_f32 v83, v86, v87
    v_mfma_f32_16x16x32_bf16 v[160:163], a[184:187], a[228:231], v[160:163]
    v_mul_f32 v88, s36, v88
    v_mul_f32 v89, s36, v89
    v_mul_f32 v90, s36, v90
    v_mul_f32 v91, s36, v91
    v_mul_f32 v92, s36, v92
    v_mfma_f32_16x16x32_bf16 v[168:171], a[184:187], a[232:235], v[168:171]
    v_mul_f32 v93, s36, v93
    v_mul_f32 v94, s36, v94
    v_mul_f32 v95, s36, v95
    v_cvt_pk_bf16_f32 v88, v88, v89
    v_cvt_pk_bf16_f32 v89, v90, v91
    v_mfma_f32_16x16x32_bf16 v[176:179], a[184:187], a[236:239], v[176:179]
    ds_read_b128 v[32:35], v8 offset:0
    v_cvt_pk_bf16_f32 v90, v92, v93
    v_cvt_pk_bf16_f32 v91, v94, v95
    v_mul_f32 v96, s36, v96
    v_mul_f32 v97, s36, v97
    v_mfma_f32_16x16x32_bf16 v[148:151], a[188:191], a[220:223], v[148:151]
    v_mul_f32 v98, s36, v98
    v_mul_f32 v99, s36, v99
    v_mul_f32 v100, s36, v100
    v_mul_f32 v101, s36, v101
    v_mul_f32 v102, s36, v102
    v_mfma_f32_16x16x32_bf16 v[156:159], a[188:191], a[224:227], v[156:159]
    v_mul_f32 v103, s36, v103
    v_cvt_pk_bf16_f32 v96, v96, v97
    v_cvt_pk_bf16_f32 v97, v98, v99
    v_cvt_pk_bf16_f32 v98, v100, v101
    v_cvt_pk_bf16_f32 v99, v102, v103
    v_mfma_f32_16x16x32_bf16 v[164:167], a[188:191], a[228:231], v[164:167]
    v_mul_f32 v104, s36, v104
    v_mul_f32 v105, s36, v105
    v_mul_f32 v106, s36, v106
    v_mul_f32 v107, s36, v107
    v_mfma_f32_16x16x32_bf16 v[172:175], a[188:191], a[232:235], v[172:175]
    v_mul_f32 v108, s36, v108
    v_mul_f32 v109, s36, v109
    v_mul_f32 v110, s36, v110
    v_mul_f32 v111, s36, v111
    v_cvt_pk_bf16_f32 v104, v104, v105
    v_mfma_f32_16x16x32_bf16 v[180:183], a[188:191], a[236:239], v[180:183]
    s_waitcnt lgkmcnt(1)
    ds_read_b128 v[36:39], v8 offset:4096
    v_cvt_pk_bf16_f32 v105, v106, v107
    v_cvt_pk_bf16_f32 v106, v108, v109
    v_cvt_pk_bf16_f32 v107, v110, v111
    v_mfma_f32_16x16x32_bf16 v[184:187], a[192:195], a[220:223], v[184:187]
    v_mul_f32 v112, s36, v112
    v_mul_f32 v113, s36, v113
    v_mul_f32 v114, s36, v114
    v_mul_f32 v115, s36, v115
    v_mul_f32 v116, s36, v116
    v_mfma_f32_16x16x32_bf16 v[192:195], a[192:195], a[224:227], v[192:195]
    v_mul_f32 v117, s36, v117
    v_mul_f32 v118, s36, v118
    v_mul_f32 v119, s36, v119
    v_cvt_pk_bf16_f32 v112, v112, v113
    v_mfma_f32_16x16x32_bf16 v[200:203], a[192:195], a[228:231], v[200:203]
    v_cvt_pk_bf16_f32 v113, v114, v115
    v_cvt_pk_bf16_f32 v114, v116, v117
    v_cvt_pk_bf16_f32 v115, v118, v119
    v_mul_f32 v120, s36, v120
    v_mul_f32 v121, s36, v121
    v_mfma_f32_16x16x32_bf16 v[208:211], a[192:195], a[232:235], v[208:211]
    v_mul_f32 v122, s36, v122
    v_mul_f32 v123, s36, v123
    v_mul_f32 v124, s36, v124
    v_mul_f32 v125, s36, v125
    v_mul_f32 v126, s36, v126
    v_mfma_f32_16x16x32_bf16 v[216:219], a[192:195], a[236:239], v[216:219]
    ds_read_b128 v[40:43], v9 offset:0
    v_mul_f32 v127, s36, v127
    v_cvt_pk_bf16_f32 v120, v120, v121
    v_cvt_pk_bf16_f32 v121, v122, v123
    v_cvt_pk_bf16_f32 v122, v124, v125
    v_mfma_f32_16x16x32_bf16 v[188:191], a[196:199], a[220:223], v[188:191]
    v_cvt_pk_bf16_f32 v123, v126, v127
    v_mul_f32 v128, s36, v128
    v_mul_f32 v129, s36, v129
    v_mul_f32 v130, s36, v130
    v_mul_f32 v131, s36, v131
    v_mfma_f32_16x16x32_bf16 v[196:199], a[196:199], a[224:227], v[196:199]
    v_mul_f32 v132, s36, v132
    v_mul_f32 v133, s36, v133
    v_mul_f32 v134, s36, v134
    v_mul_f32 v135, s36, v135
    v_cvt_pk_bf16_f32 v128, v128, v129
    v_mfma_f32_16x16x32_bf16 v[204:207], a[196:199], a[228:231], v[204:207]
    v_cvt_pk_bf16_f32 v129, v130, v131
    v_cvt_pk_bf16_f32 v130, v132, v133
    v_cvt_pk_bf16_f32 v131, v134, v135
    v_mul_f32 v136, s36, v136
    v_mul_f32 v137, s36, v137
    v_mfma_f32_16x16x32_bf16 v[212:215], a[196:199], a[232:235], v[212:215]
    v_mul_f32 v138, s36, v138
    v_mul_f32 v139, s36, v139
    v_mul_f32 v140, s36, v140
    v_mul_f32 v141, s36, v141
    v_mul_f32 v142, s36, v142
    v_mfma_f32_16x16x32_bf16 v[220:223], a[196:199], a[236:239], v[220:223]
    v_mul_f32 v143, s36, v143
    v_cvt_pk_bf16_f32 v136, v136, v137
    v_cvt_pk_bf16_f32 v137, v138, v139
    v_cvt_pk_bf16_f32 v138, v140, v141
    v_cvt_pk_bf16_f32 v139, v142, v143
    ds_read_b128 v[44:47], v9 offset:4096
    v_mul_f32 v144, s36, v144
    v_mul_f32 v145, s36, v145
    s_waitcnt lgkmcnt(3)
    v_mfma_f32_16x16x32_bf16 v[68:71], v[32:35], v[64:67], 0
    v_mul_f32 v146, s36, v146
    v_mul_f32 v147, s36, v147
    v_mul_f32 v148, s36, v148
    v_mfma_f32_16x16x32_bf16 v[76:79], v[32:35], v[72:75], 0
    v_mul_f32 v149, s36, v149
    v_mul_f32 v150, s36, v150
    v_mul_f32 v151, s36, v151
    v_mfma_f32_16x16x32_bf16 v[84:87], v[32:35], v[80:83], 0
    v_cvt_pk_bf16_f32 v144, v144, v145
    v_cvt_pk_bf16_f32 v145, v146, v147
    v_cvt_pk_bf16_f32 v146, v148, v149
    v_mfma_f32_16x16x32_bf16 v[92:95], v[32:35], v[88:91], 0
    v_cvt_pk_bf16_f32 v147, v150, v151
    v_mul_f32 v152, s36, v152
    v_mul_f32 v153, s36, v153
    v_mul_f32 v154, s36, v154
    v_mfma_f32_16x16x32_bf16 v[100:103], v[32:35], v[96:99], 0
    ds_read_b128 v[32:35], v10 offset:0
    v_mul_f32 v155, s36, v155
    v_mul_f32 v156, s36, v156
    s_waitcnt lgkmcnt(3)
    v_mfma_f32_16x16x32_bf16 v[108:111], v[36:39], v[64:67], 0
    v_mul_f32 v157, s36, v157
    v_mul_f32 v158, s36, v158
    v_mul_f32 v159, s36, v159
    v_cvt_pk_bf16_f32 v152, v152, v153
    v_mfma_f32_16x16x32_bf16 v[116:119], v[36:39], v[72:75], 0
    v_cvt_pk_bf16_f32 v153, v154, v155
    v_cvt_pk_bf16_f32 v154, v156, v157
    v_cvt_pk_bf16_f32 v155, v158, v159
    v_mul_f32 v160, s36, v160
    v_mfma_f32_16x16x32_bf16 v[124:127], v[36:39], v[80:83], 0
    v_mul_f32 v161, s36, v161
    v_mul_f32 v162, s36, v162
    v_mul_f32 v163, s36, v163
    v_mfma_f32_16x16x32_bf16 v[132:135], v[36:39], v[88:91], 0
    v_mul_f32 v164, s36, v164
    v_mul_f32 v165, s36, v165
    v_mul_f32 v166, s36, v166
    v_mfma_f32_16x16x32_bf16 v[140:143], v[36:39], v[96:99], 0
    ds_read_b128 v[36:39], v10 offset:4096
    v_mul_f32 v167, s36, v167
    v_cvt_pk_bf16_f32 v160, v160, v161
    s_waitcnt lgkmcnt(3)
    v_mfma_f32_16x16x32_bf16 v[68:71], v[40:43], v[104:107], v[68:71]
    v_cvt_pk_bf16_f32 v161, v162, v163
    v_cvt_pk_bf16_f32 v162, v164, v165
    v_cvt_pk_bf16_f32 v163, v166, v167
    v_mfma_f32_16x16x32_bf16 v[76:79], v[40:43], v[112:115], v[76:79]
    v_mul_f32 v168, s36, v168
    v_mul_f32 v169, s36, v169
    v_mul_f32 v170, s36, v170
    v_mfma_f32_16x16x32_bf16 v[84:87], v[40:43], v[120:123], v[84:87]
    v_mul_f32 v171, s36, v171
    v_mul_f32 v172, s36, v172
    v_mul_f32 v173, s36, v173
    v_mfma_f32_16x16x32_bf16 v[92:95], v[40:43], v[128:131], v[92:95]
    v_mul_f32 v174, s36, v174
    v_mul_f32 v175, s36, v175
    v_cvt_pk_bf16_f32 v168, v168, v169
    v_cvt_pk_bf16_f32 v169, v170, v171
    v_mfma_f32_16x16x32_bf16 v[100:103], v[40:43], v[136:139], v[100:103]
    ds_read_b128 v[40:43], v11 offset:0
    v_cvt_pk_bf16_f32 v170, v172, v173
    v_cvt_pk_bf16_f32 v171, v174, v175
    s_waitcnt lgkmcnt(3)
    v_mfma_f32_16x16x32_bf16 v[108:111], v[44:47], v[104:107], v[108:111]
    v_mul_f32 v176, s36, v176
    v_mul_f32 v177, s36, v177
    v_mul_f32 v178, s36, v178
    v_mul_f32 v179, s36, v179
    v_mfma_f32_16x16x32_bf16 v[116:119], v[44:47], v[112:115], v[116:119]
    v_mul_f32 v180, s36, v180
    v_mul_f32 v181, s36, v181
    v_mul_f32 v182, s36, v182
    v_mul_f32 v183, s36, v183
    v_mfma_f32_16x16x32_bf16 v[124:127], v[44:47], v[120:123], v[124:127]
    v_cvt_pk_bf16_f32 v176, v176, v177
    v_cvt_pk_bf16_f32 v177, v178, v179
    v_cvt_pk_bf16_f32 v178, v180, v181
    v_cvt_pk_bf16_f32 v179, v182, v183
    v_mfma_f32_16x16x32_bf16 v[132:135], v[44:47], v[128:131], v[132:135]
    v_mul_f32 v184, s36, v184
    v_mul_f32 v185, s36, v185
    v_mul_f32 v186, s36, v186
    v_mul_f32 v187, s36, v187
    v_mul_f32 v188, s36, v188
    v_mul_f32 v189, s36, v189
    v_mfma_f32_16x16x32_bf16 v[140:143], v[44:47], v[136:139], v[140:143]
    ds_read_b128 v[44:47], v11 offset:4096
    v_mul_f32 v190, s36, v190
    v_mul_f32 v191, s36, v191
    v_cvt_pk_bf16_f32 v184, v184, v185
    v_cvt_pk_bf16_f32 v185, v186, v187
    v_cvt_pk_bf16_f32 v186, v188, v189
    s_waitcnt lgkmcnt(3)
    v_mfma_f32_16x16x32_bf16 v[68:71], v[32:35], v[144:147], v[68:71]
    v_cvt_pk_bf16_f32 v187, v190, v191
    v_mul_f32 v192, s36, v192
    v_mul_f32 v193, s36, v193
    v_mul_f32 v194, s36, v194
    v_mul_f32 v195, s36, v195
    v_mul_f32 v196, s36, v196
    v_mfma_f32_16x16x32_bf16 v[76:79], v[32:35], v[152:155], v[76:79]
    v_mul_f32 v197, s36, v197
    v_mul_f32 v198, s36, v198
    v_mul_f32 v199, s36, v199
    v_cvt_pk_bf16_f32 v192, v192, v193
    v_cvt_pk_bf16_f32 v193, v194, v195
    v_cvt_pk_bf16_f32 v194, v196, v197
    v_mfma_f32_16x16x32_bf16 v[84:87], v[32:35], v[160:163], v[84:87]
    v_cvt_pk_bf16_f32 v195, v198, v199
    v_mul_f32 v200, s36, v200
    v_mul_f32 v201, s36, v201
    v_mul_f32 v202, s36, v202
    v_mul_f32 v203, s36, v203
    v_mul_f32 v204, s36, v204
    v_mfma_f32_16x16x32_bf16 v[92:95], v[32:35], v[168:171], v[92:95]
    v_mul_f32 v205, s36, v205
    v_mul_f32 v206, s36, v206
    v_mul_f32 v207, s36, v207
    v_cvt_pk_bf16_f32 v200, v200, v201
    v_cvt_pk_bf16_f32 v201, v202, v203
    v_cvt_pk_bf16_f32 v202, v204, v205
    v_mfma_f32_16x16x32_bf16 v[100:103], v[32:35], v[176:179], v[100:103]
    v_cvt_pk_bf16_f32 v203, v206, v207
    v_mul_f32 v208, s36, v208
    v_mul_f32 v209, s36, v209
    v_mul_f32 v210, s36, v210
    v_mul_f32 v211, s36, v211
    v_mul_f32 v212, s36, v212
    s_waitcnt lgkmcnt(2)
    v_mfma_f32_16x16x32_bf16 v[108:111], v[36:39], v[144:147], v[108:111]
    v_mul_f32 v213, s36, v213
    v_mul_f32 v214, s36, v214
    v_mul_f32 v215, s36, v215
    v_cvt_pk_bf16_f32 v208, v208, v209
    v_cvt_pk_bf16_f32 v209, v210, v211
    v_cvt_pk_bf16_f32 v210, v212, v213
    v_mfma_f32_16x16x32_bf16 v[116:119], v[36:39], v[152:155], v[116:119]
    v_cvt_pk_bf16_f32 v211, v214, v215
    v_mul_f32 v216, s36, v216
    v_mul_f32 v217, s36, v217
    v_mul_f32 v218, s36, v218
    v_mul_f32 v219, s36, v219
    v_mul_f32 v220, s36, v220
    v_mfma_f32_16x16x32_bf16 v[124:127], v[36:39], v[160:163], v[124:127]
    v_mul_f32 v221, s36, v221
    v_mul_f32 v222, s36, v222
    v_mul_f32 v223, s36, v223
    v_cvt_pk_bf16_f32 v216, v216, v217
    v_cvt_pk_bf16_f32 v217, v218, v219
    v_cvt_pk_bf16_f32 v218, v220, v221
    v_cvt_pk_bf16_f32 v219, v222, v223
    v_mfma_f32_16x16x32_bf16 v[132:135], v[36:39], v[168:171], v[132:135]
    v_mfma_f32_16x16x32_bf16 v[140:143], v[36:39], v[176:179], v[140:143]
    s_waitcnt lgkmcnt(1)
    v_mfma_f32_16x16x32_bf16 v[68:71], v[40:43], v[184:187], v[68:71]
    v_mfma_f32_16x16x32_bf16 v[76:79], v[40:43], v[192:195], v[76:79]
    v_mfma_f32_16x16x32_bf16 v[84:87], v[40:43], v[200:203], v[84:87]
    v_mfma_f32_16x16x32_bf16 v[92:95], v[40:43], v[208:211], v[92:95]
    v_mfma_f32_16x16x32_bf16 v[100:103], v[40:43], v[216:219], v[100:103]
    s_waitcnt lgkmcnt(0)
    v_mfma_f32_16x16x32_bf16 v[108:111], v[44:47], v[184:187], v[108:111]
    v_mfma_f32_16x16x32_bf16 v[116:119], v[44:47], v[192:195], v[116:119]
    v_mfma_f32_16x16x32_bf16 v[124:127], v[44:47], v[200:203], v[124:127]
    v_mfma_f32_16x16x32_bf16 v[132:135], v[44:47], v[208:211], v[132:135]
    v_mfma_f32_16x16x32_bf16 v[140:143], v[44:47], v[216:219], v[140:143]
L_start:
    s_barrier
    ds_read_b128 a[184:187], v8 offset:16384
    ds_read_b128 a[188:191], v9 offset:16384
    ds_read_b128 a[192:195], v10 offset:16384
    ds_read_b128 a[196:199], v11 offset:16384
    s_cmp_lg_u32 s29, 0
    s_cbranch_scc1 L_nomax
    v_max3_f32 v48, v68, v69, v70
    v_max3_f32 v49, v108, v109, v110
    v_max3_f32 v48, v48, v71, v111
    v_max_f32 v48, v48, v49
    v_max3_f32 v50, v76, v77, v78
    v_max3_f32 v51, v116, v117, v118
    v_max3_f32 v50, v50, v79, v119
    v_max_f32 v50, v50, v51
    v_max3_f32 v52, v84, v85, v86
    v_max3_f32 v53, v124, v125, v126
    v_max3_f32 v52, v52, v87, v127
    v_max_f32 v52, v52, v53
    v_max3_f32 v54, v92, v93, v94
    v_max3_f32 v55, v132, v133, v134
    v_max3_f32 v54, v54, v95, v135
    v_max_f32 v54, v54, v55
    v_max3_f32 v56, v100, v101, v102
    v_max3_f32 v57, v140, v141, v142
    v_max3_f32 v56, v56, v103, v143
    v_max_f32 v56, v56, v57
    v_mov_b32 v49, v48
    v_mov_b32 v51, v50
    v_mov_b32 v53, v52
    v_mov_b32 v55, v54
    v_mov_b32 v57, v56
    v_permlane16_swap_b32 v48, v49
    v_permlane16_swap_b32 v50, v51
    v_permlane16_swap_b32 v52, v53
    v_permlane16_swap_b32 v54, v55
    v_permlane16_swap_b32 v56, v57
    v_max_f32 v48, v48, v49
    v_max_f32 v50, v50, v51
    v_max_f32 v52, v52, v53
    v_max_f32 v54, v54, v55
    v_max_f32 v56, v56, v57
    v_mov_b32 v49, v48
    v_mov_b32 v51, v50
    v_mov_b32 v53, v52
    v_mov_b32 v55, v54
    v_mov_b32 v57, v56
    v_permlane32_swap_b32 v48, v49
    v_permlane32_swap_b32 v50, v51
    v_permlane32_swap_b32 v52, v53
    v_permlane32_swap_b32 v54, v55
    v_permlane32_swap_b32 v56, v57
    v_max_f32 v48, v48, v49
    v_max_f32 v50, v50, v51
    v_max_f32 v52, v52, v53
    v_max_f32 v54, v54, v55
    v_max_f32 v56, v56, v57
    v_sub_f32 v224, 0, v48
    v_sub_f32 v225, 0, v48
    v_sub_f32 v226, 0, v48
    v_sub_f32 v227, 0, v48
    v_sub_f32 v228, 0, v50
    v_sub_f32 v229, 0, v50
    v_sub_f32 v230, 0, v50
    v_sub_f32 v231, 0, v50
    v_sub_f32 v232, 0, v52
    v_sub_f32 v233, 0, v52
    v_sub_f32 v234, 0, v52
    v_sub_f32 v235, 0, v52
    v_sub_f32 v236, 0, v54
    v_sub_f32 v237, 0, v54
    v_sub_f32 v238, 0, v54
    v_sub_f32 v239, 0, v54
    v_sub_f32 v240, 0, v56
    v_sub_f32 v241, 0, v56
    v_sub_f32 v242, 0, v56
    v_sub_f32 v243, 0, v56
L_nomax:
    v_add_f32 v68, v68, v224
    v_add_f32 v69, v69, v224
    v_add_f32 v70, v70, v224
    v_add_f32 v71, v71, v224
    v_add_f32 v76, v76, v228
    v_add_f32 v77, v77, v228
    v_add_f32 v78, v78, v228
    v_add_f32 v79, v79, v228
    v_add_f32 v84, v84, v232
    v_add_f32 v85, v85, v232
    v_add_f32 v86, v86, v232
    v_add_f32 v87, v87, v232
    v_add_f32 v92, v92, v236
    v_add_f32 v93, v93, v236
    v_add_f32 v94, v94, v236
    v_add_f32 v95, v95, v236
    v_add_f32 v100, v100, v240
    v_add_f32 v101, v101, v240
    v_add_f32 v102, v102, v240
    v_add_f32 v103, v103, v240
    v_add_f32 v108, v108, v224
    v_add_f32 v109, v109, v224
    v_add_f32 v110, v110, v224
    v_add_f32 v111, v111, v224
    v_add_f32 v116, v116, v228
    v_add_f32 v117, v117, v228
    v_add_f32 v118, v118, v228
    v_add_f32 v119, v119, v228
    v_add_f32 v124, v124, v232
    v_add_f32 v125, v125, v232
    v_add_f32 v126, v126, v232
    v_add_f32 v127, v127, v232
    v_add_f32 v132, v132, v236
    v_add_f32 v133, v133, v236
    v_add_f32 v134, v134, v236
    v_add_f32 v135, v135, v236
    v_add_f32 v140, v140, v240
    v_add_f32 v141, v141, v240
    v_add_f32 v142, v142, v240
    v_add_f32 v143, v143, v240
    v_exp_f32 v68, v68
    v_exp_f32 v69, v69
    v_exp_f32 v70, v70
    v_cvt_pk_bf16_f32 v148, v68, v69
    v_exp_f32 v71, v71
    v_exp_f32 v76, v76
    v_cvt_pk_bf16_f32 v149, v70, v71
    v_exp_f32 v77, v77
    v_exp_f32 v78, v78
    v_cvt_pk_bf16_f32 v156, v76, v77
    v_exp_f32 v79, v79
    v_exp_f32 v84, v84
    v_cvt_pk_bf16_f32 v157, v78, v79
    v_exp_f32 v85, v85
    v_exp_f32 v86, v86
    v_cvt_pk_bf16_f32 v164, v84, v85
    v_exp_f32 v87, v87
    v_exp_f32 v92, v92
    v_cvt_pk_bf16_f32 v165, v86, v87
    v_exp_f32 v93, v93
    v_exp_f32 v94, v94
    v_cvt_pk_bf16_f32 v172, v92, v93
    v_exp_f32 v95, v95
    v_exp_f32 v100, v100
    v_cvt_pk_bf16_f32 v173, v94, v95
    v_exp_f32 v101, v101
    v_exp_f32 v102, v102
    v_cvt_pk_bf16_f32 v180, v100, v101
    v_exp_f32 v103, v103
    v_exp_f32 v108, v108
    v_cvt_pk_bf16_f32 v181, v102, v103
    v_exp_f32 v109, v109
    v_exp_f32 v110, v110
    v_cvt_pk_bf16_f32 v150, v108, v109
    v_exp_f32 v111, v111
    v_exp_f32 v116, v116
    v_cvt_pk_bf16_f32 v151, v110, v111
    v_exp_f32 v117, v117
    v_exp_f32 v118, v118
    v_cvt_pk_bf16_f32 v158, v116, v117
    v_exp_f32 v119, v119
    v_exp_f32 v124, v124
    v_cvt_pk_bf16_f32 v159, v118, v119
    v_exp_f32 v125, v125
    v_exp_f32 v126, v126
    v_cvt_pk_bf16_f32 v166, v124, v125
    v_exp_f32 v127, v127
    v_exp_f32 v132, v132
    v_cvt_pk_bf16_f32 v167, v126, v127
    v_exp_f32 v133, v133
    v_exp_f32 v134, v134
    v_cvt_pk_bf16_f32 v174, v132, v133
    v_exp_f32 v135, v135
    v_exp_f32 v140, v140
    v_cvt_pk_bf16_f32 v175, v134, v135
    v_exp_f32 v141, v141
    v_exp_f32 v142, v142
    s_lshl_b32 s38, s59, 20
    s_lshl_b32 s39, s3, 8
    s_add_u32 s38, s38, s39
    s_add_u32 s12, s72, s38
    s_addc_u32 s13, s73, 0
    s_sub_u32 s14, 4194304, s38
    s_mov_b32 s15, 0x20000
    s_waitcnt lgkmcnt(0)
    s_mov_b32 s28, 7
    s_mov_b64 vcc, 0
    s_cmp_lt_u32 s3, 2
    s_cselect_b32 s37, 6, 1
L_loop:
    v_mfma_f32_16x16x32_bf16 v[68:71], a[184:187], v[64:67], v[224:227]
    ds_read_b128 a[200:203], v8 offset:20480
    v_mfma_f32_16x16x32_bf16 v[68:71], a[188:191], v[104:107], v[68:71]
    s_waitcnt vmcnt(4)
    s_add_u32 m0, s25, 0
    v_mfma_f32_16x16x32_bf16 v[68:71], a[192:195], v[144:147], v[68:71]
    buffer_load_dwordx4 v20, s[4:7], s26 offen offset:0 nt lds
    v_mfma_f32_16x16x32_bf16 v[68:71], a[196:199], v[184:187], v[68:71]
    ds_read_b128 a[204:207], v9 offset:20480
    v_mfma_f32_16x16x32_bf16 v[76:79], a[184:187], v[72:75], v[228:231]
    v_cvt_pk_bf16_f32 v182, v140, v141
    v_mfma_f32_16x16x32_bf16 v[76:79], a[188:191], v[112:115], v[76:79]
    v_exp_f32 v143, v143
    v_mfma_f32_16x16x32_bf16 v[76:79], a[192:195], v[152:155], v[76:79]
    ds_read_b128 a[208:211], v10 offset:20480
    v_cvt_pk_bf16_f32 v183, v142, v143
    v_mfma_f32_16x16x32_bf16 v[76:79], a[196:199], v[192:195], v[76:79]
    v_exp_f32 v68, v68
    v_mfma_f32_16x16x32_bf16 v[84:87], a[184:187], v[80:83], v[232:235]
    v_exp_f32 v69, v69
    v_mfma_f32_16x16x32_bf16 v[84:87], a[188:191], v[120:123], v[84:87]
    ds_read_b128 a[212:215], v11 offset:20480
    v_mfma_f32_16x16x32_bf16 v[84:87], a[192:195], v[160:163], v[84:87]
    v_exp_f32 v70, v70
    v_mfma_f32_16x16x32_bf16 v[84:87], a[196:199], v[200:203], v[84:87]
    s_cbranch_vccnz L_t0_1
    s_waitcnt vmcnt(4)
L_t0_1:
    v_mfma_f32_16x16x32_bf16 v[92:95], a[184:187], v[88:91], v[236:239]
    buffer_load_dwordx4 v21, s[4:7], s26 offen offset:1024 nt lds
    v_mfma_f32_16x16x32_bf16 v[92:95], a[188:191], v[128:131], v[92:95]
    v_cvt_pk_bf16_f32 v188, v68, v69
    v_mfma_f32_16x16x32_bf16 v[92:95], a[192:195], v[168:171], v[92:95]
    v_exp_f32 v71, v71
    v_mfma_f32_16x16x32_bf16 v[92:95], a[196:199], v[208:211], v[92:95]
    v_exp_f32 v76, v76
    v_mfma_f32_16x16x32_bf16 v[100:103], a[184:187], v[96:99], v[240:243]
    v_cvt_pk_bf16_f32 v189, v70, v71
    v_mfma_f32_16x16x32_bf16 v[100:103], a[188:191], v[136:139], v[100:103]
    v_exp_f32 v77, v77
    v_mfma_f32_16x16x32_bf16 v[100:103], a[192:195], v[176:179], v[100:103]
    v_exp_f32 v78, v78
    v_mfma_f32_16x16x32_bf16 v[100:103], a[196:199], v[216:219], v[100:103]
    s_waitcnt lgkmcnt(0)
    v_cvt_pk_bf16_f32 v196, v76, v77
    v_mfma_f32_16x16x32_bf16 v[108:111], a[200:203], v[64:67], v[224:227]
    v_exp_f32 v79, v79
    v_mfma_f32_16x16x32_bf16 v[108:111], a[204:207], v[104:107], v[108:111]
    s_waitcnt vmcnt(4)
    v_mfma_f32_16x16x32_bf16 v[108:111], a[208:211], v[144:147], v[108:111]
    buffer_load_dwordx4 v22, s[4:7], s26 offen offset:2048 nt lds
    v_mfma_f32_16x16x32_bf16 v[108:111], a[212:215], v[184:187], v[108:111]
    v_exp_f32 v84, v84
    v_mfma_f32_16x16x32_bf16 v[116:119], a[200:203], v[72:75], v[228:231]
    ds_read_b64_tr_b16 v[32:33], v12 offset:0
    ds_read_b64_tr_b16 v[34:35], v12 offset:4096
    v_mfma_f32_16x16x32_bf16 v[116:119], a[204:207], v[112:115], v[116:119]
    v_cvt_pk_bf16_f32 v197, v78, v79
    v_mfma_f32_16x16x32_bf16 v[116:119], a[208:211], v[152:155], v[116:119]
    v_exp_f32 v85, v85
    v_mfma_f32_16x16x32_bf16 v[116:119], a[212:215], v[192:195], v[116:119]
    v_exp_f32 v86, v86
    v_mfma_f32_16x16x32_bf16 v[124:127], a[200:203], v[80:83], v[232:235]
    v_cvt_pk_bf16_f32 v204, v84, v85
    v_exp_f32 v87, v87
    v_mfma_f32_16x16x32_bf16 v[124:127], a[204:207], v[120:123], v[124:127]
    ds_read_b64_tr_b16 v[36:37], v13 offset:0
    ds_read_b64_tr_b16 v[38:39], v13 offset:4096
    v_mfma_f32_16x16x32_bf16 v[124:127], a[208:211], v[160:163], v[124:127]
    v_exp_f32 v92, v92
    v_mfma_f32_16x16x32_bf16 v[124:127], a[212:215], v[200:203], v[124:127]
    s_cbranch_vccnz L_t0_3
    s_waitcnt vmcnt(4)
L_t0_3:
    v_mfma_f32_16x16x32_bf16 v[132:135], a[200:203], v[88:91], v[236:239]
    buffer_load_dwordx4 v23, s[4:7], s26 offen offset:3072 nt lds
    v_mfma_f32_16x16x32_bf16 v[132:135], a[204:207], v[128:131], v[132:135]
    s_add_u32 s26, s26, 8192
    v_cvt_pk_bf16_f32 v205, v86, v87
    v_mfma_f32_16x16x32_bf16 v[132:135], a[208:211], v[168:171], v[132:135]
    ds_read_b64_tr_b16 v[40:41], v14 offset:0
    ds_read_b64_tr_b16 v[42:43], v14 offset:4096
    v_mfma_f32_16x16x32_bf16 v[132:135], a[212:215], v[208:211], v[132:135]
    v_exp_f32 v93, v93
    v_mfma_f32_16x16x32_bf16 v[140:143], a[200:203], v[96:99], v[240:243]
    v_exp_f32 v94, v94
    v_mfma_f32_16x16x32_bf16 v[140:143], a[204:207], v[136:139], v[140:143]
    v_cvt_pk_bf16_f32 v212, v92, v93
    v_mfma_f32_16x16x32_bf16 v[140:143], a[208:211], v[176:179], v[140:143]
    v_exp_f32 v95, v95
    v_mfma_f32_16x16x32_bf16 v[140:143], a[212:215], v[216:219], v[140:143]
    s_waitcnt lgkmcnt(2)
    ds_read_b64_tr_b16 v[44:45], v15 offset:0
    ds_read_b64_tr_b16 v[46:47], v15 offset:4096
    v_mfma_f32_16x16x32_bf16 a[0:3], v[32:35], v[148:151], a[0:3]
    v_exp_f32 v100, v100
    v_mfma_f32_16x16x32_bf16 a[160:163], a[180:183], v[148:151], a[160:163]
    v_cvt_pk_bf16_f32 v213, v94, v95
    v_mfma_f32_16x16x32_bf16 a[4:7], v[32:35], v[156:159], a[4:7]
    s_waitcnt vmcnt(4)
    s_add_u32 m0, s25, 114688
    v_mfma_f32_16x16x32_bf16 a[8:11], v[32:35], v[164:167], a[8:11]
    buffer_load_dwordx4 v24, s[8:11], s27 offen offset:0 nt lds
    v_mfma_f32_16x16x32_bf16 a[12:15], v[32:35], v[172:175], a[12:15]
    v_exp_f32 v101, v101
    v_mfma_f32_16x16x32_bf16 a[16:19], v[32:35], v[180:183], a[16:19]
    ds_read_b64_tr_b16 v[32:33], v16 offset:0
    ds_read_b64_tr_b16 v[34:35], v16 offset:4096
    v_mfma_f32_16x16x32_bf16 a[20:23], v[36:39], v[148:151], a[20:23]
    v_exp_f32 v102, v102
    v_mfma_f32_16x16x32_bf16 a[24:27], v[36:39], v[156:159], a[24:27]
    v_cvt_pk_bf16_f32 v220, v100, v101
    v_mfma_f32_16x16x32_bf16 a[164:167], a[180:183], v[156:159], a[164:167]
    v_exp_f32 v103, v103
    v_mfma_f32_16x16x32_bf16 a[28:31], v[36:39], v[164:167], a[28:31]
    v_exp_f32 v108, v108
    v_mfma_f32_16x16x32_bf16 a[32:35], v[36:39], v[172:175], a[32:35]
    v_cvt_pk_bf16_f32 v221, v102, v103
    v_exp_f32 v109, v109
    v_mfma_f32_16x16x32_bf16 a[36:39], v[36:39], v[180:183], a[36:39]
    s_waitcnt lgkmcnt(2)
    ds_read_b64_tr_b16 v[36:37], v17 offset:0
    ds_read_b64_tr_b16 v[38:39], v17 offset:4096
    v_mfma_f32_16x16x32_bf16 a[40:43], v[40:43], v[148:151], a[40:43]
    v_exp_f32 v110, v110
    v_mfma_f32_16x16x32_bf16 a[44:47], v[40:43], v[156:159], a[44:47]
    s_cbranch_vccnz L_t0_5
    s_waitcnt vmcnt(4)
L_t0_5:
    v_mfma_f32_16x16x32_bf16 a[48:51], v[40:43], v[164:167], a[48:51]
    buffer_load_dwordx4 v25, s[8:11], s27 offen offset:1024 nt lds
    v_cvt_pk_bf16_f32 v190, v108, v109
    v_mfma_f32_16x16x32_bf16 a[168:171], a[180:183], v[164:167], a[168:171]
    v_exp_f32 v111, v111
    v_mfma_f32_16x16x32_bf16 a[52:55], v[40:43], v[172:175], a[52:55]
    v_exp_f32 v116, v116
    v_mfma_f32_16x16x32_bf16 a[56:59], v[40:43], v[180:183], a[56:59]
    ds_read_b64_tr_b16 v[40:41], v18 offset:0
    ds_read_b64_tr_b16 v[42:43], v18 offset:4096
    v_mfma_f32_16x16x32_bf16 a[60:63], v[44:47], v[148:151], a[60:63]
    v_cvt_pk_bf16_f32 v191, v110, v111
    v_mfma_f32_16x16x32_bf16 a[64:67], v[44:47], v[156:159], a[64:67]
    v_exp_f32 v117, v117
    v_mfma_f32_16x16x32_bf16 a[68:71], v[44:47], v[164:167], a[68:71]
    v_exp_f32 v118, v118
    v_mfma_f32_16x16x32_bf16 a[72:75], v[44:47], v[172:175], a[72:75]
    v_cvt_pk_bf16_f32 v198, v116, v117
    v_mfma_f32_16x16x32_bf16 a[172:175], a[180:183], v[172:175], a[172:175]
    v_exp_f32 v119, v119
    v_mfma_f32_16x16x32_bf16 a[76:79], v[44:47], v[180:183], a[76:79]
    s_waitcnt lgkmcnt(2)
    ds_read_b64_tr_b16 v[44:45], v19 offset:0
    ds_read_b64_tr_b16 v[46:47], v19 offset:4096
    v_mfma_f32_16x16x32_bf16 a[80:83], v[32:35], v[148:151], a[80:83]
    v_exp_f32 v124, v124
    v_mfma_f32_16x16x32_bf16 a[84:87], v[32:35], v[156:159], a[84:87]
    s_waitcnt vmcnt(4)
    v_cvt_pk_bf16_f32 v199, v118, v119
    v_mfma_f32_16x16x32_bf16 a[88:91], v[32:35], v[164:167], a[88:91]
    buffer_load_dwordx4 v24, s[8:11], s27 offen offset:2048 nt lds
    v_exp_f32 v125, v125
    v_mfma_f32_16x16x32_bf16 a[92:95], v[32:35], v[172:175], a[92:95]
    v_exp_f32 v126, v126
    v_mfma_f32_16x16x32_bf16 a[96:99], v[32:35], v[180:183], a[96:99]
    v_cvt_pk_bf16_f32 v206, v124, v125
    v_mfma_f32_16x16x32_bf16 a[176:179], a[180:183], v[180:183], a[176:179]
    v_exp_f32 v127, v127
    v_mfma_f32_16x16x32_bf16 a[100:103], v[36:39], v[148:151], a[100:103]
    v_exp_f32 v132, v132
    v_mfma_f32_16x16x32_bf16 a[104:107], v[36:39], v[156:159], a[104:107]
    s_waitcnt lgkmcnt(0)
    s_waitcnt vmcnt(15)
    s_barrier
    v_mfma_f32_16x16x32_bf16 a[108:111], v[36:39], v[164:167], a[108:111]
    ds_read_b128 a[184:187], v8 offset:32768
    v_cvt_pk_bf16_f32 v207, v126, v127
    v_mfma_f32_16x16x32_bf16 a[112:115], v[36:39], v[172:175], a[112:115]
    v_exp_f32 v133, v133
    v_mfma_f32_16x16x32_bf16 a[116:119], v[36:39], v[180:183], a[116:119]
    ds_read_b128 a[188:191], v9 offset:32768
    v_mfma_f32_16x16x32_bf16 a[120:123], v[40:43], v[148:151], a[120:123]
    v_exp_f32 v134, v134
    v_mfma_f32_16x16x32_bf16 a[124:127], v[40:43], v[156:159], a[124:127]
    ds_read_b128 a[192:195], v10 offset:32768
    s_cbranch_vccnz L_t0_7
    s_waitcnt vmcnt(4)
L_t0_7:
    v_mfma_f32_16x16x32_bf16 a[128:131], v[40:43], v[164:167], a[128:131]
    buffer_load_dwordx4 v25, s[8:11], s27 offen offset:3072 nt lds
    v_cvt_pk_bf16_f32 v214, v132, v133
    v_mfma_f32_16x16x32_bf16 a[132:135], v[40:43], v[172:175], a[132:135]
    ds_read_b128 a[196:199], v11 offset:32768
    s_add_u32 s27, s27, 8192
    v_mfma_f32_16x16x32_bf16 a[136:139], v[40:43], v[180:183], a[136:139]
    v_exp_f32 v135, v135
    v_mfma_f32_16x16x32_bf16 a[140:143], v[44:47], v[148:151], a[140:143]
    v_exp_f32 v140, v140
    v_mfma_f32_16x16x32_bf16 a[144:147], v[44:47], v[156:159], a[144:147]
    v_cvt_pk_bf16_f32 v215, v134, v135
    v_mfma_f32_16x16x32_bf16 a[148:151], v[44:47], v[164:167], a[148:151]
    v_exp_f32 v141, v141
    v_mfma_f32_16x16x32_bf16 a[152:155], v[44:47], v[172:175], a[152:155]
    v_exp_f32 v142, v142
    v_mfma_f32_16x16x32_bf16 a[156:159], v[44:47], v[180:183], a[156:159]
    s_waitcnt lgkmcnt(0)
L_loop1:
    v_mfma_f32_16x16x32_bf16 v[68:71], a[184:187], v[64:67], v[224:227]
    ds_read_b128 a[200:203], v8 offset:36864
    v_mfma_f32_16x16x32_bf16 v[68:71], a[188:191], v[104:107], v[68:71]
    s_waitcnt vmcnt(4)
    s_add_u32 m0, s25, 16384
    v_mfma_f32_16x16x32_bf16 v[68:71], a[192:195], v[144:147], v[68:71]
    buffer_load_dwordx4 v20, s[4:7], s26 offen offset:0 nt lds
    v_mfma_f32_16x16x32_bf16 v[68:71], a[196:199], v[184:187], v[68:71]
    ds_read_b128 a[204:207], v9 offset:36864
    v_mfma_f32_16x16x32_bf16 v[76:79], a[184:187], v[72:75], v[228:231]
    v_cvt_pk_bf16_f32 v222, v140, v141
    v_mfma_f32_16x16x32_bf16 v[76:79], a[188:191], v[112:115], v[76:79]
    v_exp_f32 v143, v143
    v_mfma_f32_16x16x32_bf16 v[76:79], a[192:195], v[152:155], v[76:79]
    ds_read_b128 a[208:211], v10 offset:36864
    v_cvt_pk_bf16_f32 v223, v142, v143
    v_mfma_f32_16x16x32_bf16 v[76:79], a[196:199], v[192:195], v[76:79]
    v_exp_f32 v68, v68
    v_mfma_f32_16x16x32_bf16 v[84:87], a[184:187], v[80:83], v[232:235]
    v_exp_f32 v69, v69
    v_mfma_f32_16x16x32_bf16 v[84:87], a[188:191], v[120:123], v[84:87]
    ds_read_b128 a[212:215], v11 offset:36864
    v_mfma_f32_16x16x32_bf16 v[84:87], a[192:195], v[160:163], v[84:87]
    v_exp_f32 v70, v70
    v_mfma_f32_16x16x32_bf16 v[84:87], a[196:199], v[200:203], v[84:87]
    s_cbranch_vccnz L_t1_1
    s_waitcnt vmcnt(4)
L_t1_1:
    v_mfma_f32_16x16x32_bf16 v[92:95], a[184:187], v[88:91], v[236:239]
    buffer_load_dwordx4 v21, s[4:7], s26 offen offset:1024 nt lds
    v_mfma_f32_16x16x32_bf16 v[92:95], a[188:191], v[128:131], v[92:95]
    v_cvt_pk_bf16_f32 v148, v68, v69
    v_mfma_f32_16x16x32_bf16 v[92:95], a[192:195], v[168:171], v[92:95]
    v_exp_f32 v71, v71
    v_mfma_f32_16x16x32_bf16 v[92:95], a[196:199], v[208:211], v[92:95]
    v_exp_f32 v76, v76
    v_mfma_f32_16x16x32_bf16 v[100:103], a[184:187], v[96:99], v[240:243]
    v_cvt_pk_bf16_f32 v149, v70, v71
    v_mfma_f32_16x16x32_bf16 v[100:103], a[188:191], v[136:139], v[100:103]
    v_exp_f32 v77, v77
    v_mfma_f32_16x16x32_bf16 v[100:103], a[192:195], v[176:179], v[100:103]
    v_exp_f32 v78, v78
    v_mfma_f32_16x16x32_bf16 v[100:103], a[196:199], v[216:219], v[100:103]
    s_waitcnt lgkmcnt(0)
    v_cvt_pk_bf16_f32 v156, v76, v77
    v_mfma_f32_16x16x32_bf16 v[108:111], a[200:203], v[64:67], v[224:227]
    v_exp_f32 v79, v79
    v_mfma_f32_16x16x32_bf16 v[108:111], a[204:207], v[104:107], v[108:111]
    s_waitcnt vmcnt(4)
    v_mfma_f32_16x16x32_bf16 v[108:111], a[208:211], v[144:147], v[108:111]
    buffer_load_dwordx4 v22, s[4:7], s26 offen offset:2048 nt lds
    v_mfma_f32_16x16x32_bf16 v[108:111], a[212:215], v[184:187], v[108:111]
    v_exp_f32 v84, v84
    v_mfma_f32_16x16x32_bf16 v[116:119], a[200:203], v[72:75], v[228:231]
    ds_read_b64_tr_b16 v[32:33], v12 offset:16384
    ds_read_b64_tr_b16 v[34:35], v12 offset:20480
    v_mfma_f32_16x16x32_bf16 v[116:119], a[204:207], v[112:115], v[116:119]
    v_cvt_pk_bf16_f32 v157, v78, v79
    v_mfma_f32_16x16x32_bf16 v[116:119], a[208:211], v[152:155], v[116:119]
    v_exp_f32 v85, v85
    v_mfma_f32_16x16x32_bf16 v[116:119], a[212:215], v[192:195], v[116:119]
    v_exp_f32 v86, v86
    v_mfma_f32_16x16x32_bf16 v[124:127], a[200:203], v[80:83], v[232:235]
    v_cvt_pk_bf16_f32 v164, v84, v85
    v_exp_f32 v87, v87
    v_mfma_f32_16x16x32_bf16 v[124:127], a[204:207], v[120:123], v[124:127]
    ds_read_b64_tr_b16 v[36:37], v13 offset:16384
    ds_read_b64_tr_b16 v[38:39], v13 offset:20480
    v_mfma_f32_16x16x32_bf16 v[124:127], a[208:211], v[160:163], v[124:127]
    v_exp_f32 v92, v92
    v_mfma_f32_16x16x32_bf16 v[124:127], a[212:215], v[200:203], v[124:127]
    s_cbranch_vccnz L_t1_3
    s_waitcnt vmcnt(4)
L_t1_3:
    v_mfma_f32_16x16x32_bf16 v[132:135], a[200:203], v[88:91], v[236:239]
    buffer_load_dwordx4 v23, s[4:7], s26 offen offset:3072 nt lds
    v_mfma_f32_16x16x32_bf16 v[132:135], a[204:207], v[128:131], v[132:135]
    s_add_u32 s26, s26, 8192
    v_cvt_pk_bf16_f32 v165, v86, v87
    v_mfma_f32_16x16x32_bf16 v[132:135], a[208:211], v[168:171], v[132:135]
    ds_read_b64_tr_b16 v[40:41], v14 offset:16384
    ds_read_b64_tr_b16 v[42:43], v14 offset:20480
    v_mfma_f32_16x16x32_bf16 v[132:135], a[212:215], v[208:211], v[132:135]
    v_exp_f32 v93, v93
    v_mfma_f32_16x16x32_bf16 v[140:143], a[200:203], v[96:99], v[240:243]
    v_exp_f32 v94, v94
    v_mfma_f32_16x16x32_bf16 v[140:143], a[204:207], v[136:139], v[140:143]
    v_cvt_pk_bf16_f32 v172, v92, v93
    v_mfma_f32_16x16x32_bf16 v[140:143], a[208:211], v[176:179], v[140:143]
    v_exp_f32 v95, v95
    v_mfma_f32_16x16x32_bf16 v[140:143], a[212:215], v[216:219], v[140:143]
    s_waitcnt lgkmcnt(2)
    ds_read_b64_tr_b16 v[44:45], v15 offset:16384
    ds_read_b64_tr_b16 v[46:47], v15 offset:20480
    v_mfma_f32_16x16x32_bf16 a[0:3], v[32:35], v[188:191], a[0:3]
    v_exp_f32 v100, v100
    v_mfma_f32_16x16x32_bf16 a[160:163], a[180:183], v[188:191], a[160:163]
    v_cvt_pk_bf16_f32 v173, v94, v95
    v_mfma_f32_16x16x32_bf16 a[4:7], v[32:35], v[196:199], a[4:7]
    s_waitcnt vmcnt(4)
    s_add_u32 m0, s25, 65536
    v_mfma_f32_16x16x32_bf16 a[8:11], v[32:35], v[204:207], a[8:11]
    buffer_load_dwordx4 v24, s[8:11], s27 offen offset:0 nt lds
    v_mfma_f32_16x16x32_bf16 a[12:15], v[32:35], v[212:215], a[12:15]
    v_exp_f32 v101, v101
    v_mfma_f32_16x16x32_bf16 a[16:19], v[32:35], v[220:223], a[16:19]
    ds_read_b64_tr_b16 v[32:33], v16 offset:16384
    ds_read_b64_tr_b16 v[34:35], v16 offset:20480
    v_mfma_f32_16x16x32_bf16 a[20:23], v[36:39], v[188:191], a[20:23]
    v_exp_f32 v102, v102
    v_mfma_f32_16x16x32_bf16 a[24:27], v[36:39], v[196:199], a[24:27]
    v_cvt_pk_bf16_f32 v180, v100, v101
    v_mfma_f32_16x16x32_bf16 a[164:167], a[180:183], v[196:199], a[164:167]
    v_exp_f32 v103, v103
    v_mfma_f32_16x16x32_bf16 a[28:31], v[36:39], v[204:207], a[28:31]
    v_exp_f32 v108, v108
    v_mfma_f32_16x16x32_bf16 a[32:35], v[36:39], v[212:215], a[32:35]
    v_cvt_pk_bf16_f32 v181, v102, v103
    v_exp_f32 v109, v109
    v_mfma_f32_16x16x32_bf16 a[36:39], v[36:39], v[220:223], a[36:39]
    s_waitcnt lgkmcnt(2)
    ds_read_b64_tr_b16 v[36:37], v17 offset:16384
    ds_read_b64_tr_b16 v[38:39], v17 offset:20480
    v_mfma_f32_16x16x32_bf16 a[40:43], v[40:43], v[188:191], a[40:43]
    v_exp_f32 v110, v110
    v_mfma_f32_16x16x32_bf16 a[44:47], v[40:43], v[196:199], a[44:47]
    s_cbranch_vccnz L_t1_5
    s_waitcnt vmcnt(4)
L_t1_5:
    v_mfma_f32_16x16x32_bf16 a[48:51], v[40:43], v[204:207], a[48:51]
    buffer_load_dwordx4 v25, s[8:11], s27 offen offset:1024 nt lds
    v_cvt_pk_bf16_f32 v150, v108, v109
    v_mfma_f32_16x16x32_bf16 a[168:171], a[180:183], v[204:207], a[168:171]
    v_exp_f32 v111, v111
    v_mfma_f32_16x16x32_bf16 a[52:55], v[40:43], v[212:215], a[52:55]
    v_exp_f32 v116, v116
    v_mfma_f32_16x16x32_bf16 a[56:59], v[40:43], v[220:223], a[56:59]
    ds_read_b64_tr_b16 v[40:41], v18 offset:16384
    ds_read_b64_tr_b16 v[42:43], v18 offset:20480
    v_mfma_f32_16x16x32_bf16 a[60:63], v[44:47], v[188:191], a[60:63]
    v_cvt_pk_bf16_f32 v151, v110, v111
    v_mfma_f32_16x16x32_bf16 a[64:67], v[44:47], v[196:199], a[64:67]
    v_exp_f32 v117, v117
    v_mfma_f32_16x16x32_bf16 a[68:71], v[44:47], v[204:207], a[68:71]
    v_exp_f32 v118, v118
    v_mfma_f32_16x16x32_bf16 a[72:75], v[44:47], v[212:215], a[72:75]
    v_cvt_pk_bf16_f32 v158, v116, v117
    v_mfma_f32_16x16x32_bf16 a[172:175], a[180:183], v[212:215], a[172:175]
    v_exp_f32 v119, v119
    v_mfma_f32_16x16x32_bf16 a[76:79], v[44:47], v[220:223], a[76:79]
    s_waitcnt lgkmcnt(2)
    ds_read_b64_tr_b16 v[44:45], v19 offset:16384
    ds_read_b64_tr_b16 v[46:47], v19 offset:20480
    v_mfma_f32_16x16x32_bf16 a[80:83], v[32:35], v[188:191], a[80:83]
    v_exp_f32 v124, v124
    v_mfma_f32_16x16x32_bf16 a[84:87], v[32:35], v[196:199], a[84:87]
    s_waitcnt vmcnt(4)
    v_cvt_pk_bf16_f32 v159, v118, v119
    v_mfma_f32_16x16x32_bf16 a[88:91], v[32:35], v[204:207], a[88:91]
    buffer_load_dwordx4 v24, s[8:11], s27 offen offset:2048 nt lds
    v_exp_f32 v125, v125
    v_mfma_f32_16x16x32_bf16 a[92:95], v[32:35], v[212:215], a[92:95]
    v_exp_f32 v126, v126
    v_mfma_f32_16x16x32_bf16 a[96:99], v[32:35], v[220:223], a[96:99]
    v_cvt_pk_bf16_f32 v166, v124, v125
    v_mfma_f32_16x16x32_bf16 a[176:179], a[180:183], v[220:223], a[176:179]
    v_exp_f32 v127, v127
    v_mfma_f32_16x16x32_bf16 a[100:103], v[36:39], v[188:191], a[100:103]
    v_exp_f32 v132, v132
    v_mfma_f32_16x16x32_bf16 a[104:107], v[36:39], v[196:199], a[104:107]
    s_waitcnt lgkmcnt(0)
    s_waitcnt vmcnt(15)
    s_barrier
    v_mfma_f32_16x16x32_bf16 a[108:111], v[36:39], v[204:207], a[108:111]
    ds_read_b128 a[184:187], v8 offset:49152
    v_cvt_pk_bf16_f32 v167, v126, v127
    v_mfma_f32_16x16x32_bf16 a[112:115], v[36:39], v[212:215], a[112:115]
    v_exp_f32 v133, v133
    v_mfma_f32_16x16x32_bf16 a[116:119], v[36:39], v[220:223], a[116:119]
    ds_read_b128 a[188:191], v9 offset:49152
    v_mfma_f32_16x16x32_bf16 a[120:123], v[40:43], v[188:191], a[120:123]
    v_exp_f32 v134, v134
    v_mfma_f32_16x16x32_bf16 a[124:127], v[40:43], v[196:199], a[124:127]
    ds_read_b128 a[192:195], v10 offset:49152
    s_cbranch_vccnz L_t1_7
    s_waitcnt vmcnt(4)
L_t1_7:
    v_mfma_f32_16x16x32_bf16 a[128:131], v[40:43], v[204:207], a[128:131]
    buffer_load_dwordx4 v25, s[8:11], s27 offen offset:3072 nt lds
    v_cvt_pk_bf16_f32 v174, v132, v133
    v_mfma_f32_16x16x32_bf16 a[132:135], v[40:43], v[212:215], a[132:135]
    ds_read_b128 a[196:199], v11 offset:49152
    s_add_u32 s27, s27, 8192
    v_mfma_f32_16x16x32_bf16 a[136:139], v[40:43], v[220:223], a[136:139]
    v_exp_f32 v135, v135
    v_mfma_f32_16x16x32_bf16 a[140:143], v[44:47], v[188:191], a[140:143]
    v_exp_f32 v140, v140
    v_mfma_f32_16x16x32_bf16 a[144:147], v[44:47], v[196:199], a[144:147]
    v_cvt_pk_bf16_f32 v175, v134, v135
    v_mfma_f32_16x16x32_bf16 a[148:151], v[44:47], v[204:207], a[148:151]
    v_exp_f32 v141, v141
    v_mfma_f32_16x16x32_bf16 a[152:155], v[44:47], v[212:215], a[152:155]
    v_exp_f32 v142, v142
    v_mfma_f32_16x16x32_bf16 a[156:159], v[44:47], v[220:223], a[156:159]
    s_waitcnt lgkmcnt(0)
    v_mfma_f32_16x16x32_bf16 v[68:71], a[184:187], v[64:67], v[224:227]
    ds_read_b128 a[200:203], v8 offset:53248
    v_mfma_f32_16x16x32_bf16 v[68:71], a[188:191], v[104:107], v[68:71]
    s_waitcnt vmcnt(4)
    s_add_u32 m0, s25, 32768
    v_mfma_f32_16x16x32_bf16 v[68:71], a[192:195], v[144:147], v[68:71]
    buffer_load_dwordx4 v20, s[4:7], s26 offen offset:0 nt lds
    v_mfma_f32_16x16x32_bf16 v[68:71], a[196:199], v[184:187], v[68:71]
    ds_read_b128 a[204:207], v9 offset:53248
    v_mfma_f32_16x16x32_bf16 v[76:79], a[184:187], v[72:75], v[228:231]
    v_cvt_pk_bf16_f32 v182, v140, v141
    v_mfma_f32_16x16x32_bf16 v[76:79], a[188:191], v[112:115], v[76:79]
    v_exp_f32 v143, v143
    v_mfma_f32_16x16x32_bf16 v[76:79], a[192:195], v[152:155], v[76:79]
    ds_read_b128 a[208:211], v10 offset:53248
    v_cvt_pk_bf16_f32 v183, v142, v143
    v_mfma_f32_16x16x32_bf16 v[76:79], a[196:199], v[192:195], v[76:79]
    v_exp_f32 v68, v68
    v_mfma_f32_16x16x32_bf16 v[84:87], a[184:187], v[80:83], v[232:235]
    v_exp_f32 v69, v69
    v_mfma_f32_16x16x32_bf16 v[84:87], a[188:191], v[120:123], v[84:87]
    ds_read_b128 a[212:215], v11 offset:53248
    v_mfma_f32_16x16x32_bf16 v[84:87], a[192:195], v[160:163], v[84:87]
    v_exp_f32 v70, v70
    v_mfma_f32_16x16x32_bf16 v[84:87], a[196:199], v[200:203], v[84:87]
    s_cbranch_vccnz L_t2_1
    s_waitcnt vmcnt(4)
L_t2_1:
    v_mfma_f32_16x16x32_bf16 v[92:95], a[184:187], v[88:91], v[236:239]
    buffer_load_dwordx4 v21, s[4:7], s26 offen offset:1024 nt lds
    v_mfma_f32_16x16x32_bf16 v[92:95], a[188:191], v[128:131], v[92:95]
    v_cvt_pk_bf16_f32 v188, v68, v69
    v_mfma_f32_16x16x32_bf16 v[92:95], a[192:195], v[168:171], v[92:95]
    v_exp_f32 v71, v71
    v_mfma_f32_16x16x32_bf16 v[92:95], a[196:199], v[208:211], v[92:95]
    v_exp_f32 v76, v76
    v_mfma_f32_16x16x32_bf16 v[100:103], a[184:187], v[96:99], v[240:243]
    v_cvt_pk_bf16_f32 v189, v70, v71
    v_mfma_f32_16x16x32_bf16 v[100:103], a[188:191], v[136:139], v[100:103]
    v_exp_f32 v77, v77
    v_mfma_f32_16x16x32_bf16 v[100:103], a[192:195], v[176:179], v[100:103]
    v_exp_f32 v78, v78
    v_mfma_f32_16x16x32_bf16 v[100:103], a[196:199], v[216:219], v[100:103]
    s_waitcnt lgkmcnt(0)
    v_cvt_pk_bf16_f32 v196, v76, v77
    v_mfma_f32_16x16x32_bf16 v[108:111], a[200:203], v[64:67], v[224:227]
    v_exp_f32 v79, v79
    v_mfma_f32_16x16x32_bf16 v[108:111], a[204:207], v[104:107], v[108:111]
    s_waitcnt vmcnt(4)
    v_mfma_f32_16x16x32_bf16 v[108:111], a[208:211], v[144:147], v[108:111]
    buffer_load_dwordx4 v22, s[4:7], s26 offen offset:2048 nt lds
    v_mfma_f32_16x16x32_bf16 v[108:111], a[212:215], v[184:187], v[108:111]
    v_exp_f32 v84, v84
    v_mfma_f32_16x16x32_bf16 v[116:119], a[200:203], v[72:75], v[228:231]
    ds_read_b64_tr_b16 v[32:33], v12 offset:32768
    ds_read_b64_tr_b16 v[34:35], v12 offset:36864
    v_mfma_f32_16x16x32_bf16 v[116:119], a[204:207], v[112:115], v[116:119]
    v_cvt_pk_bf16_f32 v197, v78, v79
    v_mfma_f32_16x16x32_bf16 v[116:119], a[208:211], v[152:155], v[116:119]
    v_exp_f32 v85, v85
    v_mfma_f32_16x16x32_bf16 v[116:119], a[212:215], v[192:195], v[116:119]
    v_exp_f32 v86, v86
    v_mfma_f32_16x16x32_bf16 v[124:127], a[200:203], v[80:83], v[232:235]
    v_cvt_pk_bf16_f32 v204, v84, v85
    v_exp_f32 v87, v87
    v_mfma_f32_16x16x32_bf16 v[124:127], a[204:207], v[120:123], v[124:127]
    ds_read_b64_tr_b16 v[36:37], v13 offset:32768
    ds_read_b64_tr_b16 v[38:39], v13 offset:36864
    v_mfma_f32_16x16x32_bf16 v[124:127], a[208:211], v[160:163], v[124:127]
    v_exp_f32 v92, v92
    v_mfma_f32_16x16x32_bf16 v[124:127], a[212:215], v[200:203], v[124:127]
    s_cbranch_vccnz L_t2_3
    s_waitcnt vmcnt(4)
L_t2_3:
    v_mfma_f32_16x16x32_bf16 v[132:135], a[200:203], v[88:91], v[236:239]
    buffer_load_dwordx4 v23, s[4:7], s26 offen offset:3072 nt lds
    v_mfma_f32_16x16x32_bf16 v[132:135], a[204:207], v[128:131], v[132:135]
    s_add_u32 s26, s26, 8192
    v_cvt_pk_bf16_f32 v205, v86, v87
    v_mfma_f32_16x16x32_bf16 v[132:135], a[208:211], v[168:171], v[132:135]
    ds_read_b64_tr_b16 v[40:41], v14 offset:32768
    ds_read_b64_tr_b16 v[42:43], v14 offset:36864
    v_mfma_f32_16x16x32_bf16 v[132:135], a[212:215], v[208:211], v[132:135]
    v_exp_f32 v93, v93
    v_mfma_f32_16x16x32_bf16 v[140:143], a[200:203], v[96:99], v[240:243]
    v_exp_f32 v94, v94
    v_mfma_f32_16x16x32_bf16 v[140:143], a[204:207], v[136:139], v[140:143]
    v_cvt_pk_bf16_f32 v212, v92, v93
    v_mfma_f32_16x16x32_bf16 v[140:143], a[208:211], v[176:179], v[140:143]
    v_exp_f32 v95, v95
    v_mfma_f32_16x16x32_bf16 v[140:143], a[212:215], v[216:219], v[140:143]
    s_waitcnt lgkmcnt(2)
    ds_read_b64_tr_b16 v[44:45], v15 offset:32768
    ds_read_b64_tr_b16 v[46:47], v15 offset:36864
    v_mfma_f32_16x16x32_bf16 a[0:3], v[32:35], v[148:151], a[0:3]
    v_exp_f32 v100, v100
    v_mfma_f32_16x16x32_bf16 a[160:163], a[180:183], v[148:151], a[160:163]
    v_cvt_pk_bf16_f32 v213, v94, v95
    v_mfma_f32_16x16x32_bf16 a[4:7], v[32:35], v[156:159], a[4:7]
    s_waitcnt vmcnt(4)
    s_add_u32 m0, s25, 81920
    v_mfma_f32_16x16x32_bf16 a[8:11], v[32:35], v[164:167], a[8:11]
    buffer_load_dwordx4 v24, s[8:11], s27 offen offset:0 nt lds
    v_mfma_f32_16x16x32_bf16 a[12:15], v[32:35], v[172:175], a[12:15]
    v_exp_f32 v101, v101
    v_mfma_f32_16x16x32_bf16 a[16:19], v[32:35], v[180:183], a[16:19]
    ds_read_b64_tr_b16 v[32:33], v16 offset:32768
    ds_read_b64_tr_b16 v[34:35], v16 offset:36864
    v_mfma_f32_16x16x32_bf16 a[20:23], v[36:39], v[148:151], a[20:23]
    v_exp_f32 v102, v102
    v_mfma_f32_16x16x32_bf16 a[24:27], v[36:39], v[156:159], a[24:27]
    v_cvt_pk_bf16_f32 v220, v100, v101
    v_mfma_f32_16x16x32_bf16 a[164:167], a[180:183], v[156:159], a[164:167]
    v_exp_f32 v103, v103
    v_mfma_f32_16x16x32_bf16 a[28:31], v[36:39], v[164:167], a[28:31]
    v_exp_f32 v108, v108
    v_mfma_f32_16x16x32_bf16 a[32:35], v[36:39], v[172:175], a[32:35]
    v_cvt_pk_bf16_f32 v221, v102, v103
    v_exp_f32 v109, v109
    v_mfma_f32_16x16x32_bf16 a[36:39], v[36:39], v[180:183], a[36:39]
    s_waitcnt lgkmcnt(2)
    ds_read_b64_tr_b16 v[36:37], v17 offset:32768
    ds_read_b64_tr_b16 v[38:39], v17 offset:36864
    v_mfma_f32_16x16x32_bf16 a[40:43], v[40:43], v[148:151], a[40:43]
    v_exp_f32 v110, v110
    v_mfma_f32_16x16x32_bf16 a[44:47], v[40:43], v[156:159], a[44:47]
    s_cbranch_vccnz L_t2_5
    s_waitcnt vmcnt(4)
L_t2_5:
    v_mfma_f32_16x16x32_bf16 a[48:51], v[40:43], v[164:167], a[48:51]
    buffer_load_dwordx4 v25, s[8:11], s27 offen offset:1024 nt lds
    v_cvt_pk_bf16_f32 v190, v108, v109
    v_mfma_f32_16x16x32_bf16 a[168:171], a[180:183], v[164:167], a[168:171]
    v_exp_f32 v111, v111
    v_mfma_f32_16x16x32_bf16 a[52:55], v[40:43], v[172:175], a[52:55]
    v_exp_f32 v116, v116
    v_mfma_f32_16x16x32_bf16 a[56:59], v[40:43], v[180:183], a[56:59]
    ds_read_b64_tr_b16 v[40:41], v18 offset:32768
    ds_read_b64_tr_b16 v[42:43], v18 offset:36864
    v_mfma_f32_16x16x32_bf16 a[60:63], v[44:47], v[148:151], a[60:63]
    v_cvt_pk_bf16_f32 v191, v110, v111
    v_mfma_f32_16x16x32_bf16 a[64:67], v[44:47], v[156:159], a[64:67]
    v_exp_f32 v117, v117
    v_mfma_f32_16x16x32_bf16 a[68:71], v[44:47], v[164:167], a[68:71]
    v_exp_f32 v118, v118
    v_mfma_f32_16x16x32_bf16 a[72:75], v[44:47], v[172:175], a[72:75]
    v_cvt_pk_bf16_f32 v198, v116, v117
    v_mfma_f32_16x16x32_bf16 a[172:175], a[180:183], v[172:175], a[172:175]
    v_exp_f32 v119, v119
    v_mfma_f32_16x16x32_bf16 a[76:79], v[44:47], v[180:183], a[76:79]
    s_waitcnt lgkmcnt(2)
    ds_read_b64_tr_b16 v[44:45], v19 offset:32768
    ds_read_b64_tr_b16 v[46:47], v19 offset:36864
    v_mfma_f32_16x16x32_bf16 a[80:83], v[32:35], v[148:151], a[80:83]
    v_exp_f32 v124, v124
    v_mfma_f32_16x16x32_bf16 a[84:87], v[32:35], v[156:159], a[84:87]
    s_waitcnt vmcnt(4)
    v_cvt_pk_bf16_f32 v199, v118, v119
    v_mfma_f32_16x16x32_bf16 a[88:91], v[32:35], v[164:167], a[88:91]
    buffer_load_dwordx4 v24, s[8:11], s27 offen offset:2048 nt lds
    v_exp_f32 v125, v125
    v_mfma_f32_16x16x32_bf16 a[92:95], v[32:35], v[172:175], a[92:95]
    v_exp_f32 v126, v126
    v_mfma_f32_16x16x32_bf16 a[96:99], v[32:35], v[180:183], a[96:99]
    v_cvt_pk_bf16_f32 v206, v124, v125
    v_mfma_f32_16x16x32_bf16 a[176:179], a[180:183], v[180:183], a[176:179]
    v_exp_f32 v127, v127
    v_mfma_f32_16x16x32_bf16 a[100:103], v[36:39], v[148:151], a[100:103]
    v_exp_f32 v132, v132
    v_mfma_f32_16x16x32_bf16 a[104:107], v[36:39], v[156:159], a[104:107]
    s_waitcnt lgkmcnt(0)
    s_waitcnt vmcnt(15)
    s_barrier
    v_mfma_f32_16x16x32_bf16 a[108:111], v[36:39], v[164:167], a[108:111]
    ds_read_b128 a[184:187], v8 offset:0
    v_cvt_pk_bf16_f32 v207, v126, v127
    v_mfma_f32_16x16x32_bf16 a[112:115], v[36:39], v[172:175], a[112:115]
    v_exp_f32 v133, v133
    v_mfma_f32_16x16x32_bf16 a[116:119], v[36:39], v[180:183], a[116:119]
    ds_read_b128 a[188:191], v9 offset:0
    v_mfma_f32_16x16x32_bf16 a[120:123], v[40:43], v[148:151], a[120:123]
    v_exp_f32 v134, v134
    v_mfma_f32_16x16x32_bf16 a[124:127], v[40:43], v[156:159], a[124:127]
    ds_read_b128 a[192:195], v10 offset:0
    s_cbranch_vccnz L_t2_7
    s_waitcnt vmcnt(4)
L_t2_7:
    v_mfma_f32_16x16x32_bf16 a[128:131], v[40:43], v[164:167], a[128:131]
    buffer_load_dwordx4 v25, s[8:11], s27 offen offset:3072 nt lds
    v_cvt_pk_bf16_f32 v214, v132, v133
    v_mfma_f32_16x16x32_bf16 a[132:135], v[40:43], v[172:175], a[132:135]
    ds_read_b128 a[196:199], v11 offset:0
    s_add_u32 s27, s27, 8192
    v_mfma_f32_16x16x32_bf16 a[136:139], v[40:43], v[180:183], a[136:139]
    v_exp_f32 v135, v135
    v_mfma_f32_16x16x32_bf16 a[140:143], v[44:47], v[148:151], a[140:143]
    v_exp_f32 v140, v140
    v_mfma_f32_16x16x32_bf16 a[144:147], v[44:47], v[156:159], a[144:147]
    v_cvt_pk_bf16_f32 v215, v134, v135
    v_mfma_f32_16x16x32_bf16 a[148:151], v[44:47], v[164:167], a[148:151]
    v_exp_f32 v141, v141
    v_mfma_f32_16x16x32_bf16 a[152:155], v[44:47], v[172:175], a[152:155]
    v_exp_f32 v142, v142
    v_mfma_f32_16x16x32_bf16 a[156:159], v[44:47], v[180:183], a[156:159]
    s_waitcnt lgkmcnt(0)
    v_mfma_f32_16x16x32_bf16 v[68:71], a[184:187], v[64:67], v[224:227]
    ds_read_b128 a[200:203], v8 offset:4096
    v_mfma_f32_16x16x32_bf16 v[68:71], a[188:191], v[104:107], v[68:71]
    s_waitcnt vmcnt(4)
    s_add_u32 m0, s25, 49152
    v_mfma_f32_16x16x32_bf16 v[68:71], a[192:195], v[144:147], v[68:71]
    buffer_load_dwordx4 v20, s[4:7], s26 offen offset:0 nt lds
    v_mfma_f32_16x16x32_bf16 v[68:71], a[196:199], v[184:187], v[68:71]
    ds_read_b128 a[204:207], v9 offset:4096
    v_mfma_f32_16x16x32_bf16 v[76:79], a[184:187], v[72:75], v[228:231]
    v_cvt_pk_bf16_f32 v222, v140, v141
    v_mfma_f32_16x16x32_bf16 v[76:79], a[188:191], v[112:115], v[76:79]
    v_exp_f32 v143, v143
    v_mfma_f32_16x16x32_bf16 v[76:79], a[192:195], v[152:155], v[76:79]
    ds_read_b128 a[208:211], v10 offset:4096
    v_cvt_pk_bf16_f32 v223, v142, v143
    v_mfma_f32_16x16x32_bf16 v[76:79], a[196:199], v[192:195], v[76:79]
    v_exp_f32 v68, v68
    v_mfma_f32_16x16x32_bf16 v[84:87], a[184:187], v[80:83], v[232:235]
    v_exp_f32 v69, v69
    v_mfma_f32_16x16x32_bf16 v[84:87], a[188:191], v[120:123], v[84:87]
    ds_read_b128 a[212:215], v11 offset:4096
    v_mfma_f32_16x16x32_bf16 v[84:87], a[192:195], v[160:163], v[84:87]
    v_exp_f32 v70, v70
    v_mfma_f32_16x16x32_bf16 v[84:87], a[196:199], v[200:203], v[84:87]
    s_cbranch_vccnz L_t3_1
    s_waitcnt vmcnt(4)
L_t3_1:
    v_mfma_f32_16x16x32_bf16 v[92:95], a[184:187], v[88:91], v[236:239]
    buffer_load_dwordx4 v21, s[4:7], s26 offen offset:1024 nt lds
    v_mfma_f32_16x16x32_bf16 v[92:95], a[188:191], v[128:131], v[92:95]
    v_cvt_pk_bf16_f32 v148, v68, v69
    v_mfma_f32_16x16x32_bf16 v[92:95], a[192:195], v[168:171], v[92:95]
    v_exp_f32 v71, v71
    v_mfma_f32_16x16x32_bf16 v[92:95], a[196:199], v[208:211], v[92:95]
    v_exp_f32 v76, v76
    v_mfma_f32_16x16x32_bf16 v[100:103], a[184:187], v[96:99], v[240:243]
    v_cvt_pk_bf16_f32 v149, v70, v71
    v_mfma_f32_16x16x32_bf16 v[100:103], a[188:191], v[136:139], v[100:103]
    v_exp_f32 v77, v77
    v_mfma_f32_16x16x32_bf16 v[100:103], a[192:195], v[176:179], v[100:103]
    v_exp_f32 v78, v78
    v_mfma_f32_16x16x32_bf16 v[100:103], a[196:199], v[216:219], v[100:103]
    s_waitcnt lgkmcnt(0)
    v_cvt_pk_bf16_f32 v156, v76, v77
    v_mfma_f32_16x16x32_bf16 v[108:111], a[200:203], v[64:67], v[224:227]
    v_exp_f32 v79, v79
    v_mfma_f32_16x16x32_bf16 v[108:111], a[204:207], v[104:107], v[108:111]
    s_waitcnt vmcnt(4)
    v_mfma_f32_16x16x32_bf16 v[108:111], a[208:211], v[144:147], v[108:111]
    buffer_load_dwordx4 v22, s[4:7], s26 offen offset:2048 nt lds
    v_mfma_f32_16x16x32_bf16 v[108:111], a[212:215], v[184:187], v[108:111]
    v_exp_f32 v84, v84
    v_mfma_f32_16x16x32_bf16 v[116:119], a[200:203], v[72:75], v[228:231]
    ds_read_b64_tr_b16 v[32:33], v12 offset:49152
    ds_read_b64_tr_b16 v[34:35], v12 offset:53248
    v_mfma_f32_16x16x32_bf16 v[116:119], a[204:207], v[112:115], v[116:119]
    v_cvt_pk_bf16_f32 v157, v78, v79
    v_mfma_f32_16x16x32_bf16 v[116:119], a[208:211], v[152:155], v[116:119]
    v_exp_f32 v85, v85
    v_mfma_f32_16x16x32_bf16 v[116:119], a[212:215], v[192:195], v[116:119]
    v_exp_f32 v86, v86
    v_mfma_f32_16x16x32_bf16 v[124:127], a[200:203], v[80:83], v[232:235]
    v_cvt_pk_bf16_f32 v164, v84, v85
    v_exp_f32 v87, v87
    v_mfma_f32_16x16x32_bf16 v[124:127], a[204:207], v[120:123], v[124:127]
    ds_read_b64_tr_b16 v[36:37], v13 offset:49152
    ds_read_b64_tr_b16 v[38:39], v13 offset:53248
    v_mfma_f32_16x16x32_bf16 v[124:127], a[208:211], v[160:163], v[124:127]
    v_exp_f32 v92, v92
    v_mfma_f32_16x16x32_bf16 v[124:127], a[212:215], v[200:203], v[124:127]
    s_cbranch_vccnz L_t3_3
    s_waitcnt vmcnt(4)
L_t3_3:
    v_mfma_f32_16x16x32_bf16 v[132:135], a[200:203], v[88:91], v[236:239]
    buffer_load_dwordx4 v23, s[4:7], s26 offen offset:3072 nt lds
    v_mfma_f32_16x16x32_bf16 v[132:135], a[204:207], v[128:131], v[132:135]
    s_add_u32 s26, s26, 8192
    v_cvt_pk_bf16_f32 v165, v86, v87
    v_mfma_f32_16x16x32_bf16 v[132:135], a[208:211], v[168:171], v[132:135]
    ds_read_b64_tr_b16 v[40:41], v14 offset:49152
    ds_read_b64_tr_b16 v[42:43], v14 offset:53248
    v_mfma_f32_16x16x32_bf16 v[132:135], a[212:215], v[208:211], v[132:135]
    v_exp_f32 v93, v93
    v_mfma_f32_16x16x32_bf16 v[140:143], a[200:203], v[96:99], v[240:243]
    v_exp_f32 v94, v94
    v_mfma_f32_16x16x32_bf16 v[140:143], a[204:207], v[136:139], v[140:143]
    v_cvt_pk_bf16_f32 v172, v92, v93
    v_mfma_f32_16x16x32_bf16 v[140:143], a[208:211], v[176:179], v[140:143]
    v_exp_f32 v95, v95
    v_mfma_f32_16x16x32_bf16 v[140:143], a[212:215], v[216:219], v[140:143]
    s_waitcnt lgkmcnt(2)
    ds_read_b64_tr_b16 v[44:45], v15 offset:49152
    ds_read_b64_tr_b16 v[46:47], v15 offset:53248
    v_mfma_f32_16x16x32_bf16 a[0:3], v[32:35], v[188:191], a[0:3]
    v_exp_f32 v100, v100
    v_mfma_f32_16x16x32_bf16 a[160:163], a[180:183], v[188:191], a[160:163]
    v_cvt_pk_bf16_f32 v173, v94, v95
    v_mfma_f32_16x16x32_bf16 a[4:7], v[32:35], v[196:199], a[4:7]
    s_waitcnt vmcnt(4)
    s_add_u32 m0, s25, 98304
    v_mfma_f32_16x16x32_bf16 a[8:11], v[32:35], v[204:207], a[8:11]
    buffer_load_dwordx4 v24, s[8:11], s27 offen offset:0 nt lds
    v_mfma_f32_16x16x32_bf16 a[12:15], v[32:35], v[212:215], a[12:15]
    v_exp_f32 v101, v101
    v_mfma_f32_16x16x32_bf16 a[16:19], v[32:35], v[220:223], a[16:19]
    ds_read_b64_tr_b16 v[32:33], v16 offset:49152
    ds_read_b64_tr_b16 v[34:35], v16 offset:53248
    v_mfma_f32_16x16x32_bf16 a[20:23], v[36:39], v[188:191], a[20:23]
    v_exp_f32 v102, v102
    v_mfma_f32_16x16x32_bf16 a[24:27], v[36:39], v[196:199], a[24:27]
    v_cvt_pk_bf16_f32 v180, v100, v101
    v_mfma_f32_16x16x32_bf16 a[164:167], a[180:183], v[196:199], a[164:167]
    v_exp_f32 v103, v103
    v_mfma_f32_16x16x32_bf16 a[28:31], v[36:39], v[204:207], a[28:31]
    v_exp_f32 v108, v108
    v_mfma_f32_16x16x32_bf16 a[32:35], v[36:39], v[212:215], a[32:35]
    v_cvt_pk_bf16_f32 v181, v102, v103
    v_exp_f32 v109, v109
    v_mfma_f32_16x16x32_bf16 a[36:39], v[36:39], v[220:223], a[36:39]
    s_waitcnt lgkmcnt(2)
    ds_read_b64_tr_b16 v[36:37], v17 offset:49152
    ds_read_b64_tr_b16 v[38:39], v17 offset:53248
    v_mfma_f32_16x16x32_bf16 a[40:43], v[40:43], v[188:191], a[40:43]
    v_exp_f32 v110, v110
    v_mfma_f32_16x16x32_bf16 a[44:47], v[40:43], v[196:199], a[44:47]
    s_cbranch_vccnz L_t3_5
    s_waitcnt vmcnt(4)
L_t3_5:
    v_mfma_f32_16x16x32_bf16 a[48:51], v[40:43], v[204:207], a[48:51]
    buffer_load_dwordx4 v25, s[8:11], s27 offen offset:1024 nt lds
    v_cvt_pk_bf16_f32 v150, v108, v109
    v_mfma_f32_16x16x32_bf16 a[168:171], a[180:183], v[204:207], a[168:171]
    v_exp_f32 v111, v111
    v_mfma_f32_16x16x32_bf16 a[52:55], v[40:43], v[212:215], a[52:55]
    v_exp_f32 v116, v116
    v_mfma_f32_16x16x32_bf16 a[56:59], v[40:43], v[220:223], a[56:59]
    ds_read_b64_tr_b16 v[40:41], v18 offset:49152
    ds_read_b64_tr_b16 v[42:43], v18 offset:53248
    v_mfma_f32_16x16x32_bf16 a[60:63], v[44:47], v[188:191], a[60:63]
    v_cvt_pk_bf16_f32 v151, v110, v111
    v_mfma_f32_16x16x32_bf16 a[64:67], v[44:47], v[196:199], a[64:67]
    v_exp_f32 v117, v117
    v_mfma_f32_16x16x32_bf16 a[68:71], v[44:47], v[204:207], a[68:71]
    v_exp_f32 v118, v118
    v_mfma_f32_16x16x32_bf16 a[72:75], v[44:47], v[212:215], a[72:75]
    v_cvt_pk_bf16_f32 v158, v116, v117
    v_mfma_f32_16x16x32_bf16 a[172:175], a[180:183], v[212:215], a[172:175]
    v_exp_f32 v119, v119
    v_mfma_f32_16x16x32_bf16 a[76:79], v[44:47], v[220:223], a[76:79]
    s_waitcnt lgkmcnt(2)
    ds_read_b64_tr_b16 v[44:45], v19 offset:49152
    ds_read_b64_tr_b16 v[46:47], v19 offset:53248
    v_mfma_f32_16x16x32_bf16 a[80:83], v[32:35], v[188:191], a[80:83]
    v_exp_f32 v124, v124
    v_mfma_f32_16x16x32_bf16 a[84:87], v[32:35], v[196:199], a[84:87]
    s_waitcnt vmcnt(4)
    v_cvt_pk_bf16_f32 v159, v118, v119
    v_mfma_f32_16x16x32_bf16 a[88:91], v[32:35], v[204:207], a[88:91]
    buffer_load_dwordx4 v24, s[8:11], s27 offen offset:2048 nt lds
    v_exp_f32 v125, v125
    v_mfma_f32_16x16x32_bf16 a[92:95], v[32:35], v[212:215], a[92:95]
    v_exp_f32 v126, v126
    v_mfma_f32_16x16x32_bf16 a[96:99], v[32:35], v[220:223], a[96:99]
    v_cvt_pk_bf16_f32 v166, v124, v125
    v_mfma_f32_16x16x32_bf16 a[176:179], a[180:183], v[220:223], a[176:179]
    v_exp_f32 v127, v127
    v_mfma_f32_16x16x32_bf16 a[100:103], v[36:39], v[188:191], a[100:103]
    v_exp_f32 v132, v132
    v_mfma_f32_16x16x32_bf16 a[104:107], v[36:39], v[196:199], a[104:107]
    s_waitcnt lgkmcnt(0)
    s_waitcnt vmcnt(15)
    s_barrier
    v_mfma_f32_16x16x32_bf16 a[108:111], v[36:39], v[204:207], a[108:111]
    ds_read_b128 a[184:187], v8 offset:16384
    v_cvt_pk_bf16_f32 v167, v126, v127
    v_mfma_f32_16x16x32_bf16 a[112:115], v[36:39], v[212:215], a[112:115]
    v_exp_f32 v133, v133
    v_mfma_f32_16x16x32_bf16 a[116:119], v[36:39], v[220:223], a[116:119]
    ds_read_b128 a[188:191], v9 offset:16384
    v_mfma_f32_16x16x32_bf16 a[120:123], v[40:43], v[188:191], a[120:123]
    v_exp_f32 v134, v134
    v_mfma_f32_16x16x32_bf16 a[124:127], v[40:43], v[196:199], a[124:127]
    ds_read_b128 a[192:195], v10 offset:16384
    s_cbranch_vccnz L_t3_7
    s_waitcnt vmcnt(4)
L_t3_7:
    s_sub_u32 s28, s28, 1
    v_mfma_f32_16x16x32_bf16 a[128:131], v[40:43], v[204:207], a[128:131]
    buffer_load_dwordx4 v25, s[8:11], s27 offen offset:3072 nt lds
    v_cvt_pk_bf16_f32 v174, v132, v133
    v_mfma_f32_16x16x32_bf16 a[132:135], v[40:43], v[212:215], a[132:135]
    ds_read_b128 a[196:199], v11 offset:16384
    s_add_u32 s27, s27, 8192
    v_mfma_f32_16x16x32_bf16 a[136:139], v[40:43], v[220:223], a[136:139]
    s_cmp_le_u32 s28, s37
    s_cselect_b64 vcc, 1, vcc
    v_exp_f32 v135, v135
    v_mfma_f32_16x16x32_bf16 a[140:143], v[44:47], v[188:191], a[140:143]
    v_exp_f32 v140, v140
    v_mfma_f32_16x16x32_bf16 a[144:147], v[44:47], v[196:199], a[144:147]
    v_cvt_pk_bf16_f32 v175, v134, v135
    v_mfma_f32_16x16x32_bf16 a[148:151], v[44:47], v[204:207], a[148:151]
    s_cmp_lg_u32 s28, 0
    v_exp_f32 v141, v141
    v_mfma_f32_16x16x32_bf16 a[152:155], v[44:47], v[212:215], a[152:155]
    v_exp_f32 v142, v142
    v_mfma_f32_16x16x32_bf16 a[156:159], v[44:47], v[220:223], a[156:159]
    s_waitcnt lgkmcnt(0)
    s_cbranch_scc1 L_loop
    v_mfma_f32_16x16x32_bf16 v[68:71], a[184:187], v[64:67], v[224:227]
    ds_read_b128 a[200:203], v8 offset:20480
    v_mfma_f32_16x16x32_bf16 v[68:71], a[188:191], v[104:107], v[68:71]
    s_add_u32 m0, s25, 114688
    v_mfma_f32_16x16x32_bf16 v[68:71], a[192:195], v[144:147], v[68:71]
    buffer_load_dwordx4 v24, s[8:11], s27 offen offset:0 nt lds
    v_mfma_f32_16x16x32_bf16 v[68:71], a[196:199], v[184:187], v[68:71]
    ds_read_b128 a[204:207], v9 offset:20480
    v_mfma_f32_16x16x32_bf16 v[76:79], a[184:187], v[72:75], v[228:231]
    v_cvt_pk_bf16_f32 v182, v140, v141
    v_mfma_f32_16x16x32_bf16 v[76:79], a[188:191], v[112:115], v[76:79]
    v_exp_f32 v143, v143
    v_mfma_f32_16x16x32_bf16 v[76:79], a[192:195], v[152:155], v[76:79]
    ds_read_b128 a[208:211], v10 offset:20480
    v_cvt_pk_bf16_f32 v183, v142, v143
    v_mfma_f32_16x16x32_bf16 v[76:79], a[196:199], v[192:195], v[76:79]
    v_exp_f32 v68, v68
    v_mfma_f32_16x16x32_bf16 v[84:87], a[184:187], v[80:83], v[232:235]
    v_exp_f32 v69, v69
    v_mfma_f32_16x16x32_bf16 v[84:87], a[188:191], v[120:123], v[84:87]
    ds_read_b128 a[212:215], v11 offset:20480
    v_mfma_f32_16x16x32_bf16 v[84:87], a[192:195], v[160:163], v[84:87]
    v_exp_f32 v70, v70
    v_mfma_f32_16x16x32_bf16 v[84:87], a[196:199], v[200:203], v[84:87]
    v_mfma_f32_16x16x32_bf16 v[92:95], a[184:187], v[88:91], v[236:239]
    buffer_load_dwordx4 v25, s[8:11], s27 offen offset:1024 nt lds
    v_mfma_f32_16x16x32_bf16 v[92:95], a[188:191], v[128:131], v[92:95]
    v_cvt_pk_bf16_f32 v188, v68, v69
    v_mfma_f32_16x16x32_bf16 v[92:95], a[192:195], v[168:171], v[92:95]
    v_exp_f32 v71, v71
    v_mfma_f32_16x16x32_bf16 v[92:95], a[196:199], v[208:211], v[92:95]
    v_exp_f32 v76, v76
    v_mfma_f32_16x16x32_bf16 v[100:103], a[184:187], v[96:99], v[240:243]
    v_cvt_pk_bf16_f32 v189, v70, v71
    v_mfma_f32_16x16x32_bf16 v[100:103], a[188:191], v[136:139], v[100:103]
    v_exp_f32 v77, v77
    v_mfma_f32_16x16x32_bf16 v[100:103], a[192:195], v[176:179], v[100:103]
    v_exp_f32 v78, v78
    v_mfma_f32_16x16x32_bf16 v[100:103], a[196:199], v[216:219], v[100:103]
    s_waitcnt lgkmcnt(0)
    v_cvt_pk_bf16_f32 v196, v76, v77
    v_mfma_f32_16x16x32_bf16 v[108:111], a[200:203], v[64:67], v[224:227]
    v_exp_f32 v79, v79
    v_mfma_f32_16x16x32_bf16 v[108:111], a[204:207], v[104:107], v[108:111]
    v_mfma_f32_16x16x32_bf16 v[108:111], a[208:211], v[144:147], v[108:111]
    buffer_load_dwordx4 v24, s[8:11], s27 offen offset:2048 nt lds
    v_mfma_f32_16x16x32_bf16 v[108:111], a[212:215], v[184:187], v[108:111]
    v_exp_f32 v84, v84
    v_mfma_f32_16x16x32_bf16 v[116:119], a[200:203], v[72:75], v[228:231]
    ds_read_b64_tr_b16 v[32:33], v12 offset:0
    ds_read_b64_tr_b16 v[34:35], v12 offset:4096
    v_mfma_f32_16x16x32_bf16 v[116:119], a[204:207], v[112:115], v[116:119]
    v_cvt_pk_bf16_f32 v197, v78, v79
    v_mfma_f32_16x16x32_bf16 v[116:119], a[208:211], v[152:155], v[116:119]
    v_exp_f32 v85, v85
    v_mfma_f32_16x16x32_bf16 v[116:119], a[212:215], v[192:195], v[116:119]
    v_exp_f32 v86, v86
    v_mfma_f32_16x16x32_bf16 v[124:127], a[200:203], v[80:83], v[232:235]
    v_cvt_pk_bf16_f32 v204, v84, v85
    v_exp_f32 v87, v87
    v_mfma_f32_16x16x32_bf16 v[124:127], a[204:207], v[120:123], v[124:127]
    ds_read_b64_tr_b16 v[36:37], v13 offset:0
    ds_read_b64_tr_b16 v[38:39], v13 offset:4096
    v_mfma_f32_16x16x32_bf16 v[124:127], a[208:211], v[160:163], v[124:127]
    v_exp_f32 v92, v92
    v_mfma_f32_16x16x32_bf16 v[124:127], a[212:215], v[200:203], v[124:127]
    v_mfma_f32_16x16x32_bf16 v[132:135], a[200:203], v[88:91], v[236:239]
    buffer_load_dwordx4 v25, s[8:11], s27 offen offset:3072 nt lds
    v_mfma_f32_16x16x32_bf16 v[132:135], a[204:207], v[128:131], v[132:135]
    s_add_u32 s27, s27, 8192
    v_cvt_pk_bf16_f32 v205, v86, v87
    v_mfma_f32_16x16x32_bf16 v[132:135], a[208:211], v[168:171], v[132:135]
    ds_read_b64_tr_b16 v[40:41], v14 offset:0
    ds_read_b64_tr_b16 v[42:43], v14 offset:4096
    s_and_b32 s78, s24, 1
    s_lshr_b32 s79, s24, 1
    v_mfma_f32_16x16x32_bf16 v[132:135], a[212:215], v[208:211], v[132:135]
    v_exp_f32 v93, v93
    s_lshl_b32 s38, s32, 3
    s_add_u32 s38, s38, s31
    v_mfma_f32_16x16x32_bf16 v[140:143], a[200:203], v[96:99], v[240:243]
    v_exp_f32 v94, v94
    s_lshl_b32 s38, s38, 2
    s_add_u32 s38, s38, s59
    v_mfma_f32_16x16x32_bf16 v[140:143], a[204:207], v[136:139], v[140:143]
    v_cvt_pk_bf16_f32 v212, v92, v93
    s_mul_i32 s38, s38, 327680
    s_mul_i32 s39, s79, 20480
    s_mul_i32 s40, s78, 5120
    v_mfma_f32_16x16x32_bf16 v[140:143], a[208:211], v[176:179], v[140:143]
    v_exp_f32 v95, v95
    s_add_u32 s39, s39, s40
    s_add_u32 s38, s38, s39
    v_mfma_f32_16x16x32_bf16 v[140:143], a[212:215], v[216:219], v[140:143]
    s_waitcnt lgkmcnt(2)
    ds_read_b64_tr_b16 v[44:45], v15 offset:0
    ds_read_b64_tr_b16 v[46:47], v15 offset:4096
    s_add_u32 s16, s74, s38
    s_addc_u32 s17, s75, 0
    v_mfma_f32_16x16x32_bf16 a[0:3], v[32:35], v[148:151], a[0:3]
    buffer_load_dword v244, v30, s[48:51], 0 offen sc1
    v_exp_f32 v100, v100
    s_sub_u32 s18, 327680, s39
    v_mfma_f32_16x16x32_bf16 a[160:163], a[180:183], v[148:151], a[160:163]
    v_cvt_pk_bf16_f32 v213, v94, v95
    s_mov_b32 s19, 0x20000
    s_lshl_b32 s40, s24, 15
    s_lshl_b32 s35, s24, 13
    v_mfma_f32_16x16x32_bf16 a[4:7], v[32:35], v[156:159], a[4:7]
    s_mov_b32 s38, s3
    s_lshl_b32 s38, s38, 1
    s_add_u32 s38, s38, 0
    s_mov_b32 s39, s38
    v_mfma_f32_16x16x32_bf16 a[8:11], v[32:35], v[164:167], a[8:11]
    s_mul_i32 s88, s39, 40960
    s_lshl_b32 s38, s38, 17
    s_add_u32 s80, s38, s40
    s_mov_b32 s38, s3
    v_mfma_f32_16x16x32_bf16 a[12:15], v[32:35], v[172:175], a[12:15]
    v_exp_f32 v101, v101
    s_lshl_b32 s38, s38, 1
    s_add_u32 s38, s38, 1
    v_mfma_f32_16x16x32_bf16 a[16:19], v[32:35], v[180:183], a[16:19]
    ds_read_b64_tr_b16 v[32:33], v16 offset:0
    ds_read_b64_tr_b16 v[34:35], v16 offset:4096
    s_mov_b32 s39, s38
    s_mul_i32 s89, s39, 40960
    v_mfma_f32_16x16x32_bf16 a[20:23], v[36:39], v[148:151], a[20:23]
    v_exp_f32 v102, v102
    s_lshl_b32 s38, s38, 17
    s_add_u32 s81, s38, s40
    v_mfma_f32_16x16x32_bf16 a[24:27], v[36:39], v[156:159], a[24:27]
    v_cvt_pk_bf16_f32 v220, v100, v101
    s_cmp_lt_u32 s3, 2
    s_cselect_b32 s38, 1, 2
    s_xor_b32 s38, s38, s3
    v_mfma_f32_16x16x32_bf16 a[164:167], a[180:183], v[156:159], a[164:167]
    v_exp_f32 v103, v103
    s_lshl_b32 s38, s38, 1
    s_add_u32 s38, s38, 0
    v_mfma_f32_16x16x32_bf16 a[28:31], v[36:39], v[164:167], a[28:31]
    v_exp_f32 v108, v108
    s_mov_b32 s39, s38
    s_mul_i32 s90, s39, 40960
    v_mfma_f32_16x16x32_bf16 a[32:35], v[36:39], v[172:175], a[32:35]
    v_cvt_pk_bf16_f32 v221, v102, v103
    v_exp_f32 v109, v109
    s_lshl_b32 s38, s38, 17
    v_mfma_f32_16x16x32_bf16 a[36:39], v[36:39], v[180:183], a[36:39]
    s_waitcnt lgkmcnt(2)
    ds_read_b64_tr_b16 v[36:37], v17 offset:0
    ds_read_b64_tr_b16 v[38:39], v17 offset:4096
    s_add_u32 s82, s38, s40
    v_mfma_f32_16x16x32_bf16 a[40:43], v[40:43], v[148:151], a[40:43]
    v_exp_f32 v110, v110
    s_cmp_lt_u32 s3, 2
    s_cselect_b32 s38, 1, 2
    v_mfma_f32_16x16x32_bf16 a[44:47], v[40:43], v[156:159], a[44:47]
    s_xor_b32 s38, s38, s3
    s_lshl_b32 s38, s38, 1
    s_add_u32 s38, s38, 1
    s_mov_b32 s39, s38
    v_mfma_f32_16x16x32_bf16 a[48:51], v[40:43], v[164:167], a[48:51]
    v_cvt_pk_bf16_f32 v190, v108, v109
    s_mul_i32 s91, s39, 40960
    s_lshl_b32 s38, s38, 17
    s_add_u32 s83, s38, s40
    v_mfma_f32_16x16x32_bf16 a[168:171], a[180:183], v[164:167], a[168:171]
    v_exp_f32 v111, v111
    s_cmp_lt_u32 s3, 2
    s_cselect_b32 s38, 2, 3
    v_mfma_f32_16x16x32_bf16 a[52:55], v[40:43], v[172:175], a[52:55]
    v_exp_f32 v116, v116
    s_xor_b32 s38, s38, s3
    s_lshl_b32 s38, s38, 1
    v_mfma_f32_16x16x32_bf16 a[56:59], v[40:43], v[180:183], a[56:59]
    ds_read_b64_tr_b16 v[40:41], v18 offset:0
    ds_read_b64_tr_b16 v[42:43], v18 offset:4096
    s_add_u32 s38, s38, 0
    s_mov_b32 s39, s38
    v_mfma_f32_16x16x32_bf16 a[60:63], v[44:47], v[148:151], a[60:63]
    v_cvt_pk_bf16_f32 v191, v110, v111
    s_mul_i32 s92, s39, 40960
    s_lshl_b32 s38, s38, 17
    s_add_u32 s84, s38, s40
    v_mfma_f32_16x16x32_bf16 a[64:67], v[44:47], v[156:159], a[64:67]
    v_exp_f32 v117, v117
    s_cmp_lt_u32 s3, 2
    s_cselect_b32 s38, 2, 3
    v_mfma_f32_16x16x32_bf16 a[68:71], v[44:47], v[164:167], a[68:71]
    v_exp_f32 v118, v118
    s_xor_b32 s38, s38, s3
    s_lshl_b32 s38, s38, 1
    v_mfma_f32_16x16x32_bf16 a[72:75], v[44:47], v[172:175], a[72:75]
    v_cvt_pk_bf16_f32 v198, v116, v117
    s_add_u32 s38, s38, 1
    s_mov_b32 s39, s38
    s_mul_i32 s93, s39, 40960
    v_mfma_f32_16x16x32_bf16 a[172:175], a[180:183], v[172:175], a[172:175]
    v_exp_f32 v119, v119
    s_lshl_b32 s38, s38, 17
    s_add_u32 s85, s38, s40
    v_mfma_f32_16x16x32_bf16 a[76:79], v[44:47], v[180:183], a[76:79]
    s_waitcnt lgkmcnt(2)
    ds_read_b64_tr_b16 v[44:45], v19 offset:0
    ds_read_b64_tr_b16 v[46:47], v19 offset:4096
    s_cmp_lt_u32 s3, 2
    s_cselect_b32 s38, 3, 1
    v_mfma_f32_16x16x32_bf16 a[80:83], v[32:35], v[148:151], a[80:83]
    v_exp_f32 v124, v124
    s_xor_b32 s38, s38, s3
    s_lshl_b32 s38, s38, 1
    v_mfma_f32_16x16x32_bf16 a[84:87], v[32:35], v[156:159], a[84:87]
    v_cvt_pk_bf16_f32 v199, v118, v119
    s_add_u32 s38, s38, 0
    s_mov_b32 s39, s38
    s_mul_i32 s94, s39, 40960
    v_mfma_f32_16x16x32_bf16 a[88:91], v[32:35], v[164:167], a[88:91]
    v_exp_f32 v125, v125
    s_lshl_b32 s38, s38, 17
    s_add_u32 s86, s38, s40
    v_mfma_f32_16x16x32_bf16 a[92:95], v[32:35], v[172:175], a[92:95]
    v_exp_f32 v126, v126
    s_cmp_lt_u32 s3, 2
    s_cselect_b32 s38, 3, 1
    s_xor_b32 s38, s38, s3
    v_mfma_f32_16x16x32_bf16 a[96:99], v[32:35], v[180:183], a[96:99]
    v_cvt_pk_bf16_f32 v206, v124, v125
    s_lshl_b32 s38, s38, 1
    s_add_u32 s38, s38, 1
    s_mov_b32 s39, s38
    s_mul_i32 s95, s39, 40960
    v_mfma_f32_16x16x32_bf16 a[176:179], a[180:183], v[180:183], a[176:179]
    v_exp_f32 v127, v127
    s_lshl_b32 s38, s38, 17
    s_add_u32 s87, s38, s40
    v_lshrrev_b32 v4, 4, v26
    v_mfma_f32_16x16x32_bf16 a[100:103], v[36:39], v[148:151], a[100:103]
    v_exp_f32 v132, v132
    v_and_b32 v5, 15, v26
    v_add_u32 v6, 0, v4
    v_lshlrev_b32 v6, 1, v6
    v_mfma_f32_16x16x32_bf16 a[104:107], v[36:39], v[156:159], a[104:107]
    s_waitcnt lgkmcnt(0)
    s_waitcnt vmcnt(13)
    s_barrier
    v_xor_b32 v6, v6, v5
    v_mfma_f32_16x16x32_bf16 a[108:111], v[36:39], v[164:167], a[108:111]
    ds_read_b128 a[184:187], v8 offset:32768
    v_cvt_pk_bf16_f32 v207, v126, v127
    v_lshlrev_b32 v6, 4, v6
    v_lshl_add_u32 v6, v4, 10, v6
    v_mfma_f32_16x16x32_bf16 a[112:115], v[36:39], v[172:175], a[112:115]
    v_exp_f32 v133, v133
    v_add_u32 v54, 0, v6
    v_add_u32 v6, 4, v4
    v_mfma_f32_16x16x32_bf16 a[116:119], v[36:39], v[180:183], a[116:119]
    ds_read_b128 a[188:191], v9 offset:32768
    v_lshlrev_b32 v6, 1, v6
    v_xor_b32 v6, v6, v5
    v_mfma_f32_16x16x32_bf16 a[120:123], v[40:43], v[148:151], a[120:123]
    v_exp_f32 v134, v134
    v_lshlrev_b32 v6, 4, v6
    v_lshl_add_u32 v6, v4, 10, v6
    v_mfma_f32_16x16x32_bf16 a[124:127], v[40:43], v[156:159], a[124:127]
    ds_read_b128 a[192:195], v10 offset:32768
    v_add_u32 v55, 3072, v6
    v_add_u32 v6, 0, v4
    v_lshlrev_b32 v6, 1, v6
    v_mfma_f32_16x16x32_bf16 a[128:131], v[40:43], v[164:167], a[128:131]
    v_cvt_pk_bf16_f32 v214, v132, v133
    v_xor_b32 v6, v6, v5
    v_lshlrev_b32 v6, 4, v6
    v_lshl_add_u32 v6, v4, 10, v6
    v_mfma_f32_16x16x32_bf16 a[132:135], v[40:43], v[172:175], a[132:135]
    ds_read_b128 a[196:199], v11 offset:32768
    v_add_u32 v56, 6144, v6
    v_add_u32 v6, 4, v4
    v_lshlrev_b32 v6, 1, v6
    v_mfma_f32_16x16x32_bf16 a[136:139], v[40:43], v[180:183], a[136:139]
    v_exp_f32 v135, v135
    v_xor_b32 v6, v6, v5
    v_lshlrev_b32 v6, 4, v6
    v_mfma_f32_16x16x32_bf16 a[140:143], v[44:47], v[148:151], a[140:143]
    v_exp_f32 v140, v140
    v_lshl_add_u32 v6, v4, 10, v6
    v_add_u32 v57, 9216, v6
    v_mfma_f32_16x16x32_bf16 a[144:147], v[44:47], v[156:159], a[144:147]
    v_cvt_pk_bf16_f32 v215, v134, v135
    s_add_u32 m0, s35, 131072
    s_nop 0
    buffer_load_dwordx4 v54, s[12:15], s80 offen offset:0 lds
    buffer_load_dwordx4 v55, s[12:15], s80 offen offset:1024 lds
    v_mfma_f32_16x16x32_bf16 a[148:151], v[44:47], v[164:167], a[148:151]
    v_exp_f32 v141, v141
    buffer_load_dwordx4 v56, s[12:15], s80 offen offset:2048 lds
    buffer_load_dwordx4 v57, s[12:15], s80 offen offset:3072 lds
    v_mfma_f32_16x16x32_bf16 a[152:155], v[44:47], v[172:175], a[152:155]
    v_exp_f32 v142, v142
    s_add_u32 s2, s80, 16384
    s_add_u32 m0, s35, 135168
    v_mfma_f32_16x16x32_bf16 a[156:159], v[44:47], v[180:183], a[156:159]
    s_waitcnt lgkmcnt(0)
    buffer_load_dwordx4 v54, s[12:15], s2 offen offset:0 lds
    buffer_load_dwordx4 v55, s[12:15], s2 offen offset:1024 lds
    buffer_load_dwordx4 v56, s[12:15], s2 offen offset:2048 lds
    buffer_load_dwordx4 v57, s[12:15], s2 offen offset:3072 lds
    v_mfma_f32_16x16x32_bf16 v[68:71], a[184:187], v[64:67], v[224:227]
    ds_read_b128 a[200:203], v8 offset:36864
    v_mfma_f32_16x16x32_bf16 v[68:71], a[188:191], v[104:107], v[68:71]
    s_add_u32 m0, s35, 0
    v_mfma_f32_16x16x32_bf16 v[68:71], a[192:195], v[144:147], v[68:71]
    buffer_load_dwordx4 v54, s[12:15], s81 offen offset:0 lds
    v_mfma_f32_16x16x32_bf16 v[68:71], a[196:199], v[184:187], v[68:71]
    ds_read_b128 a[204:207], v9 offset:36864
    v_mfma_f32_16x16x32_bf16 v[76:79], a[184:187], v[72:75], v[228:231]
    v_cvt_pk_bf16_f32 v222, v140, v141
    v_mfma_f32_16x16x32_bf16 v[76:79], a[188:191], v[112:115], v[76:79]
    v_exp_f32 v143, v143
    v_mfma_f32_16x16x32_bf16 v[76:79], a[192:195], v[152:155], v[76:79]
    ds_read_b128 a[208:211], v10 offset:36864
    v_cvt_pk_bf16_f32 v223, v142, v143
    v_mfma_f32_16x16x32_bf16 v[76:79], a[196:199], v[192:195], v[76:79]
    v_exp_f32 v68, v68
    v_mfma_f32_16x16x32_bf16 v[84:87], a[184:187], v[80:83], v[232:235]
    v_exp_f32 v69, v69
    v_mfma_f32_16x16x32_bf16 v[84:87], a[188:191], v[120:123], v[84:87]
    ds_read_b128 a[212:215], v11 offset:36864
    v_mfma_f32_16x16x32_bf16 v[84:87], a[192:195], v[160:163], v[84:87]
    v_exp_f32 v70, v70
    v_mfma_f32_16x16x32_bf16 v[84:87], a[196:199], v[200:203], v[84:87]
    v_mfma_f32_16x16x32_bf16 v[92:95], a[184:187], v[88:91], v[236:239]
    buffer_load_dwordx4 v55, s[12:15], s81 offen offset:1024 lds
    v_mfma_f32_16x16x32_bf16 v[92:95], a[188:191], v[128:131], v[92:95]
    v_cvt_pk_bf16_f32 v148, v68, v69
    v_mfma_f32_16x16x32_bf16 v[92:95], a[192:195], v[168:171], v[92:95]
    v_exp_f32 v71, v71
    v_mfma_f32_16x16x32_bf16 v[92:95], a[196:199], v[208:211], v[92:95]
    v_exp_f32 v76, v76
    v_mfma_f32_16x16x32_bf16 v[100:103], a[184:187], v[96:99], v[240:243]
    v_cvt_pk_bf16_f32 v149, v70, v71
    v_mfma_f32_16x16x32_bf16 v[100:103], a[188:191], v[136:139], v[100:103]
    v_exp_f32 v77, v77
    v_mfma_f32_16x16x32_bf16 v[100:103], a[192:195], v[176:179], v[100:103]
    v_exp_f32 v78, v78
    v_mfma_f32_16x16x32_bf16 v[100:103], a[196:199], v[216:219], v[100:103]
    s_waitcnt lgkmcnt(0)
    v_cvt_pk_bf16_f32 v156, v76, v77
    v_mfma_f32_16x16x32_bf16 v[108:111], a[200:203], v[64:67], v[224:227]
    v_exp_f32 v79, v79
    v_mfma_f32_16x16x32_bf16 v[108:111], a[204:207], v[104:107], v[108:111]
    v_mfma_f32_16x16x32_bf16 v[108:111], a[208:211], v[144:147], v[108:111]
    buffer_load_dwordx4 v56, s[12:15], s81 offen offset:2048 lds
    v_mfma_f32_16x16x32_bf16 v[108:111], a[212:215], v[184:187], v[108:111]
    v_exp_f32 v84, v84
    v_mfma_f32_16x16x32_bf16 v[116:119], a[200:203], v[72:75], v[228:231]
    ds_read_b64_tr_b16 v[32:33], v12 offset:16384
    ds_read_b64_tr_b16 v[34:35], v12 offset:20480
    v_mfma_f32_16x16x32_bf16 v[116:119], a[204:207], v[112:115], v[116:119]
    v_cvt_pk_bf16_f32 v157, v78, v79
    v_mfma_f32_16x16x32_bf16 v[116:119], a[208:211], v[152:155], v[116:119]
    v_exp_f32 v85, v85
    v_mfma_f32_16x16x32_bf16 v[116:119], a[212:215], v[192:195], v[116:119]
    v_exp_f32 v86, v86
    v_mfma_f32_16x16x32_bf16 v[124:127], a[200:203], v[80:83], v[232:235]
    v_cvt_pk_bf16_f32 v164, v84, v85
    v_exp_f32 v87, v87
    v_mfma_f32_16x16x32_bf16 v[124:127], a[204:207], v[120:123], v[124:127]
    ds_read_b64_tr_b16 v[36:37], v13 offset:16384
    ds_read_b64_tr_b16 v[38:39], v13 offset:20480
    v_mfma_f32_16x16x32_bf16 v[124:127], a[208:211], v[160:163], v[124:127]
    v_exp_f32 v92, v92
    v_mfma_f32_16x16x32_bf16 v[124:127], a[212:215], v[200:203], v[124:127]
    v_mfma_f32_16x16x32_bf16 v[132:135], a[200:203], v[88:91], v[236:239]
    buffer_load_dwordx4 v57, s[12:15], s81 offen offset:3072 lds
    v_mfma_f32_16x16x32_bf16 v[132:135], a[204:207], v[128:131], v[132:135]
    v_cvt_pk_bf16_f32 v165, v86, v87
    v_mfma_f32_16x16x32_bf16 v[132:135], a[208:211], v[168:171], v[132:135]
    ds_read_b64_tr_b16 v[40:41], v14 offset:16384
    ds_read_b64_tr_b16 v[42:43], v14 offset:20480
    v_mfma_f32_16x16x32_bf16 v[132:135], a[212:215], v[208:211], v[132:135]
    v_exp_f32 v93, v93
    v_mfma_f32_16x16x32_bf16 v[140:143], a[200:203], v[96:99], v[240:243]
    v_exp_f32 v94, v94
    v_mfma_f32_16x16x32_bf16 v[140:143], a[204:207], v[136:139], v[140:143]
    v_cvt_pk_bf16_f32 v172, v92, v93
    v_mfma_f32_16x16x32_bf16 v[140:143], a[208:211], v[176:179], v[140:143]
    v_exp_f32 v95, v95
    v_mfma_f32_16x16x32_bf16 v[140:143], a[212:215], v[216:219], v[140:143]
    s_waitcnt lgkmcnt(2)
    ds_read_b64_tr_b16 v[44:45], v15 offset:16384
    ds_read_b64_tr_b16 v[46:47], v15 offset:20480
    v_mfma_f32_16x16x32_bf16 a[0:3], v[32:35], v[188:191], a[0:3]
    v_exp_f32 v100, v100
    v_mfma_f32_16x16x32_bf16 a[160:163], a[180:183], v[188:191], a[160:163]
    s_add_u32 s2, s81, 16384
    v_cvt_pk_bf16_f32 v173, v94, v95
    v_mfma_f32_16x16x32_bf16 a[4:7], v[32:35], v[196:199], a[4:7]
    s_add_u32 m0, s35, 4096
    v_mfma_f32_16x16x32_bf16 a[8:11], v[32:35], v[204:207], a[8:11]
    buffer_load_dwordx4 v54, s[12:15], s2 offen offset:0 lds
    v_mfma_f32_16x16x32_bf16 a[12:15], v[32:35], v[212:215], a[12:15]
    v_exp_f32 v101, v101
    v_lshlrev_b32 v58, 4, v26
    v_mfma_f32_16x16x32_bf16 a[16:19], v[32:35], v[220:223], a[16:19]
    ds_read_b64_tr_b16 v[32:33], v16 offset:16384
    ds_read_b64_tr_b16 v[34:35], v16 offset:20480
    v_add_u32 v59, 4096, v58
    v_mfma_f32_16x16x32_bf16 a[20:23], v[36:39], v[188:191], a[20:23]
    v_exp_f32 v102, v102
    v_add_u32 v60, 10240, v58
    v_add_u32 v61, 14336, v58
    v_mfma_f32_16x16x32_bf16 a[24:27], v[36:39], v[196:199], a[24:27]
    v_cvt_pk_bf16_f32 v180, v100, v101
    v_lshlrev_b32 v5, 11, v5
    v_lshl_add_u32 v50, v4, 3, v5
    s_xor_b32 s41, s24, 2
    v_mfma_f32_16x16x32_bf16 a[164:167], a[180:183], v[196:199], a[164:167]
    v_exp_f32 v103, v103
    s_mul_i32 s38, s24, 20480
    s_add_u32 s38, s38, 65536
    v_mfma_f32_16x16x32_bf16 a[28:31], v[36:39], v[204:207], a[28:31]
    v_exp_f32 v108, v108
    s_cmp_eq_u32 s24, 3
    s_cselect_b32 s38, 126976, s38
    v_mfma_f32_16x16x32_bf16 a[32:35], v[36:39], v[212:215], a[32:35]
    v_cvt_pk_bf16_f32 v181, v102, v103
    v_exp_f32 v109, v109
    v_mfma_f32_16x16x32_bf16 a[36:39], v[36:39], v[220:223], a[36:39]
    s_waitcnt lgkmcnt(2)
    ds_read_b64_tr_b16 v[36:37], v17 offset:16384
    ds_read_b64_tr_b16 v[38:39], v17 offset:20480
    v_add_u32 v48, s38, v58
    v_mfma_f32_16x16x32_bf16 a[40:43], v[40:43], v[188:191], a[40:43]
    v_exp_f32 v110, v110
    s_xor_b32 s41, s24, 2
    s_mul_i32 s38, s41, 20480
    v_mfma_f32_16x16x32_bf16 a[44:47], v[40:43], v[196:199], a[44:47]
    s_add_u32 s38, s38, 65536
    s_cmp_eq_u32 s41, 3
    s_cselect_b32 s38, 126976, s38
    v_mfma_f32_16x16x32_bf16 a[48:51], v[40:43], v[204:207], a[48:51]
    buffer_load_dwordx4 v55, s[12:15], s2 offen offset:1024 lds
    v_cvt_pk_bf16_f32 v150, v108, v109
    v_add_u32 v49, s38, v58
    v_mfma_f32_16x16x32_bf16 a[168:171], a[180:183], v[204:207], a[168:171]
    v_exp_f32 v111, v111
    v_lshrrev_b32 v6, 4, v26
    v_mfma_f32_16x16x32_bf16 a[52:55], v[40:43], v[212:215], a[52:55]
    v_exp_f32 v116, v116
    v_bfe_u32 v4, v26, 2, 2
    v_mfma_f32_16x16x32_bf16 a[56:59], v[40:43], v[220:223], a[56:59]
    ds_read_b64_tr_b16 v[40:41], v18 offset:16384
    ds_read_b64_tr_b16 v[42:43], v18 offset:20480
    v_lshl_add_u32 v6, v6, 2, v4
    v_and_b32 v4, 3, v26
    v_mfma_f32_16x16x32_bf16 a[60:63], v[44:47], v[188:191], a[60:63]
    v_cvt_pk_bf16_f32 v151, v110, v111
    v_lshlrev_b32 v4, 3, v4
    v_lshl_add_u32 v4, v6, 8, v4
    s_lshr_b32 s38, s24, 1
    v_mfma_f32_16x16x32_bf16 a[64:67], v[44:47], v[196:199], a[64:67]
    v_exp_f32 v117, v117
    s_lshl_b32 s39, s38, 2
    s_add_u32 s39, s39, s59
    v_mfma_f32_16x16x32_bf16 a[68:71], v[44:47], v[204:207], a[68:71]
    v_exp_f32 v118, v118
    s_mul_i32 s38, s38, 4294836224
    s_add_u32 s38, s38, 131072
    v_mfma_f32_16x16x32_bf16 a[72:75], v[44:47], v[212:215], a[72:75]
    v_cvt_pk_bf16_f32 v158, v116, v117
    v_add_u32 v4, s38, v4
    v_and_b32 v6, 7, v6
    v_xor_b32 v6, s39, v6
    v_mfma_f32_16x16x32_bf16 a[172:175], a[180:183], v[212:215], a[172:175]
    v_exp_f32 v119, v119
    v_xor_b32 v5, 0, v6
    v_lshl_add_u32 v246, v5, 5, v4
    v_mfma_f32_16x16x32_bf16 a[76:79], v[44:47], v[220:223], a[76:79]
    s_waitcnt lgkmcnt(2)
    ds_read_b64_tr_b16 v[44:45], v19 offset:16384
    ds_read_b64_tr_b16 v[46:47], v19 offset:20480
    v_xor_b32 v5, 1, v6
    v_mfma_f32_16x16x32_bf16 a[80:83], v[32:35], v[188:191], a[80:83]
    v_exp_f32 v124, v124
    v_lshl_add_u32 v247, v5, 5, v4
    v_xor_b32 v5, 2, v6
    v_mfma_f32_16x16x32_bf16 a[84:87], v[32:35], v[196:199], a[84:87]
    v_cvt_pk_bf16_f32 v159, v118, v119
    v_lshl_add_u32 v248, v5, 5, v4
    v_xor_b32 v5, 3, v6
    v_lshl_add_u32 v249, v5, 5, v4
    v_mfma_f32_16x16x32_bf16 a[88:91], v[32:35], v[204:207], a[88:91]
    buffer_load_dwordx4 v56, s[12:15], s2 offen offset:2048 lds
    v_exp_f32 v125, v125
    v_xor_b32 v5, 4, v6
    v_mfma_f32_16x16x32_bf16 a[92:95], v[32:35], v[212:215], a[92:95]
    v_exp_f32 v126, v126
    v_lshl_add_u32 v250, v5, 5, v4
    v_xor_b32 v5, 5, v6
    v_mfma_f32_16x16x32_bf16 a[96:99], v[32:35], v[220:223], a[96:99]
    v_cvt_pk_bf16_f32 v166, v124, v125
    v_lshl_add_u32 v251, v5, 5, v4
    v_xor_b32 v5, 6, v6
    v_mfma_f32_16x16x32_bf16 a[176:179], a[180:183], v[220:223], a[176:179]
    v_exp_f32 v127, v127
    v_lshl_add_u32 v252, v5, 5, v4
    v_mfma_f32_16x16x32_bf16 a[100:103], v[36:39], v[188:191], a[100:103]
    v_exp_f32 v132, v132
    v_xor_b32 v5, 7, v6
    v_mfma_f32_16x16x32_bf16 a[104:107], v[36:39], v[196:199], a[104:107]
    s_waitcnt lgkmcnt(0)
    s_waitcnt vmcnt(20)
    s_barrier
    v_mfma_f32_16x16x32_bf16 a[108:111], v[36:39], v[204:207], a[108:111]
    ds_read_b128 a[184:187], v8 offset:49152
    v_cvt_pk_bf16_f32 v167, v126, v127
    v_lshl_add_u32 v253, v5, 5, v4
    v_mfma_f32_16x16x32_bf16 a[112:115], v[36:39], v[212:215], a[112:115]
    v_exp_f32 v133, v133
    s_lshl_b32 s38, s3, 2
    v_mfma_f32_16x16x32_bf16 a[116:119], v[36:39], v[220:223], a[116:119]
    ds_read_b128 a[188:191], v9 offset:49152
    s_add_u32 s38, s38, s24
    v_mfma_f32_16x16x32_bf16 a[120:123], v[40:43], v[188:191], a[120:123]
    v_exp_f32 v134, v134
    s_lshl_b32 s38, s38, 2
    v_mfma_f32_16x16x32_bf16 a[124:127], v[40:43], v[196:199], a[124:127]
    ds_read_b128 a[192:195], v10 offset:49152
    v_readfirstlane_b32 s39, v28
    s_nop 1
    s_add_u32 s38, s38, s39
    v_mfma_f32_16x16x32_bf16 a[128:131], v[40:43], v[204:207], a[128:131]
    buffer_load_dwordx4 v57, s[12:15], s2 offen offset:3072 lds
    v_cvt_pk_bf16_f32 v174, v132, v133
    v_lshl_add_u32 v51, v26, 16, s38
    v_mfma_f32_16x16x32_bf16 a[132:135], v[40:43], v[212:215], a[132:135]
    ds_read_b128 a[196:199], v11 offset:49152
    s_lshl_b32 s38, s59, 2
    s_add_u32 s38, s38, s24
    v_mfma_f32_16x16x32_bf16 a[136:139], v[40:43], v[220:223], a[136:139]
    v_exp_f32 v135, v135
    s_lshl_b32 s38, s38, 2
    v_mfma_f32_16x16x32_bf16 a[140:143], v[44:47], v[188:191], a[140:143]
    v_exp_f32 v140, v140
    v_readfirstlane_b32 s39, v29
    v_mfma_f32_16x16x32_bf16 a[144:147], v[44:47], v[196:199], a[144:147]
    v_cvt_pk_bf16_f32 v175, v134, v135
    s_add_u32 s38, s38, s39
    v_lshl_add_u32 v52, v26, 16, s38
    v_mfma_f32_16x16x32_bf16 a[148:151], v[44:47], v[204:207], a[148:151]
    v_exp_f32 v141, v141
    s_mov_b32 s76, 0
    v_mfma_f32_16x16x32_bf16 a[152:155], v[44:47], v[212:215], a[152:155]
    v_exp_f32 v142, v142
    s_mov_b32 s77, 10240
    v_mfma_f32_16x16x32_bf16 a[156:159], v[44:47], v[220:223], a[156:159]
    s_waitcnt lgkmcnt(0)
    s_mov_b32 s78, 20480
    s_mov_b32 s79, 30720
    s_waitcnt vmcnt(16)
    v_readlane_b32 s38, v244, 0
    v_readlane_b32 s39, v244, 1
    s_nop 0
    s_and_b32 s38, s38, 0xffff
    s_lshr_b32 s39, s39, 16
    s_min_u32 s38, s38, s39
    s_cmp_lt_u32 s38, 4
    s_cbranch_scc1 L_spin_d
L_back_d:
    v_mfma_f32_16x16x32_bf16 v[68:71], a[184:187], v[64:67], v[224:227]
    ds_read_b128 a[200:203], v8 offset:53248
    v_mfma_f32_16x16x32_bf16 v[68:71], a[188:191], v[104:107], v[68:71]
    s_add_u32 m0, s35, 65536
    v_mfma_f32_16x16x32_bf16 v[68:71], a[192:195], v[144:147], v[68:71]
    buffer_load_dwordx4 v54, s[12:15], s82 offen offset:0 lds
    v_mfma_f32_16x16x32_bf16 v[68:71], a[196:199], v[184:187], v[68:71]
    ds_read_b128 a[204:207], v9 offset:53248
    v_mfma_f32_16x16x32_bf16 v[76:79], a[184:187], v[72:75], v[228:231]
    v_cvt_pk_bf16_f32 v182, v140, v141
    v_mfma_f32_16x16x32_bf16 v[76:79], a[188:191], v[112:115], v[76:79]
    v_exp_f32 v143, v143
    v_mfma_f32_16x16x32_bf16 v[76:79], a[192:195], v[152:155], v[76:79]
    ds_read_b128 a[208:211], v10 offset:53248
    v_cvt_pk_bf16_f32 v183, v142, v143
    v_mfma_f32_16x16x32_bf16 v[76:79], a[196:199], v[192:195], v[76:79]
    v_exp_f32 v68, v68
    v_mfma_f32_16x16x32_bf16 v[84:87], a[184:187], v[80:83], v[232:235]
    v_exp_f32 v69, v69
    v_mfma_f32_16x16x32_bf16 v[84:87], a[188:191], v[120:123], v[84:87]
    ds_read_b128 a[212:215], v11 offset:53248
    v_mfma_f32_16x16x32_bf16 v[84:87], a[192:195], v[160:163], v[84:87]
    v_exp_f32 v70, v70
    v_mfma_f32_16x16x32_bf16 v[84:87], a[196:199], v[200:203], v[84:87]
    v_mfma_f32_16x16x32_bf16 v[92:95], a[184:187], v[88:91], v[236:239]
    buffer_load_dwordx4 v55, s[12:15], s82 offen offset:1024 lds
    v_mfma_f32_16x16x32_bf16 v[92:95], a[188:191], v[128:131], v[92:95]
    v_cvt_pk_bf16_f32 v188, v68, v69
    v_mfma_f32_16x16x32_bf16 v[92:95], a[192:195], v[168:171], v[92:95]
    v_exp_f32 v71, v71
    v_mfma_f32_16x16x32_bf16 v[92:95], a[196:199], v[208:211], v[92:95]
    v_exp_f32 v76, v76
    v_mfma_f32_16x16x32_bf16 v[100:103], a[184:187], v[96:99], v[240:243]
    v_cvt_pk_bf16_f32 v189, v70, v71
    v_mfma_f32_16x16x32_bf16 v[100:103], a[188:191], v[136:139], v[100:103]
    v_exp_f32 v77, v77
    v_mfma_f32_16x16x32_bf16 v[100:103], a[192:195], v[176:179], v[100:103]
    v_exp_f32 v78, v78
    v_mfma_f32_16x16x32_bf16 v[100:103], a[196:199], v[216:219], v[100:103]
    s_waitcnt lgkmcnt(0)
    v_cvt_pk_bf16_f32 v196, v76, v77
    v_mfma_f32_16x16x32_bf16 v[108:111], a[200:203], v[64:67], v[224:227]
    v_exp_f32 v79, v79
    v_mfma_f32_16x16x32_bf16 v[108:111], a[204:207], v[104:107], v[108:111]
    v_mfma_f32_16x16x32_bf16 v[108:111], a[208:211], v[144:147], v[108:111]
    buffer_load_dwordx4 v56, s[12:15], s82 offen offset:2048 lds
    v_mfma_f32_16x16x32_bf16 v[108:111], a[212:215], v[184:187], v[108:111]
    v_exp_f32 v84, v84
    v_mfma_f32_16x16x32_bf16 v[116:119], a[200:203], v[72:75], v[228:231]
    ds_read_b64_tr_b16 v[32:33], v12 offset:32768
    ds_read_b64_tr_b16 v[34:35], v12 offset:36864
    v_mfma_f32_16x16x32_bf16 v[116:119], a[204:207], v[112:115], v[116:119]
    v_cvt_pk_bf16_f32 v197, v78, v79
    v_mfma_f32_16x16x32_bf16 v[116:119], a[208:211], v[152:155], v[116:119]
    v_exp_f32 v85, v85
    v_mfma_f32_16x16x32_bf16 v[116:119], a[212:215], v[192:195], v[116:119]
    v_exp_f32 v86, v86
    v_mfma_f32_16x16x32_bf16 v[124:127], a[200:203], v[80:83], v[232:235]
    v_cvt_pk_bf16_f32 v204, v84, v85
    v_exp_f32 v87, v87
    v_mfma_f32_16x16x32_bf16 v[124:127], a[204:207], v[120:123], v[124:127]
    ds_read_b64_tr_b16 v[36:37], v13 offset:32768
    ds_read_b64_tr_b16 v[38:39], v13 offset:36864
    v_mfma_f32_16x16x32_bf16 v[124:127], a[208:211], v[160:163], v[124:127]
    v_exp_f32 v92, v92
    v_mfma_f32_16x16x32_bf16 v[124:127], a[212:215], v[200:203], v[124:127]
    v_mfma_f32_16x16x32_bf16 v[132:135], a[200:203], v[88:91], v[236:239]
    buffer_load_dwordx4 v57, s[12:15], s82 offen offset:3072 lds
    v_mfma_f32_16x16x32_bf16 v[132:135], a[204:207], v[128:131], v[132:135]
    v_cvt_pk_bf16_f32 v205, v86, v87
    v_mfma_f32_16x16x32_bf16 v[132:135], a[208:211], v[168:171], v[132:135]
    ds_read_b64_tr_b16 v[40:41], v14 offset:32768
    ds_read_b64_tr_b16 v[42:43], v14 offset:36864
    v_mfma_f32_16x16x32_bf16 v[132:135], a[212:215], v[208:211], v[132:135]
    v_exp_f32 v93, v93
    v_mfma_f32_16x16x32_bf16 v[140:143], a[200:203], v[96:99], v[240:243]
    v_exp_f32 v94, v94
    v_mfma_f32_16x16x32_bf16 v[140:143], a[204:207], v[136:139], v[140:143]
    v_cvt_pk_bf16_f32 v212, v92, v93
    v_mfma_f32_16x16x32_bf16 v[140:143], a[208:211], v[176:179], v[140:143]
    v_exp_f32 v95, v95
    v_mfma_f32_16x16x32_bf16 v[140:143], a[212:215], v[216:219], v[140:143]
    s_waitcnt lgkmcnt(2)
    ds_read_b64_tr_b16 v[44:45], v15 offset:32768
    ds_read_b64_tr_b16 v[46:47], v15 offset:36864
    v_mfma_f32_16x16x32_bf16 a[0:3], v[32:35], v[148:151], a[0:3]
    v_exp_f32 v100, v100
    v_mfma_f32_16x16x32_bf16 a[160:163], a[180:183], v[148:151], a[160:163]
    s_add_u32 s2, s82, 16384
    v_cvt_pk_bf16_f32 v213, v94, v95
    v_mfma_f32_16x16x32_bf16 a[4:7], v[32:35], v[156:159], a[4:7]
    s_add_u32 m0, s35, 69632
    v_mfma_f32_16x16x32_bf16 a[8:11], v[32:35], v[164:167], a[8:11]
    buffer_load_dwordx4 v54, s[12:15], s2 offen offset:0 lds
    v_mfma_f32_16x16x32_bf16 a[12:15], v[32:35], v[172:175], a[12:15]
    v_exp_f32 v101, v101
    v_mfma_f32_16x16x32_bf16 a[16:19], v[32:35], v[180:183], a[16:19]
    ds_read_b64_tr_b16 v[32:33], v16 offset:32768
    ds_read_b64_tr_b16 v[34:35], v16 offset:36864
    v_mfma_f32_16x16x32_bf16 a[20:23], v[36:39], v[148:151], a[20:23]
    v_exp_f32 v102, v102
    v_mfma_f32_16x16x32_bf16 a[24:27], v[36:39], v[156:159], a[24:27]
    v_cvt_pk_bf16_f32 v220, v100, v101
    v_mfma_f32_16x16x32_bf16 a[164:167], a[180:183], v[156:159], a[164:167]
    v_exp_f32 v103, v103
    v_mfma_f32_16x16x32_bf16 a[28:31], v[36:39], v[164:167], a[28:31]
    v_exp_f32 v108, v108
    v_mfma_f32_16x16x32_bf16 a[32:35], v[36:39], v[172:175], a[32:35]
    v_cvt_pk_bf16_f32 v221, v102, v103
    v_exp_f32 v109, v109
    v_mfma_f32_16x16x32_bf16 a[36:39], v[36:39], v[180:183], a[36:39]
    s_waitcnt lgkmcnt(2)
    ds_read_b64_tr_b16 v[36:37], v17 offset:32768
    ds_read_b64_tr_b16 v[38:39], v17 offset:36864
    v_mfma_f32_16x16x32_bf16 a[40:43], v[40:43], v[148:151], a[40:43]
    v_exp_f32 v110, v110
    v_mfma_f32_16x16x32_bf16 a[44:47], v[40:43], v[156:159], a[44:47]
    v_mfma_f32_16x16x32_bf16 a[48:51], v[40:43], v[164:167], a[48:51]
    buffer_load_dwordx4 v55, s[12:15], s2 offen offset:1024 lds
    v_cvt_pk_bf16_f32 v190, v108, v109
    v_mfma_f32_16x16x32_bf16 a[168:171], a[180:183], v[164:167], a[168:171]
    v_exp_f32 v111, v111
    v_mfma_f32_16x16x32_bf16 a[52:55], v[40:43], v[172:175], a[52:55]
    v_exp_f32 v116, v116
    v_mfma_f32_16x16x32_bf16 a[56:59], v[40:43], v[180:183], a[56:59]
    ds_read_b64_tr_b16 v[40:41], v18 offset:32768
    ds_read_b64_tr_b16 v[42:43], v18 offset:36864
    v_mfma_f32_16x16x32_bf16 a[60:63], v[44:47], v[148:151], a[60:63]
    v_cvt_pk_bf16_f32 v191, v110, v111
    v_mfma_f32_16x16x32_bf16 a[64:67], v[44:47], v[156:159], a[64:67]
    v_exp_f32 v117, v117
    v_mfma_f32_16x16x32_bf16 a[68:71], v[44:47], v[164:167], a[68:71]
    v_exp_f32 v118, v118
    v_mfma_f32_16x16x32_bf16 a[72:75], v[44:47], v[172:175], a[72:75]
    v_cvt_pk_bf16_f32 v198, v116, v117
    v_mfma_f32_16x16x32_bf16 a[172:175], a[180:183], v[172:175], a[172:175]
    v_exp_f32 v119, v119
    v_mfma_f32_16x16x32_bf16 a[76:79], v[44:47], v[180:183], a[76:79]
    s_waitcnt lgkmcnt(2)
    ds_read_b64_tr_b16 v[44:45], v19 offset:32768
    ds_read_b64_tr_b16 v[46:47], v19 offset:36864
    v_mfma_f32_16x16x32_bf16 a[80:83], v[32:35], v[148:151], a[80:83]
    v_exp_f32 v124, v124
    v_mfma_f32_16x16x32_bf16 a[84:87], v[32:35], v[156:159], a[84:87]
    v_cvt_pk_bf16_f32 v199, v118, v119
    v_mfma_f32_16x16x32_bf16 a[88:91], v[32:35], v[164:167], a[88:91]
    buffer_load_dwordx4 v56, s[12:15], s2 offen offset:2048 lds
    v_exp_f32 v125, v125
    v_mfma_f32_16x16x32_bf16 a[92:95], v[32:35], v[172:175], a[92:95]
    v_exp_f32 v126, v126
    v_mfma_f32_16x16x32_bf16 a[96:99], v[32:35], v[180:183], a[96:99]
    v_cvt_pk_bf16_f32 v206, v124, v125
    v_mfma_f32_16x16x32_bf16 a[176:179], a[180:183], v[180:183], a[176:179]
    v_exp_f32 v127, v127
    v_mfma_f32_16x16x32_bf16 a[100:103], v[36:39], v[148:151], a[100:103]
    v_exp_f32 v132, v132
    v_mfma_f32_16x16x32_bf16 a[104:107], v[36:39], v[156:159], a[104:107]
    s_waitcnt lgkmcnt(0)
    s_barrier
    v_mfma_f32_16x16x32_bf16 a[108:111], v[36:39], v[164:167], a[108:111]
    ds_read_b64_tr_b16 v[32:33], v12 offset:49152
    ds_read_b64_tr_b16 v[34:35], v12 offset:53248
    v_cvt_pk_bf16_f32 v207, v126, v127
    v_mfma_f32_16x16x32_bf16 a[112:115], v[36:39], v[172:175], a[112:115]
    v_exp_f32 v133, v133
    v_mfma_f32_16x16x32_bf16 a[116:119], v[36:39], v[180:183], a[116:119]
    ds_read_b64_tr_b16 v[36:37], v13 offset:49152
    ds_read_b64_tr_b16 v[38:39], v13 offset:53248
    v_mfma_f32_16x16x32_bf16 a[120:123], v[40:43], v[148:151], a[120:123]
    v_exp_f32 v134, v134
    v_mfma_f32_16x16x32_bf16 a[124:127], v[40:43], v[156:159], a[124:127]
    v_mfma_f32_16x16x32_bf16 a[128:131], v[40:43], v[164:167], a[128:131]
    buffer_load_dwordx4 v57, s[12:15], s2 offen offset:3072 lds
    v_cvt_pk_bf16_f32 v214, v132, v133
    v_mfma_f32_16x16x32_bf16 a[132:135], v[40:43], v[172:175], a[132:135]
    v_mfma_f32_16x16x32_bf16 a[136:139], v[40:43], v[180:183], a[136:139]
    ds_read_b64_tr_b16 v[40:41], v14 offset:49152
    ds_read_b64_tr_b16 v[42:43], v14 offset:53248
    v_exp_f32 v135, v135
    v_mfma_f32_16x16x32_bf16 a[140:143], v[44:47], v[148:151], a[140:143]
    v_exp_f32 v140, v140
    v_mfma_f32_16x16x32_bf16 a[144:147], v[44:47], v[156:159], a[144:147]
    v_cvt_pk_bf16_f32 v215, v134, v135
    v_mfma_f32_16x16x32_bf16 a[148:151], v[44:47], v[164:167], a[148:151]
    v_exp_f32 v141, v141
    v_mfma_f32_16x16x32_bf16 a[152:155], v[44:47], v[172:175], a[152:155]
    v_exp_f32 v142, v142
    v_mfma_f32_16x16x32_bf16 a[156:159], v[44:47], v[180:183], a[156:159]
    v_cvt_pk_bf16_f32 v222, v140, v141
    v_exp_f32 v143, v143
    s_nop 0
    v_cvt_pk_bf16_f32 v223, v142, v143
    v_mfma_f32_16x16x32_bf16 a[160:163], a[180:183], v[188:191], a[160:163]
    v_mfma_f32_16x16x32_bf16 a[164:167], a[180:183], v[196:199], a[164:167]
    v_mfma_f32_16x16x32_bf16 a[168:171], a[180:183], v[204:207], a[168:171]
    v_mfma_f32_16x16x32_bf16 a[172:175], a[180:183], v[212:215], a[172:175]
    v_mfma_f32_16x16x32_bf16 a[176:179], a[180:183], v[220:223], a[176:179]
    s_waitcnt lgkmcnt(4)
    v_mfma_f32_16x16x32_bf16 a[0:3], v[32:35], v[188:191], a[0:3]
    v_mfma_f32_16x16x32_bf16 a[4:7], v[32:35], v[196:199], a[4:7]
    v_mfma_f32_16x16x32_bf16 a[8:11], v[32:35], v[204:207], a[8:11]
    v_accvgpr_read_b32 v233, a160
    v_accvgpr_read_b32 v234, a164
    v_accvgpr_read_b32 v235, a168
    v_mfma_f32_16x16x32_bf16 a[12:15], v[32:35], v[212:215], a[12:15]
    v_accvgpr_read_b32 v236, a172
    v_accvgpr_read_b32 v237, a176
    v_add_f32 v238, v233, v234
    v_mfma_f32_16x16x32_bf16 a[16:19], v[32:35], v[220:223], a[16:19]
    ds_read_b64_tr_b16 v[44:45], v15 offset:49152
    ds_read_b64_tr_b16 v[46:47], v15 offset:53248
    v_add_f32 v239, v235, v236
    s_waitcnt lgkmcnt(4)
    v_mfma_f32_16x16x32_bf16 a[20:23], v[36:39], v[188:191], a[20:23]
    v_add_f32 v238, v238, v237
    v_add_f32 v238, v238, v239
    v_cmp_ngt_f32 vcc, s34, v238
    v_mfma_f32_16x16x32_bf16 a[24:27], v[36:39], v[196:199], a[24:27]
    s_lshl_b32 s39, s24, 2
    s_add_u32 s39, s39, 108544
    v_mov_b32 v239, s39
    v_mfma_f32_16x16x32_bf16 a[28:31], v[36:39], v[204:207], a[28:31]
    s_cmp_lg_u64 vcc, 0
    s_cselect_b32 s38, 1, 0
    v_mov_b32 v238, s38
    v_mfma_f32_16x16x32_bf16 a[32:35], v[36:39], v[212:215], a[32:35]
    ds_write_b32 v239, v238
    v_mov_b32 v239, 108544
    v_mfma_f32_16x16x32_bf16 a[36:39], v[36:39], v[220:223], a[36:39]
    ds_read_b64_tr_b16 v[32:33], v16 offset:49152
    ds_read_b64_tr_b16 v[34:35], v16 offset:53248
    v_rcp_f32 v224, v233
    s_waitcnt lgkmcnt(5)
    v_mfma_f32_16x16x32_bf16 a[40:43], v[40:43], v[188:191], a[40:43]
    v_rcp_f32 v226, v234
    v_rcp_f32 v228, v235
    v_mfma_f32_16x16x32_bf16 a[44:47], v[40:43], v[196:199], a[44:47]
    v_rcp_f32 v230, v236
    v_rcp_f32 v232, v237
    v_mfma_f32_16x16x32_bf16 a[48:51], v[40:43], v[204:207], a[48:51]
    s_waitcnt lgkmcnt(2)
    s_waitcnt vmcnt(8)
    s_barrier
    ds_read_b128 v[240:243], v239
    v_mfma_f32_16x16x32_bf16 a[52:55], v[40:43], v[212:215], a[52:55]
    v_mfma_f32_16x16x32_bf16 a[56:59], v[40:43], v[220:223], a[56:59]
    ds_read_b64_tr_b16 v[36:37], v17 offset:49152
    ds_read_b64_tr_b16 v[38:39], v17 offset:53248
    v_mfma_f32_16x16x32_bf16 a[60:63], v[44:47], v[188:191], a[60:63]
    v_mfma_f32_16x16x32_bf16 a[64:67], v[44:47], v[196:199], a[64:67]
    s_waitcnt lgkmcnt(2)
    v_or_b32 v238, v240, v241
    v_or3_b32 v238, v238, v242, v243
    v_mfma_f32_16x16x32_bf16 a[68:71], v[44:47], v[204:207], a[68:71]
    v_readfirstlane_b32 s38, v238
    v_mfma_f32_16x16x32_bf16 a[72:75], v[44:47], v[212:215], a[72:75]
    s_cmp_lg_u32 s29, 0
    s_cselect_b32 s38, 0, s38
    s_cmp_lg_u32 s38, 0
    s_cbranch_scc1 L_fallback
    v_mfma_f32_16x16x32_bf16 a[76:79], v[44:47], v[220:223], a[76:79]
    ds_read_b64_tr_b16 v[40:41], v18 offset:49152
    ds_read_b64_tr_b16 v[42:43], v18 offset:53248
    v_accvgpr_read_b32 v64, a0
    v_accvgpr_read_b32 v65, a1
    v_accvgpr_read_b32 v66, a2
    v_accvgpr_read_b32 v67, a3
    v_mfma_f32_16x16x32_bf16 a[80:83], v[32:35], v[188:191], a[80:83]
    v_accvgpr_read_b32 v148, a20
    v_accvgpr_read_b32 v149, a21
    v_accvgpr_read_b32 v150, a22
    v_accvgpr_read_b32 v151, a23
    v_mul_f32 v64, v224, v64
    v_mul_f32 v65, v224, v65
    v_mfma_f32_16x16x32_bf16 a[84:87], v[32:35], v[196:199], a[84:87]
    v_mul_f32 v66, v224, v66
    v_mul_f32 v67, v224, v67
    v_mul_f32 v148, v224, v148
    v_mul_f32 v149, v224, v149
    v_mul_f32 v150, v224, v150
    v_mul_f32 v151, v224, v151
    v_mfma_f32_16x16x32_bf16 a[88:91], v[32:35], v[204:207], a[88:91]
    v_cvt_pk_bf16_f32 v64, v64, v65
    v_cvt_pk_bf16_f32 v65, v66, v67
    v_cvt_pk_bf16_f32 v66, v148, v149
    v_cvt_pk_bf16_f32 v67, v150, v151
    buffer_store_dwordx4 v[64:67], v58, s[20:23], s76 offen offset:0 sc1
    v_mfma_f32_16x16x32_bf16 a[92:95], v[32:35], v[212:215], a[92:95]
    v_accvgpr_read_b32 v72, a4
    v_accvgpr_read_b32 v73, a5
    v_accvgpr_read_b32 v74, a6
    v_accvgpr_read_b32 v75, a7
    v_accvgpr_read_b32 v156, a24
    v_mfma_f32_16x16x32_bf16 a[96:99], v[32:35], v[220:223], a[96:99]
    ds_read_b64_tr_b16 v[44:45], v19 offset:49152
    ds_read_b64_tr_b16 v[46:47], v19 offset:53248
    v_accvgpr_read_b32 v157, a25
    v_accvgpr_read_b32 v158, a26
    v_accvgpr_read_b32 v159, a27
    s_waitcnt lgkmcnt(4)
    v_mfma_f32_16x16x32_bf16 a[100:103], v[36:39], v[188:191], a[100:103]
    v_mul_f32 v72, v226, v72
    v_mul_f32 v73, v226, v73
    v_mul_f32 v74, v226, v74
    v_mul_f32 v75, v226, v75
    v_mul_f32 v156, v226, v156
    v_mfma_f32_16x16x32_bf16 a[104:107], v[36:39], v[196:199], a[104:107]
    v_mul_f32 v157, v226, v157
    v_mul_f32 v158, v226, v158
    v_mul_f32 v159, v226, v159
    v_cvt_pk_bf16_f32 v72, v72, v73
    v_cvt_pk_bf16_f32 v73, v74, v75
    v_mfma_f32_16x16x32_bf16 a[108:111], v[36:39], v[204:207], a[108:111]
    v_cvt_pk_bf16_f32 v74, v156, v157
    v_cvt_pk_bf16_f32 v75, v158, v159
    buffer_store_dwordx4 v[72:75], v58, s[20:23], s76 offen offset:1024 sc1
    v_accvgpr_read_b32 v80, a8
    v_accvgpr_read_b32 v81, a9
    v_mfma_f32_16x16x32_bf16 a[112:115], v[36:39], v[212:215], a[112:115]
    v_accvgpr_read_b32 v82, a10
    v_accvgpr_read_b32 v83, a11
    v_accvgpr_read_b32 v164, a28
    v_accvgpr_read_b32 v165, a29
    v_accvgpr_read_b32 v166, a30
    v_mfma_f32_16x16x32_bf16 a[116:119], v[36:39], v[220:223], a[116:119]
    v_accvgpr_read_b32 v167, a31
    v_mul_f32 v80, v228, v80
    v_mul_f32 v81, v228, v81
    v_mul_f32 v82, v228, v82
    v_mul_f32 v83, v228, v83
    s_waitcnt lgkmcnt(2)
    v_mfma_f32_16x16x32_bf16 a[120:123], v[40:43], v[188:191], a[120:123]
    v_mul_f32 v164, v228, v164
    v_mul_f32 v165, v228, v165
    v_mul_f32 v166, v228, v166
    v_mul_f32 v167, v228, v167
    v_cvt_pk_bf16_f32 v80, v80, v81
    v_cvt_pk_bf16_f32 v81, v82, v83
    v_mfma_f32_16x16x32_bf16 a[124:127], v[40:43], v[196:199], a[124:127]
    v_cvt_pk_bf16_f32 v82, v164, v165
    v_cvt_pk_bf16_f32 v83, v166, v167
    buffer_store_dwordx4 v[80:83], v58, s[20:23], s76 offen offset:2048 sc1
    v_accvgpr_read_b32 v88, a12
    v_accvgpr_read_b32 v89, a13
    v_accvgpr_read_b32 v90, a14
    v_mfma_f32_16x16x32_bf16 a[128:131], v[40:43], v[204:207], a[128:131]
    v_accvgpr_read_b32 v91, a15
    v_accvgpr_read_b32 v172, a32
    v_accvgpr_read_b32 v173, a33
    v_accvgpr_read_b32 v174, a34
    v_accvgpr_read_b32 v175, a35
    v_mul_f32 v88, v230, v88
    v_mfma_f32_16x16x32_bf16 a[132:135], v[40:43], v[212:215], a[132:135]
    v_mul_f32 v89, v230, v89
    v_mul_f32 v90, v230, v90
    v_mul_f32 v91, v230, v91
    v_mul_f32 v172, v230, v172
    v_mul_f32 v173, v230, v173
    v_mul_f32 v174, v230, v174
    v_mfma_f32_16x16x32_bf16 a[136:139], v[40:43], v[220:223], a[136:139]
    v_mul_f32 v175, v230, v175
    v_cvt_pk_bf16_f32 v88, v88, v89
    v_cvt_pk_bf16_f32 v89, v90, v91
    v_cvt_pk_bf16_f32 v90, v172, v173
    v_cvt_pk_bf16_f32 v91, v174, v175
    buffer_store_dwordx4 v[88:91], v58, s[20:23], s76 offen offset:3072 sc1
    s_waitcnt lgkmcnt(0)
    v_mfma_f32_16x16x32_bf16 a[140:143], v[44:47], v[188:191], a[140:143]
    v_accvgpr_read_b32 v96, a16
    v_accvgpr_read_b32 v97, a17
    v_accvgpr_read_b32 v98, a18
    v_accvgpr_read_b32 v99, a19
    v_accvgpr_read_b32 v180, a36
    v_accvgpr_read_b32 v181, a37
    v_mfma_f32_16x16x32_bf16 a[144:147], v[44:47], v[196:199], a[144:147]
    v_accvgpr_read_b32 v182, a38
    v_accvgpr_read_b32 v183, a39
    v_mul_f32 v96, v232, v96
    v_mul_f32 v97, v232, v97
    v_mul_f32 v98, v232, v98
    v_mul_f32 v99, v232, v99
    v_mfma_f32_16x16x32_bf16 a[148:151], v[44:47], v[204:207], a[148:151]
    v_mul_f32 v180, v232, v180
    v_mul_f32 v181, v232, v181
    v_mul_f32 v182, v232, v182
    v_mul_f32 v183, v232, v183
    v_cvt_pk_bf16_f32 v96, v96, v97
    v_cvt_pk_bf16_f32 v97, v98, v99
    v_mfma_f32_16x16x32_bf16 a[152:155], v[44:47], v[212:215], a[152:155]
    v_cvt_pk_bf16_f32 v98, v180, v181
    v_cvt_pk_bf16_f32 v99, v182, v183
    buffer_store_dwordx4 v[96:99], v59, s[20:23], s76 offen offset:0 sc1
    s_lshr_b32 s41, s24, 1
    s_mov_b32 s30, 0x4000
    s_mul_i32 s33, s41, 0x24000
    v_mfma_f32_16x16x32_bf16 a[156:159], v[44:47], v[220:223], a[156:159]
    s_add_u32 s33, s33, 0xfffec000
    s_mov_b32 s28, 0xffff8000
    s_mov_b32 s36, 0x10000
    s_mov_b32 s37, 0x8000
    s_mov_b32 s34, 0xfffe0000
    s_mov_b32 s29, 0x10000
    v_accvgpr_read_b32 v104, a40
    v_accvgpr_read_b32 v105, a41
    v_accvgpr_read_b32 v106, a42
    v_accvgpr_read_b32 v107, a43
    v_accvgpr_read_b32 v148, a60
    v_accvgpr_read_b32 v149, a61
    v_accvgpr_read_b32 v150, a62
    v_accvgpr_read_b32 v151, a63
    v_pk_mul_f32 v[104:105], v[104:105], v[224:225] op_sel_hi:[1,0]
    v_pk_mul_f32 v[106:107], v[106:107], v[224:225] op_sel_hi:[1,0]
    v_pk_mul_f32 v[148:149], v[148:149], v[224:225] op_sel_hi:[1,0]
    v_pk_mul_f32 v[150:151], v[150:151], v[224:225] op_sel_hi:[1,0]
    v_cvt_pk_bf16_f32 v104, v104, v105
    v_cvt_pk_bf16_f32 v105, v106, v107
    v_cvt_pk_bf16_f32 v106, v148, v149
    v_cvt_pk_bf16_f32 v107, v150, v151
    buffer_store_dwordx4 v[104:107], v58, s[20:23], s77 offen offset:0 sc1
    v_accvgpr_read_b32 v112, a44
    v_accvgpr_read_b32 v113, a45
    v_accvgpr_read_b32 v114, a46
    v_accvgpr_read_b32 v115, a47
    v_accvgpr_read_b32 v156, a64
    v_accvgpr_read_b32 v157, a65
    v_accvgpr_read_b32 v158, a66
    v_accvgpr_read_b32 v159, a67
    v_pk_mul_f32 v[112:113], v[112:113], v[226:227] op_sel_hi:[1,0]
    v_pk_mul_f32 v[114:115], v[114:115], v[226:227] op_sel_hi:[1,0]
    v_pk_mul_f32 v[156:157], v[156:157], v[226:227] op_sel_hi:[1,0]
    v_pk_mul_f32 v[158:159], v[158:159], v[226:227] op_sel_hi:[1,0]
    v_cvt_pk_bf16_f32 v112, v112, v113
    v_cvt_pk_bf16_f32 v113, v114, v115
    v_cvt_pk_bf16_f32 v114, v156, v157
    v_cvt_pk_bf16_f32 v115, v158, v159
    buffer_store_dwordx4 v[112:115], v58, s[20:23], s77 offen offset:1024 sc1
    v_accvgpr_read_b32 v120, a48
    v_accvgpr_read_b32 v121, a49
    v_accvgpr_read_b32 v122, a50
    v_accvgpr_read_b32 v123, a51
    v_accvgpr_read_b32 v164, a68
    v_accvgpr_read_b32 v165, a69
    v_accvgpr_read_b32 v166, a70
    v_accvgpr_read_b32 v167, a71
    v_pk_mul_f32 v[120:121], v[120:121], v[228:229] op_sel_hi:[1,0]
    v_pk_mul_f32 v[122:123], v[122:123], v[228:229] op_sel_hi:[1,0]
    v_pk_mul_f32 v[164:165], v[164:165], v[228:229] op_sel_hi:[1,0]
    v_pk_mul_f32 v[166:167], v[166:167], v[228:229] op_sel_hi:[1,0]
    v_cvt_pk_bf16_f32 v120, v120, v121
    v_cvt_pk_bf16_f32 v121, v122, v123
    v_cvt_pk_bf16_f32 v122, v164, v165
    v_cvt_pk_bf16_f32 v123, v166, v167
    buffer_store_dwordx4 v[120:123], v58, s[20:23], s77 offen offset:2048 sc1
    v_accvgpr_read_b32 v128, a52
    v_accvgpr_read_b32 v129, a53
    v_accvgpr_read_b32 v130, a54
    v_accvgpr_read_b32 v131, a55
    v_accvgpr_read_b32 v172, a72
    v_accvgpr_read_b32 v173, a73
    v_accvgpr_read_b32 v174, a74
    v_accvgpr_read_b32 v175, a75
    v_pk_mul_f32 v[128:129], v[128:129], v[230:231] op_sel_hi:[1,0]
    v_pk_mul_f32 v[130:131], v[130:131], v[230:231] op_sel_hi:[1,0]
    v_pk_mul_f32 v[172:173], v[172:173], v[230:231] op_sel_hi:[1,0]
    v_pk_mul_f32 v[174:175], v[174:175], v[230:231] op_sel_hi:[1,0]
    v_cvt_pk_bf16_f32 v128, v128, v129
    v_cvt_pk_bf16_f32 v129, v130, v131
    v_cvt_pk_bf16_f32 v130, v172, v173
    v_cvt_pk_bf16_f32 v131, v174, v175
    buffer_store_dwordx4 v[128:131], v58, s[20:23], s77 offen offset:3072 sc1
    v_accvgpr_read_b32 v136, a56
    v_accvgpr_read_b32 v137, a57
    v_accvgpr_read_b32 v138, a58
    v_accvgpr_read_b32 v139, a59
    v_accvgpr_read_b32 v180, a76
    v_accvgpr_read_b32 v181, a77
    v_accvgpr_read_b32 v182, a78
    v_accvgpr_read_b32 v183, a79
    v_pk_mul_f32 v[136:137], v[136:137], v[232:233] op_sel_hi:[1,0]
    v_pk_mul_f32 v[138:139], v[138:139], v[232:233] op_sel_hi:[1,0]
    v_pk_mul_f32 v[180:181], v[180:181], v[232:233] op_sel_hi:[1,0]
    v_pk_mul_f32 v[182:183], v[182:183], v[232:233] op_sel_hi:[1,0]
    v_cvt_pk_bf16_f32 v136, v136, v137
    v_cvt_pk_bf16_f32 v137, v138, v139
    v_cvt_pk_bf16_f32 v138, v180, v181
    v_cvt_pk_bf16_f32 v139, v182, v183
    buffer_store_dwordx4 v[136:139], v59, s[20:23], s77 offen offset:0 sc1
    v_accvgpr_read_b32 v144, a80
    v_accvgpr_read_b32 v145, a81
    v_accvgpr_read_b32 v146, a82
    v_accvgpr_read_b32 v147, a83
    v_accvgpr_read_b32 v148, a100
    v_accvgpr_read_b32 v149, a101
    v_accvgpr_read_b32 v150, a102
    v_accvgpr_read_b32 v151, a103
    v_pk_mul_f32 v[144:145], v[144:145], v[224:225] op_sel_hi:[1,0]
    v_pk_mul_f32 v[146:147], v[146:147], v[224:225] op_sel_hi:[1,0]
    v_pk_mul_f32 v[148:149], v[148:149], v[224:225] op_sel_hi:[1,0]
    v_pk_mul_f32 v[150:151], v[150:151], v[224:225] op_sel_hi:[1,0]
    v_cvt_pk_bf16_f32 v144, v144, v145
    v_cvt_pk_bf16_f32 v145, v146, v147
    v_cvt_pk_bf16_f32 v146, v148, v149
    v_cvt_pk_bf16_f32 v147, v150, v151
    buffer_store_dwordx4 v[144:147], v58, s[20:23], s78 offen offset:0 sc1
    v_accvgpr_read_b32 v152, a84
    v_accvgpr_read_b32 v153, a85
    v_accvgpr_read_b32 v154, a86
    v_accvgpr_read_b32 v155, a87
    v_accvgpr_read_b32 v156, a104
    v_accvgpr_read_b32 v157, a105
    v_accvgpr_read_b32 v158, a106
    v_accvgpr_read_b32 v159, a107
    v_pk_mul_f32 v[152:153], v[152:153], v[226:227] op_sel_hi:[1,0]
    v_pk_mul_f32 v[154:155], v[154:155], v[226:227] op_sel_hi:[1,0]
    v_pk_mul_f32 v[156:157], v[156:157], v[226:227] op_sel_hi:[1,0]
    v_pk_mul_f32 v[158:159], v[158:159], v[226:227] op_sel_hi:[1,0]
    v_cvt_pk_bf16_f32 v152, v152, v153
    v_cvt_pk_bf16_f32 v153, v154, v155
    v_cvt_pk_bf16_f32 v154, v156, v157
    v_cvt_pk_bf16_f32 v155, v158, v159
    buffer_store_dwordx4 v[152:155], v58, s[20:23], s78 offen offset:1024 sc1
    v_accvgpr_read_b32 v160, a88
    v_accvgpr_read_b32 v161, a89
    v_accvgpr_read_b32 v162, a90
    v_accvgpr_read_b32 v163, a91
    v_accvgpr_read_b32 v164, a108
    v_accvgpr_read_b32 v165, a109
    v_accvgpr_read_b32 v166, a110
    v_accvgpr_read_b32 v167, a111
    v_pk_mul_f32 v[160:161], v[160:161], v[228:229] op_sel_hi:[1,0]
    v_pk_mul_f32 v[162:163], v[162:163], v[228:229] op_sel_hi:[1,0]
    v_pk_mul_f32 v[164:165], v[164:165], v[228:229] op_sel_hi:[1,0]
    v_pk_mul_f32 v[166:167], v[166:167], v[228:229] op_sel_hi:[1,0]
    v_cvt_pk_bf16_f32 v160, v160, v161
    v_cvt_pk_bf16_f32 v161, v162, v163
    v_cvt_pk_bf16_f32 v162, v164, v165
    v_cvt_pk_bf16_f32 v163, v166, v167
    buffer_store_dwordx4 v[160:163], v58, s[20:23], s78 offen offset:2048 sc1
    v_accvgpr_read_b32 v168, a92
    v_accvgpr_read_b32 v169, a93
    v_accvgpr_read_b32 v170, a94
    v_accvgpr_read_b32 v171, a95
    v_accvgpr_read_b32 v172, a112
    v_accvgpr_read_b32 v173, a113
    v_accvgpr_read_b32 v174, a114
    v_accvgpr_read_b32 v175, a115
    v_pk_mul_f32 v[168:169], v[168:169], v[230:231] op_sel_hi:[1,0]
    v_pk_mul_f32 v[170:171], v[170:171], v[230:231] op_sel_hi:[1,0]
    v_pk_mul_f32 v[172:173], v[172:173], v[230:231] op_sel_hi:[1,0]
    v_pk_mul_f32 v[174:175], v[174:175], v[230:231] op_sel_hi:[1,0]
    v_cvt_pk_bf16_f32 v168, v168, v169
    v_cvt_pk_bf16_f32 v169, v170, v171
    v_cvt_pk_bf16_f32 v170, v172, v173
    v_cvt_pk_bf16_f32 v171, v174, v175
    buffer_store_dwordx4 v[168:171], v58, s[20:23], s78 offen offset:3072 sc1
    v_accvgpr_read_b32 v176, a96
    v_accvgpr_read_b32 v177, a97
    v_accvgpr_read_b32 v178, a98
    v_accvgpr_read_b32 v179, a99
    v_accvgpr_read_b32 v180, a116
    v_accvgpr_read_b32 v181, a117
    v_accvgpr_read_b32 v182, a118
    v_accvgpr_read_b32 v183, a119
    v_pk_mul_f32 v[176:177], v[176:177], v[232:233] op_sel_hi:[1,0]
    v_pk_mul_f32 v[178:179], v[178:179], v[232:233] op_sel_hi:[1,0]
    v_pk_mul_f32 v[180:181], v[180:181], v[232:233] op_sel_hi:[1,0]
    v_pk_mul_f32 v[182:183], v[182:183], v[232:233] op_sel_hi:[1,0]
    v_cvt_pk_bf16_f32 v176, v176, v177
    v_cvt_pk_bf16_f32 v177, v178, v179
    v_cvt_pk_bf16_f32 v178, v180, v181
    v_cvt_pk_bf16_f32 v179, v182, v183
    buffer_store_dwordx4 v[176:179], v59, s[20:23], s78 offen offset:0 sc1
    v_accvgpr_read_b32 v184, a120
    v_accvgpr_read_b32 v185, a121
    v_accvgpr_read_b32 v186, a122
    v_accvgpr_read_b32 v187, a123
    v_accvgpr_read_b32 v148, a140
    v_accvgpr_read_b32 v149, a141
    v_accvgpr_read_b32 v150, a142
    v_accvgpr_read_b32 v151, a143
    v_pk_mul_f32 v[184:185], v[184:185], v[224:225] op_sel_hi:[1,0]
    v_pk_mul_f32 v[186:187], v[186:187], v[224:225] op_sel_hi:[1,0]
    v_pk_mul_f32 v[148:149], v[148:149], v[224:225] op_sel_hi:[1,0]
    v_pk_mul_f32 v[150:151], v[150:151], v[224:225] op_sel_hi:[1,0]
    v_cvt_pk_bf16_f32 v184, v184, v185
    v_cvt_pk_bf16_f32 v185, v186, v187
    v_cvt_pk_bf16_f32 v186, v148, v149
    v_cvt_pk_bf16_f32 v187, v150, v151
    buffer_store_dwordx4 v[184:187], v58, s[20:23], s79 offen offset:0 sc1
    v_accvgpr_read_b32 v192, a124
    v_accvgpr_read_b32 v193, a125
    v_accvgpr_read_b32 v194, a126
    v_accvgpr_read_b32 v195, a127
    v_accvgpr_read_b32 v156, a144
    v_accvgpr_read_b32 v157, a145
    v_accvgpr_read_b32 v158, a146
    v_accvgpr_read_b32 v159, a147
    v_pk_mul_f32 v[192:193], v[192:193], v[226:227] op_sel_hi:[1,0]
    v_pk_mul_f32 v[194:195], v[194:195], v[226:227] op_sel_hi:[1,0]
    v_pk_mul_f32 v[156:157], v[156:157], v[226:227] op_sel_hi:[1,0]
    v_pk_mul_f32 v[158:159], v[158:159], v[226:227] op_sel_hi:[1,0]
    v_cvt_pk_bf16_f32 v192, v192, v193
    v_cvt_pk_bf16_f32 v193, v194, v195
    v_cvt_pk_bf16_f32 v194, v156, v157
    v_cvt_pk_bf16_f32 v195, v158, v159
    buffer_store_dwordx4 v[192:195], v58, s[20:23], s79 offen offset:1024 sc1
    v_accvgpr_read_b32 v200, a128
    v_accvgpr_read_b32 v201, a129
    v_accvgpr_read_b32 v202, a130
    v_accvgpr_read_b32 v203, a131
    v_accvgpr_read_b32 v164, a148
    v_accvgpr_read_b32 v165, a149
    ds_read_b64_tr_b16 v[32:33], v246 offset:0
    ds_read_b64_tr_b16 v[34:35], v246 offset:4096
    ds_read_b64_tr_b16 v[36:37], v246 offset:8192
    ds_read_b64_tr_b16 v[38:39], v246 offset:12288
    ds_read_b64_tr_b16 v[40:41], v247 offset:0
    ds_read_b64_tr_b16 v[42:43], v247 offset:4096
    ds_read_b64_tr_b16 v[44:45], v247 offset:8192
    ds_read_b64_tr_b16 v[46:47], v247 offset:12288
    v_accvgpr_read_b32 v166, a150
    v_accvgpr_read_b32 v167, a151
    v_pk_mul_f32 v[200:201], v[200:201], v[228:229] op_sel_hi:[1,0]
    v_pk_mul_f32 v[202:203], v[202:203], v[228:229] op_sel_hi:[1,0]
    v_pk_mul_f32 v[164:165], v[164:165], v[228:229] op_sel_hi:[1,0]
    v_pk_mul_f32 v[166:167], v[166:167], v[228:229] op_sel_hi:[1,0]
    v_cvt_pk_bf16_f32 v200, v200, v201
    v_cvt_pk_bf16_f32 v201, v202, v203
    v_cvt_pk_bf16_f32 v202, v164, v165
    v_cvt_pk_bf16_f32 v203, v166, v167
    buffer_store_dwordx4 v[200:203], v58, s[20:23], s79 offen offset:2048 sc1
    v_accvgpr_read_b32 v208, a132
    v_accvgpr_read_b32 v209, a133
    v_accvgpr_read_b32 v210, a134
    v_accvgpr_read_b32 v211, a135
    v_accvgpr_read_b32 v172, a152
    v_accvgpr_read_b32 v173, a153
    v_accvgpr_read_b32 v174, a154
    v_accvgpr_read_b32 v175, a155
    v_pk_mul_f32 v[208:209], v[208:209], v[230:231] op_sel_hi:[1,0]
    v_pk_mul_f32 v[210:211], v[210:211], v[230:231] op_sel_hi:[1,0]
    v_pk_mul_f32 v[172:173], v[172:173], v[230:231] op_sel_hi:[1,0]
    v_pk_mul_f32 v[174:175], v[174:175], v[230:231] op_sel_hi:[1,0]
    v_cvt_pk_bf16_f32 v208, v208, v209
    v_cvt_pk_bf16_f32 v209, v210, v211
    v_cvt_pk_bf16_f32 v210, v172, v173
    v_cvt_pk_bf16_f32 v211, v174, v175
    buffer_store_dwordx4 v[208:211], v58, s[20:23], s79 offen offset:3072 sc1
    v_accvgpr_read_b32 v216, a136
    v_accvgpr_read_b32 v217, a137
    v_accvgpr_read_b32 v218, a138
    v_accvgpr_read_b32 v219, a139
    v_accvgpr_read_b32 v180, a156
    v_accvgpr_read_b32 v181, a157
    v_accvgpr_read_b32 v182, a158
    v_accvgpr_read_b32 v183, a159
    v_pk_mul_f32 v[216:217], v[216:217], v[232:233] op_sel_hi:[1,0]
    v_pk_mul_f32 v[218:219], v[218:219], v[232:233] op_sel_hi:[1,0]
    v_pk_mul_f32 v[180:181], v[180:181], v[232:233] op_sel_hi:[1,0]
    v_pk_mul_f32 v[182:183], v[182:183], v[232:233] op_sel_hi:[1,0]
    v_cvt_pk_bf16_f32 v216, v216, v217
    v_cvt_pk_bf16_f32 v217, v218, v219
    v_cvt_pk_bf16_f32 v218, v180, v181
    v_cvt_pk_bf16_f32 v219, v182, v183
    buffer_store_dwordx4 v[216:219], v59, s[20:23], s79 offen offset:0 sc1
    v_mov_b32 v245, 1
    v_mov_b32 v254, 2
    s_waitcnt lgkmcnt(6)
    v_mfma_f32_16x16x32_bf16 a[0:3], v[32:35], v[64:67], 0
    v_add_u32 v246, s30, v246
    v_add_u32 v247, s30, v247
    s_waitcnt lgkmcnt(4)
    v_mfma_f32_16x16x32_bf16 a[0:3], v[36:39], v[104:107], a[0:3]
    v_mfma_f32_16x16x32_bf16 a[4:7], v[32:35], v[72:75], 0
    ds_read_b64_tr_b16 v[8:9], v248 offset:0
    ds_read_b64_tr_b16 v[10:11], v248 offset:4096
    v_mfma_f32_16x16x32_bf16 a[4:7], v[36:39], v[112:115], a[4:7]
    s_waitcnt lgkmcnt(0)
    s_waitcnt vmcnt(20)
    s_barrier
    ds_read_b64_tr_b16 v[12:13], v248 offset:8192
    ds_read_b64_tr_b16 v[14:15], v248 offset:12288
    v_mfma_f32_16x16x32_bf16 a[8:11], v[32:35], v[80:83], 0
    v_add_u32 v248, s30, v248
    v_mfma_f32_16x16x32_bf16 a[8:11], v[36:39], v[120:123], a[8:11]
    v_mfma_f32_16x16x32_bf16 a[12:15], v[32:35], v[88:91], 0
    v_mfma_f32_16x16x32_bf16 a[12:15], v[36:39], v[128:131], a[12:15]
    v_mfma_f32_16x16x32_bf16 a[16:19], v[32:35], v[96:99], 0
    v_mfma_f32_16x16x32_bf16 a[16:19], v[36:39], v[136:139], a[16:19]
    v_mfma_f32_16x16x32_bf16 a[20:23], v[40:43], v[64:67], 0
    v_mfma_f32_16x16x32_bf16 a[20:23], v[44:47], v[104:107], a[20:23]
    v_mfma_f32_16x16x32_bf16 a[24:27], v[40:43], v[72:75], 0
    ds_read_b64_tr_b16 v[16:17], v249 offset:0
    ds_read_b64_tr_b16 v[18:19], v249 offset:4096
    s_waitcnt vmcnt(0)
    buffer_store_dword v254, v51, s[44:47], 0 offen sc1
    v_mfma_f32_16x16x32_bf16 a[24:27], v[44:47], v[112:115], a[24:27]
    ds_read_b64_tr_b16 v[20:21], v249 offset:8192
    ds_read_b64_tr_b16 v[22:23], v249 offset:12288
    v_mfma_f32_16x16x32_bf16 a[28:31], v[40:43], v[80:83], 0
    v_add_u32 v249, s30, v249
    v_mfma_f32_16x16x32_bf16 a[28:31], v[44:47], v[120:123], a[28:31]
    v_mfma_f32_16x16x32_bf16 a[32:35], v[40:43], v[88:91], 0
    v_mfma_f32_16x16x32_bf16 a[32:35], v[44:47], v[128:131], a[32:35]
    v_mfma_f32_16x16x32_bf16 a[36:39], v[40:43], v[96:99], 0
    v_mfma_f32_16x16x32_bf16 a[36:39], v[44:47], v[136:139], a[36:39]
    s_waitcnt lgkmcnt(4)
    v_mfma_f32_16x16x32_bf16 a[40:43], v[8:11], v[64:67], 0
    v_mfma_f32_16x16x32_bf16 a[40:43], v[12:15], v[104:107], a[40:43]
    v_mfma_f32_16x16x32_bf16 a[44:47], v[8:11], v[72:75], 0
    ds_read_b64_tr_b16 v[32:33], v250 offset:0
    ds_read_b64_tr_b16 v[34:35], v250 offset:4096
    v_mfma_f32_16x16x32_bf16 a[44:47], v[12:15], v[112:115], a[44:47]
    ds_read_b64_tr_b16 v[36:37], v250 offset:8192
    ds_read_b64_tr_b16 v[38:39], v250 offset:12288
    v_mfma_f32_16x16x32_bf16 a[48:51], v[8:11], v[80:83], 0
    v_add_u32 v250, s30, v250
    v_mfma_f32_16x16x32_bf16 a[48:51], v[12:15], v[120:123], a[48:51]
    v_mfma_f32_16x16x32_bf16 a[52:55], v[8:11], v[88:91], 0
    v_mfma_f32_16x16x32_bf16 a[52:55], v[12:15], v[128:131], a[52:55]
    v_mfma_f32_16x16x32_bf16 a[56:59], v[8:11], v[96:99], 0
    v_mfma_f32_16x16x32_bf16 a[56:59], v[12:15], v[136:139], a[56:59]
    s_waitcnt lgkmcnt(4)
    v_mfma_f32_16x16x32_bf16 a[60:63], v[16:19], v[64:67], 0
    s_add_u32 m0, s35, 32768
    v_mfma_f32_16x16x32_bf16 a[60:63], v[20:23], v[104:107], a[60:63]
    buffer_load_dwordx4 v54, s[12:15], s83 offen offset:0 lds
    v_mfma_f32_16x16x32_bf16 a[64:67], v[16:19], v[72:75], 0
    ds_read_b64_tr_b16 v[40:41], v251 offset:0
    ds_read_b64_tr_b16 v[42:43], v251 offset:4096
    v_mfma_f32_16x16x32_bf16 a[64:67], v[20:23], v[112:115], a[64:67]
    ds_read_b64_tr_b16 v[44:45], v251 offset:8192
    ds_read_b64_tr_b16 v[46:47], v251 offset:12288
    v_mfma_f32_16x16x32_bf16 a[68:71], v[16:19], v[80:83], 0
    v_add_u32 v251, s30, v251
    v_mfma_f32_16x16x32_bf16 a[68:71], v[20:23], v[120:123], a[68:71]
    buffer_load_dwordx4 v55, s[12:15], s83 offen offset:1024 lds
    v_mfma_f32_16x16x32_bf16 a[72:75], v[16:19], v[88:91], 0
    buffer_load_dwordx4 v56, s[12:15], s83 offen offset:2048 lds
    v_mfma_f32_16x16x32_bf16 a[72:75], v[20:23], v[128:131], a[72:75]
    buffer_load_dwordx4 v57, s[12:15], s83 offen offset:3072 lds
    v_mfma_f32_16x16x32_bf16 a[76:79], v[16:19], v[96:99], 0
    s_add_u32 s2, s83, 16384
    v_mfma_f32_16x16x32_bf16 a[76:79], v[20:23], v[136:139], a[76:79]
    s_waitcnt lgkmcnt(4)
    v_mfma_f32_16x16x32_bf16 a[80:83], v[32:35], v[64:67], 0
    s_add_u32 m0, s35, 36864
    v_mfma_f32_16x16x32_bf16 a[80:83], v[36:39], v[104:107], a[80:83]
    buffer_load_dwordx4 v54, s[12:15], s2 offen offset:0 lds
    v_mfma_f32_16x16x32_bf16 a[84:87], v[32:35], v[72:75], 0
    ds_read_b64_tr_b16 v[8:9], v252 offset:0
    ds_read_b64_tr_b16 v[10:11], v252 offset:4096
    v_mfma_f32_16x16x32_bf16 a[84:87], v[36:39], v[112:115], a[84:87]
    ds_read_b64_tr_b16 v[12:13], v252 offset:8192
    ds_read_b64_tr_b16 v[14:15], v252 offset:12288
    v_mfma_f32_16x16x32_bf16 a[88:91], v[32:35], v[80:83], 0
    v_add_u32 v252, s30, v252
    v_mfma_f32_16x16x32_bf16 a[88:91], v[36:39], v[120:123], a[88:91]
    buffer_load_dwordx4 v55, s[12:15], s2 offen offset:1024 lds
    v_mfma_f32_16x16x32_bf16 a[92:95], v[32:35], v[88:91], 0
    buffer_load_dwordx4 v56, s[12:15], s2 offen offset:2048 lds
    v_mfma_f32_16x16x32_bf16 a[92:95], v[36:39], v[128:131], a[92:95]
    buffer_load_dwordx4 v57, s[12:15], s2 offen offset:3072 lds
    v_mfma_f32_16x16x32_bf16 a[96:99], v[32:35], v[96:99], 0
    s_add_u32 m0, s35, 98304
    v_mfma_f32_16x16x32_bf16 a[96:99], v[36:39], v[136:139], a[96:99]
    s_waitcnt lgkmcnt(4)
    v_mfma_f32_16x16x32_bf16 a[100:103], v[40:43], v[64:67], 0
    buffer_load_dwordx4 v54, s[12:15], s84 offen offset:0 lds
    v_mfma_f32_16x16x32_bf16 a[100:103], v[44:47], v[104:107], a[100:103]
    buffer_load_dwordx4 v55, s[12:15], s84 offen offset:1024 lds
    v_mfma_f32_16x16x32_bf16 a[104:107], v[40:43], v[72:75], 0
    ds_read_b64_tr_b16 v[16:17], v253 offset:0
    ds_read_b64_tr_b16 v[18:19], v253 offset:4096
    v_mfma_f32_16x16x32_bf16 a[104:107], v[44:47], v[112:115], a[104:107]
    ds_read_b64_tr_b16 v[20:21], v253 offset:8192
    ds_read_b64_tr_b16 v[22:23], v253 offset:12288
    v_mfma_f32_16x16x32_bf16 a[108:111], v[40:43], v[80:83], 0
    v_add_u32 v253, s30, v253
    v_mfma_f32_16x16x32_bf16 a[108:111], v[44:47], v[120:123], a[108:111]
    buffer_load_dwordx4 v56, s[12:15], s84 offen offset:2048 lds
    v_mfma_f32_16x16x32_bf16 a[112:115], v[40:43], v[88:91], 0
    buffer_load_dwordx4 v57, s[12:15], s84 offen offset:3072 lds
    v_mfma_f32_16x16x32_bf16 a[112:115], v[44:47], v[128:131], a[112:115]
    s_add_u32 s2, s84, 16384
    v_mfma_f32_16x16x32_bf16 a[116:119], v[40:43], v[96:99], 0
    s_add_u32 m0, s35, 102400
    v_mfma_f32_16x16x32_bf16 a[116:119], v[44:47], v[136:139], a[116:119]
    s_waitcnt lgkmcnt(4)
    v_mfma_f32_16x16x32_bf16 a[120:123], v[8:11], v[64:67], 0
    buffer_load_dwordx4 v54, s[12:15], s2 offen offset:0 lds
    v_mfma_f32_16x16x32_bf16 a[120:123], v[12:15], v[104:107], a[120:123]
    buffer_load_dwordx4 v55, s[12:15], s2 offen offset:1024 lds
    v_mfma_f32_16x16x32_bf16 a[124:127], v[8:11], v[72:75], 0
    ds_read_b64_tr_b16 v[32:33], v246 offset:0
    ds_read_b64_tr_b16 v[34:35], v246 offset:4096
    v_mfma_f32_16x16x32_bf16 a[124:127], v[12:15], v[112:115], a[124:127]
    ds_read_b64_tr_b16 v[36:37], v246 offset:8192
    ds_read_b64_tr_b16 v[38:39], v246 offset:12288
    v_mfma_f32_16x16x32_bf16 a[128:131], v[8:11], v[80:83], 0
    v_add_u32 v246, s33, v246
    v_mfma_f32_16x16x32_bf16 a[128:131], v[12:15], v[120:123], a[128:131]
    buffer_load_dwordx4 v56, s[12:15], s2 offen offset:2048 lds
    v_mfma_f32_16x16x32_bf16 a[132:135], v[8:11], v[88:91], 0
    buffer_load_dwordx4 v57, s[12:15], s2 offen offset:3072 lds
    v_mfma_f32_16x16x32_bf16 a[132:135], v[12:15], v[128:131], a[132:135]
    v_mfma_f32_16x16x32_bf16 a[136:139], v[8:11], v[96:99], 0
    v_mfma_f32_16x16x32_bf16 a[136:139], v[12:15], v[136:139], a[136:139]
    s_waitcnt lgkmcnt(4)
    v_mfma_f32_16x16x32_bf16 a[140:143], v[16:19], v[64:67], 0
    v_mfma_f32_16x16x32_bf16 a[140:143], v[20:23], v[104:107], a[140:143]
    v_mfma_f32_16x16x32_bf16 a[144:147], v[16:19], v[72:75], 0
    ds_read_b64_tr_b16 v[40:41], v247 offset:0
    ds_read_b64_tr_b16 v[42:43], v247 offset:4096
    v_mfma_f32_16x16x32_bf16 a[144:147], v[20:23], v[112:115], a[144:147]
    ds_read_b64_tr_b16 v[44:45], v247 offset:8192
    ds_read_b64_tr_b16 v[46:47], v247 offset:12288
    v_mfma_f32_16x16x32_bf16 a[148:151], v[16:19], v[80:83], 0
    v_add_u32 v247, s33, v247
    v_mfma_f32_16x16x32_bf16 a[148:151], v[20:23], v[120:123], a[148:151]
    v_mfma_f32_16x16x32_bf16 a[152:155], v[16:19], v[88:91], 0
    v_mfma_f32_16x16x32_bf16 a[152:155], v[20:23], v[128:131], a[152:155]
    v_mfma_f32_16x16x32_bf16 a[156:159], v[16:19], v[96:99], 0
    v_mfma_f32_16x16x32_bf16 a[156:159], v[20:23], v[136:139], a[156:159]
    s_waitcnt lgkmcnt(4)
    v_mfma_f32_16x16x32_bf16 a[0:3], v[32:35], v[144:147], a[0:3]
    v_mfma_f32_16x16x32_bf16 a[0:3], v[36:39], v[184:187], a[0:3]
    v_mfma_f32_16x16x32_bf16 a[4:7], v[32:35], v[152:155], a[4:7]
    ds_read_b64_tr_b16 v[8:9], v248 offset:0
    ds_read_b64_tr_b16 v[10:11], v248 offset:4096
    v_mfma_f32_16x16x32_bf16 a[4:7], v[36:39], v[192:195], a[4:7]
    ds_read_b64_tr_b16 v[12:13], v248 offset:8192
    ds_read_b64_tr_b16 v[14:15], v248 offset:12288
    v_mfma_f32_16x16x32_bf16 a[8:11], v[32:35], v[160:163], a[8:11]
    v_add_u32 v248, s33, v248
    v_mfma_f32_16x16x32_bf16 a[8:11], v[36:39], v[200:203], a[8:11]
    v_mfma_f32_16x16x32_bf16 a[12:15], v[32:35], v[168:171], a[12:15]
    v_mfma_f32_16x16x32_bf16 a[12:15], v[36:39], v[208:211], a[12:15]
    v_mfma_f32_16x16x32_bf16 a[16:19], v[32:35], v[176:179], a[16:19]
    v_mfma_f32_16x16x32_bf16 a[16:19], v[36:39], v[216:219], a[16:19]
    s_waitcnt lgkmcnt(4)
    v_mfma_f32_16x16x32_bf16 a[20:23], v[40:43], v[144:147], a[20:23]
    v_mfma_f32_16x16x32_bf16 a[20:23], v[44:47], v[184:187], a[20:23]
    v_mfma_f32_16x16x32_bf16 a[24:27], v[40:43], v[152:155], a[24:27]
    ds_read_b64_tr_b16 v[16:17], v249 offset:0
    ds_read_b64_tr_b16 v[18:19], v249 offset:4096
    v_mfma_f32_16x16x32_bf16 a[24:27], v[44:47], v[192:195], a[24:27]
    ds_read_b64_tr_b16 v[20:21], v249 offset:8192
    ds_read_b64_tr_b16 v[22:23], v249 offset:12288
    v_mfma_f32_16x16x32_bf16 a[28:31], v[40:43], v[160:163], a[28:31]
    v_add_u32 v249, s33, v249
    v_mfma_f32_16x16x32_bf16 a[28:31], v[44:47], v[200:203], a[28:31]
    v_mfma_f32_16x16x32_bf16 a[32:35], v[40:43], v[168:171], a[32:35]
    v_mfma_f32_16x16x32_bf16 a[32:35], v[44:47], v[208:211], a[32:35]
    v_mfma_f32_16x16x32_bf16 a[36:39], v[40:43], v[176:179], a[36:39]
    v_mfma_f32_16x16x32_bf16 a[36:39], v[44:47], v[216:219], a[36:39]
    s_waitcnt lgkmcnt(4)
    v_mfma_f32_16x16x32_bf16 a[40:43], v[8:11], v[144:147], a[40:43]
    v_mfma_f32_16x16x32_bf16 a[40:43], v[12:15], v[184:187], a[40:43]
    v_mfma_f32_16x16x32_bf16 a[44:47], v[8:11], v[152:155], a[44:47]
    ds_read_b64_tr_b16 v[32:33], v250 offset:0
    ds_read_b64_tr_b16 v[34:35], v250 offset:4096
    v_mfma_f32_16x16x32_bf16 a[44:47], v[12:15], v[192:195], a[44:47]
    ds_read_b64_tr_b16 v[36:37], v250 offset:8192
    ds_read_b64_tr_b16 v[38:39], v250 offset:12288
    v_mfma_f32_16x16x32_bf16 a[48:51], v[8:11], v[160:163], a[48:51]
    v_add_u32 v250, s33, v250
    v_mfma_f32_16x16x32_bf16 a[48:51], v[12:15], v[200:203], a[48:51]
    buffer_load_dword v244, v28, s[44:47], 0 offen sc1
    v_mfma_f32_16x16x32_bf16 a[52:55], v[8:11], v[168:171], a[52:55]
    v_mfma_f32_16x16x32_bf16 a[52:55], v[12:15], v[208:211], a[52:55]
    v_mfma_f32_16x16x32_bf16 a[56:59], v[8:11], v[176:179], a[56:59]
    v_mfma_f32_16x16x32_bf16 a[56:59], v[12:15], v[216:219], a[56:59]
    s_waitcnt lgkmcnt(4)
    v_mfma_f32_16x16x32_bf16 a[60:63], v[16:19], v[144:147], a[60:63]
    v_mfma_f32_16x16x32_bf16 a[60:63], v[20:23], v[184:187], a[60:63]
    v_mfma_f32_16x16x32_bf16 a[64:67], v[16:19], v[152:155], a[64:67]
    ds_read_b64_tr_b16 v[40:41], v251 offset:0
    ds_read_b64_tr_b16 v[42:43], v251 offset:4096
    v_mfma_f32_16x16x32_bf16 a[64:67], v[20:23], v[192:195], a[64:67]
    ds_read_b64_tr_b16 v[44:45], v251 offset:8192
    ds_read_b64_tr_b16 v[46:47], v251 offset:12288
    v_mfma_f32_16x16x32_bf16 a[68:71], v[16:19], v[160:163], a[68:71]
    v_add_u32 v251, s33, v251
    v_mfma_f32_16x16x32_bf16 a[68:71], v[20:23], v[200:203], a[68:71]
    v_mfma_f32_16x16x32_bf16 a[72:75], v[16:19], v[168:171], a[72:75]
    v_mfma_f32_16x16x32_bf16 a[72:75], v[20:23], v[208:211], a[72:75]
    v_mfma_f32_16x16x32_bf16 a[76:79], v[16:19], v[176:179], a[76:79]
    v_mfma_f32_16x16x32_bf16 a[76:79], v[20:23], v[216:219], a[76:79]
    s_waitcnt lgkmcnt(4)
    v_mfma_f32_16x16x32_bf16 a[80:83], v[32:35], v[144:147], a[80:83]
    v_mfma_f32_16x16x32_bf16 a[80:83], v[36:39], v[184:187], a[80:83]
    v_mfma_f32_16x16x32_bf16 a[84:87], v[32:35], v[152:155], a[84:87]
    ds_read_b64_tr_b16 v[8:9], v252 offset:0
    ds_read_b64_tr_b16 v[10:11], v252 offset:4096
    v_mfma_f32_16x16x32_bf16 a[84:87], v[36:39], v[192:195], a[84:87]
    ds_read_b64_tr_b16 v[12:13], v252 offset:8192
    ds_read_b64_tr_b16 v[14:15], v252 offset:12288
    v_mfma_f32_16x16x32_bf16 a[88:91], v[32:35], v[160:163], a[88:91]
    v_add_u32 v252, s33, v252
    v_mfma_f32_16x16x32_bf16 a[88:91], v[36:39], v[200:203], a[88:91]
    v_mfma_f32_16x16x32_bf16 a[92:95], v[32:35], v[168:171], a[92:95]
    v_mfma_f32_16x16x32_bf16 a[92:95], v[36:39], v[208:211], a[92:95]
    v_mfma_f32_16x16x32_bf16 a[96:99], v[32:35], v[176:179], a[96:99]
    v_mfma_f32_16x16x32_bf16 a[96:99], v[36:39], v[216:219], a[96:99]
    s_waitcnt lgkmcnt(4)
    v_mfma_f32_16x16x32_bf16 a[100:103], v[40:43], v[144:147], a[100:103]
    v_mfma_f32_16x16x32_bf16 a[100:103], v[44:47], v[184:187], a[100:103]
    v_mfma_f32_16x16x32_bf16 a[104:107], v[40:43], v[152:155], a[104:107]
    ds_read_b64_tr_b16 v[16:17], v253 offset:0
    ds_read_b64_tr_b16 v[18:19], v253 offset:4096
    v_mfma_f32_16x16x32_bf16 a[104:107], v[44:47], v[192:195], a[104:107]
    ds_read_b64_tr_b16 v[20:21], v253 offset:8192
    ds_read_b64_tr_b16 v[22:23], v253 offset:12288
    v_mfma_f32_16x16x32_bf16 a[108:111], v[40:43], v[160:163], a[108:111]
    v_add_u32 v253, s33, v253
    v_mfma_f32_16x16x32_bf16 a[108:111], v[44:47], v[200:203], a[108:111]
    v_mfma_f32_16x16x32_bf16 a[112:115], v[40:43], v[168:171], a[112:115]
    v_mfma_f32_16x16x32_bf16 a[112:115], v[44:47], v[208:211], a[112:115]
    v_mfma_f32_16x16x32_bf16 a[116:119], v[40:43], v[176:179], a[116:119]
    v_mfma_f32_16x16x32_bf16 a[116:119], v[44:47], v[216:219], a[116:119]
    s_waitcnt lgkmcnt(4)
    v_mfma_f32_16x16x32_bf16 a[120:123], v[8:11], v[144:147], a[120:123]
    s_waitcnt vmcnt(0)
    v_cmp_le_u32 vcc, 2, v244
    s_nop 1
    s_and_b32 s38, vcc_lo, s42
    s_cmp_lg_u32 s38, s42
    s_cbranch_scc1 L_spin_o1
L_back_o1:
    v_mfma_f32_16x16x32_bf16 a[120:123], v[12:15], v[184:187], a[120:123]
    buffer_load_dwordx4 v[68:71], v58, s[16:19], s90 offen offset:0 sc1
    buffer_load_dwordx4 v[76:79], v58, s[16:19], s90 offen offset:1024 sc1
    v_mfma_f32_16x16x32_bf16 a[124:127], v[8:11], v[152:155], a[124:127]
    buffer_load_dwordx4 v[84:87], v58, s[16:19], s90 offen offset:2048 sc1
    buffer_load_dwordx4 v[92:95], v58, s[16:19], s90 offen offset:3072 sc1
    v_mfma_f32_16x16x32_bf16 a[124:127], v[12:15], v[192:195], a[124:127]
    buffer_load_dwordx4 v[100:103], v59, s[16:19], s90 offen offset:0 sc1
    buffer_load_dwordx4 v[108:111], v60, s[16:19], s90 offen offset:0 sc1
    v_mfma_f32_16x16x32_bf16 a[128:131], v[8:11], v[160:163], a[128:131]
    buffer_load_dwordx4 v[116:119], v60, s[16:19], s90 offen offset:1024 sc1
    buffer_load_dwordx4 v[124:127], v60, s[16:19], s90 offen offset:2048 sc1
    v_mfma_f32_16x16x32_bf16 a[128:131], v[12:15], v[200:203], a[128:131]
    buffer_load_dwordx4 v[132:135], v60, s[16:19], s90 offen offset:3072 sc1
    buffer_load_dwordx4 v[140:143], v61, s[16:19], s90 offen offset:0 sc1
    v_mfma_f32_16x16x32_bf16 a[132:135], v[8:11], v[168:171], a[132:135]
    s_waitcnt lgkmcnt(0)
    s_barrier
    v_mfma_f32_16x16x32_bf16 a[132:135], v[12:15], v[208:211], a[132:135]
    ds_read_b64_tr_b16 v[32:33], v246 offset:0
    ds_read_b64_tr_b16 v[34:35], v246 offset:4096
    v_mfma_f32_16x16x32_bf16 a[136:139], v[8:11], v[176:179], a[136:139]
    ds_read_b64_tr_b16 v[36:37], v246 offset:8192
    ds_read_b64_tr_b16 v[38:39], v246 offset:12288
    v_mfma_f32_16x16x32_bf16 a[136:139], v[12:15], v[216:219], a[136:139]
    v_add_u32 v246, s28, v246
    v_mfma_f32_16x16x32_bf16 a[140:143], v[16:19], v[144:147], a[140:143]
    v_mfma_f32_16x16x32_bf16 a[140:143], v[20:23], v[184:187], a[140:143]
    v_mfma_f32_16x16x32_bf16 a[144:147], v[16:19], v[152:155], a[144:147]
    ds_read_b64_tr_b16 v[40:41], v247 offset:0
    ds_read_b64_tr_b16 v[42:43], v247 offset:4096
    v_mfma_f32_16x16x32_bf16 a[144:147], v[20:23], v[192:195], a[144:147]
    ds_read_b64_tr_b16 v[44:45], v247 offset:8192
    ds_read_b64_tr_b16 v[46:47], v247 offset:12288
    v_mfma_f32_16x16x32_bf16 a[148:151], v[16:19], v[160:163], a[148:151]
    v_add_u32 v247, s28, v247
    buffer_load_dwordx4 v[64:67], v58, s[16:19], s91 offen offset:0 sc1
    v_mfma_f32_16x16x32_bf16 a[148:151], v[20:23], v[200:203], a[148:151]
    v_mfma_f32_16x16x32_bf16 a[152:155], v[16:19], v[168:171], a[152:155]
    v_mfma_f32_16x16x32_bf16 a[152:155], v[20:23], v[208:211], a[152:155]
    v_mfma_f32_16x16x32_bf16 a[156:159], v[16:19], v[176:179], a[156:159]
    v_mfma_f32_16x16x32_bf16 a[156:159], v[20:23], v[216:219], a[156:159]
    s_waitcnt lgkmcnt(4)
    s_waitcnt vmcnt(10)
    v_mfma_f32_16x16x32_bf16 a[0:3], v[32:35], v[68:71], a[0:3]
    s_waitcnt vmcnt(5)
    v_mfma_f32_16x16x32_bf16 a[0:3], v[36:39], v[108:111], a[0:3]
    v_mfma_f32_16x16x32_bf16 a[4:7], v[32:35], v[76:79], a[4:7]
    ds_read_b64_tr_b16 v[8:9], v248 offset:0
    ds_read_b64_tr_b16 v[10:11], v248 offset:4096
    buffer_load_dwordx4 v[72:75], v58, s[16:19], s91 offen offset:1024 sc1
    s_waitcnt vmcnt(5)
    v_mfma_f32_16x16x32_bf16 a[4:7], v[36:39], v[116:119], a[4:7]
    ds_read_b64_tr_b16 v[12:13], v248 offset:8192
    ds_read_b64_tr_b16 v[14:15], v248 offset:12288
    v_mfma_f32_16x16x32_bf16 a[8:11], v[32:35], v[84:87], a[8:11]
    v_add_u32 v248, s28, v248
    s_waitcnt vmcnt(4)
    v_mfma_f32_16x16x32_bf16 a[8:11], v[36:39], v[124:127], a[8:11]
    v_mfma_f32_16x16x32_bf16 a[12:15], v[32:35], v[92:95], a[12:15]
    s_waitcnt vmcnt(3)
    v_mfma_f32_16x16x32_bf16 a[12:15], v[36:39], v[132:135], a[12:15]
    v_mfma_f32_16x16x32_bf16 a[16:19], v[32:35], v[100:103], a[16:19]
    s_waitcnt vmcnt(2)
    v_mfma_f32_16x16x32_bf16 a[16:19], v[36:39], v[140:143], a[16:19]
    s_waitcnt lgkmcnt(4)
    v_mfma_f32_16x16x32_bf16 a[20:23], v[40:43], v[68:71], a[20:23]
    buffer_load_dwordx4 v[80:83], v58, s[16:19], s91 offen offset:2048 sc1
    v_mfma_f32_16x16x32_bf16 a[20:23], v[44:47], v[108:111], a[20:23]
    v_mfma_f32_16x16x32_bf16 a[24:27], v[40:43], v[76:79], a[24:27]
    ds_read_b64_tr_b16 v[16:17], v249 offset:0
    ds_read_b64_tr_b16 v[18:19], v249 offset:4096
    v_mfma_f32_16x16x32_bf16 a[24:27], v[44:47], v[116:119], a[24:27]
    ds_read_b64_tr_b16 v[20:21], v249 offset:8192
    ds_read_b64_tr_b16 v[22:23], v249 offset:12288
    v_mfma_f32_16x16x32_bf16 a[28:31], v[40:43], v[84:87], a[28:31]
    v_add_u32 v249, s28, v249
    v_mfma_f32_16x16x32_bf16 a[28:31], v[44:47], v[124:127], a[28:31]
    v_mfma_f32_16x16x32_bf16 a[32:35], v[40:43], v[92:95], a[32:35]
    v_mfma_f32_16x16x32_bf16 a[32:35], v[44:47], v[132:135], a[32:35]
    v_mfma_f32_16x16x32_bf16 a[36:39], v[40:43], v[100:103], a[36:39]
    buffer_load_dwordx4 v[88:91], v58, s[16:19], s91 offen offset:3072 sc1
    v_mfma_f32_16x16x32_bf16 a[36:39], v[44:47], v[140:143], a[36:39]
    s_waitcnt lgkmcnt(4)
    v_mfma_f32_16x16x32_bf16 a[40:43], v[8:11], v[68:71], a[40:43]
    v_mfma_f32_16x16x32_bf16 a[40:43], v[12:15], v[108:111], a[40:43]
    v_mfma_f32_16x16x32_bf16 a[44:47], v[8:11], v[76:79], a[44:47]
    ds_read_b64_tr_b16 v[32:33], v250 offset:0
    ds_read_b64_tr_b16 v[34:35], v250 offset:4096
    v_mfma_f32_16x16x32_bf16 a[44:47], v[12:15], v[116:119], a[44:47]
    ds_read_b64_tr_b16 v[36:37], v250 offset:8192
    ds_read_b64_tr_b16 v[38:39], v250 offset:12288
    v_mfma_f32_16x16x32_bf16 a[48:51], v[8:11], v[84:87], a[48:51]
    v_add_u32 v250, s28, v250
    v_mfma_f32_16x16x32_bf16 a[48:51], v[12:15], v[124:127], a[48:51]
    v_mfma_f32_16x16x32_bf16 a[52:55], v[8:11], v[92:95], a[52:55]
    buffer_load_dwordx4 v[96:99], v59, s[16:19], s91 offen offset:0 sc1
    v_mfma_f32_16x16x32_bf16 a[52:55], v[12:15], v[132:135], a[52:55]
    v_mfma_f32_16x16x32_bf16 a[56:59], v[8:11], v[100:103], a[56:59]
    v_mfma_f32_16x16x32_bf16 a[56:59], v[12:15], v[140:143], a[56:59]
    s_waitcnt lgkmcnt(4)
    v_mfma_f32_16x16x32_bf16 a[60:63], v[16:19], v[68:71], a[60:63]
    v_mfma_f32_16x16x32_bf16 a[60:63], v[20:23], v[108:111], a[60:63]
    v_mfma_f32_16x16x32_bf16 a[64:67], v[16:19], v[76:79], a[64:67]
    ds_read_b64_tr_b16 v[40:41], v251 offset:0
    ds_read_b64_tr_b16 v[42:43], v251 offset:4096
    v_mfma_f32_16x16x32_bf16 a[64:67], v[20:23], v[116:119], a[64:67]
    ds_read_b64_tr_b16 v[44:45], v251 offset:8192
    ds_read_b64_tr_b16 v[46:47], v251 offset:12288
    v_mfma_f32_16x16x32_bf16 a[68:71], v[16:19], v[84:87], a[68:71]
    v_add_u32 v251, s28, v251
    v_mfma_f32_16x16x32_bf16 a[68:71], v[20:23], v[124:127], a[68:71]
    buffer_load_dwordx4 v[104:107], v60, s[16:19], s91 offen offset:0 sc1
    v_mfma_f32_16x16x32_bf16 a[72:75], v[16:19], v[92:95], a[72:75]
    v_mfma_f32_16x16x32_bf16 a[72:75], v[20:23], v[132:135], a[72:75]
    v_mfma_f32_16x16x32_bf16 a[76:79], v[16:19], v[100:103], a[76:79]
    v_mfma_f32_16x16x32_bf16 a[76:79], v[20:23], v[140:143], a[76:79]
    s_waitcnt lgkmcnt(4)
    v_mfma_f32_16x16x32_bf16 a[80:83], v[32:35], v[68:71], a[80:83]
    v_mfma_f32_16x16x32_bf16 a[80:83], v[36:39], v[108:111], a[80:83]
    v_mfma_f32_16x16x32_bf16 a[84:87], v[32:35], v[76:79], a[84:87]
    ds_read_b64_tr_b16 v[8:9], v252 offset:0
    ds_read_b64_tr_b16 v[10:11], v252 offset:4096
    v_mfma_f32_16x16x32_bf16 a[84:87], v[36:39], v[116:119], a[84:87]
    ds_read_b64_tr_b16 v[12:13], v252 offset:8192
    ds_read_b64_tr_b16 v[14:15], v252 offset:12288
    buffer_load_dwordx4 v[112:115], v60, s[16:19], s91 offen offset:1024 sc1
    v_mfma_f32_16x16x32_bf16 a[88:91], v[32:35], v[84:87], a[88:91]
    v_add_u32 v252, s28, v252
    v_mfma_f32_16x16x32_bf16 a[88:91], v[36:39], v[124:127], a[88:91]
    v_mfma_f32_16x16x32_bf16 a[92:95], v[32:35], v[92:95], a[92:95]
    v_mfma_f32_16x16x32_bf16 a[92:95], v[36:39], v[132:135], a[92:95]
    v_mfma_f32_16x16x32_bf16 a[96:99], v[32:35], v[100:103], a[96:99]
    v_mfma_f32_16x16x32_bf16 a[96:99], v[36:39], v[140:143], a[96:99]
    s_waitcnt lgkmcnt(4)
    v_mfma_f32_16x16x32_bf16 a[100:103], v[40:43], v[68:71], a[100:103]
    v_mfma_f32_16x16x32_bf16 a[100:103], v[44:47], v[108:111], a[100:103]
    buffer_load_dwordx4 v[120:123], v60, s[16:19], s91 offen offset:2048 sc1
    v_mfma_f32_16x16x32_bf16 a[104:107], v[40:43], v[76:79], a[104:107]
    ds_read_b64_tr_b16 v[16:17], v253 offset:0
    ds_read_b64_tr_b16 v[18:19], v253 offset:4096
    v_mfma_f32_16x16x32_bf16 a[104:107], v[44:47], v[116:119], a[104:107]
    ds_read_b64_tr_b16 v[20:21], v253 offset:8192
    ds_read_b64_tr_b16 v[22:23], v253 offset:12288
    v_mfma_f32_16x16x32_bf16 a[108:111], v[40:43], v[84:87], a[108:111]
    v_add_u32 v253, s28, v253
    v_mfma_f32_16x16x32_bf16 a[108:111], v[44:47], v[124:127], a[108:111]
    v_mfma_f32_16x16x32_bf16 a[112:115], v[40:43], v[92:95], a[112:115]
    v_mfma_f32_16x16x32_bf16 a[112:115], v[44:47], v[132:135], a[112:115]
    v_mfma_f32_16x16x32_bf16 a[116:119], v[40:43], v[100:103], a[116:119]
    v_mfma_f32_16x16x32_bf16 a[116:119], v[44:47], v[140:143], a[116:119]
    s_waitcnt lgkmcnt(4)
    buffer_load_dwordx4 v[128:131], v60, s[16:19], s91 offen offset:3072 sc1
    v_mfma_f32_16x16x32_bf16 a[120:123], v[8:11], v[68:71], a[120:123]
    v_mfma_f32_16x16x32_bf16 a[120:123], v[12:15], v[108:111], a[120:123]
    v_mfma_f32_16x16x32_bf16 a[124:127], v[8:11], v[76:79], a[124:127]
    ds_read_b64_tr_b16 v[32:33], v246 offset:0
    ds_read_b64_tr_b16 v[34:35], v246 offset:4096
    v_mfma_f32_16x16x32_bf16 a[124:127], v[12:15], v[116:119], a[124:127]
    ds_read_b64_tr_b16 v[36:37], v246 offset:8192
    ds_read_b64_tr_b16 v[38:39], v246 offset:12288
    v_mfma_f32_16x16x32_bf16 a[128:131], v[8:11], v[84:87], a[128:131]
    v_add_u32 v246, s36, v246
    v_mfma_f32_16x16x32_bf16 a[128:131], v[12:15], v[124:127], a[128:131]
    v_mfma_f32_16x16x32_bf16 a[132:135], v[8:11], v[92:95], a[132:135]
    v_mfma_f32_16x16x32_bf16 a[132:135], v[12:15], v[132:135], a[132:135]
    v_mfma_f32_16x16x32_bf16 a[136:139], v[8:11], v[100:103], a[136:139]
    buffer_load_dwordx4 v[136:139], v61, s[16:19], s91 offen offset:0 sc1
    v_mfma_f32_16x16x32_bf16 a[136:139], v[12:15], v[140:143], a[136:139]
    s_waitcnt lgkmcnt(4)
    v_mfma_f32_16x16x32_bf16 a[140:143], v[16:19], v[68:71], a[140:143]
    buffer_load_dword v244, v28, s[44:47], 0 offen sc1
    v_mfma_f32_16x16x32_bf16 a[140:143], v[20:23], v[108:111], a[140:143]
    s_add_u32 m0, s35, 131072
    v_mfma_f32_16x16x32_bf16 a[144:147], v[16:19], v[76:79], a[144:147]
    ds_read_b64_tr_b16 v[40:41], v247 offset:0
    ds_read_b64_tr_b16 v[42:43], v247 offset:4096
    buffer_load_dwordx4 v54, s[12:15], s85 offen offset:0 lds
    v_mfma_f32_16x16x32_bf16 a[144:147], v[20:23], v[116:119], a[144:147]
    ds_read_b64_tr_b16 v[44:45], v247 offset:8192
    ds_read_b64_tr_b16 v[46:47], v247 offset:12288
    v_mfma_f32_16x16x32_bf16 a[148:151], v[16:19], v[84:87], a[148:151]
    v_add_u32 v247, s36, v247
    v_mfma_f32_16x16x32_bf16 a[148:151], v[20:23], v[124:127], a[148:151]
    v_mfma_f32_16x16x32_bf16 a[152:155], v[16:19], v[92:95], a[152:155]
    v_mfma_f32_16x16x32_bf16 a[152:155], v[20:23], v[132:135], a[152:155]
    buffer_load_dwordx4 v55, s[12:15], s85 offen offset:1024 lds
    v_mfma_f32_16x16x32_bf16 a[156:159], v[16:19], v[100:103], a[156:159]
    v_mfma_f32_16x16x32_bf16 a[156:159], v[20:23], v[140:143], a[156:159]
    s_waitcnt lgkmcnt(4)
    s_waitcnt vmcnt(12)
    v_mfma_f32_16x16x32_bf16 a[0:3], v[32:35], v[64:67], a[0:3]
    s_waitcnt vmcnt(7)
    v_mfma_f32_16x16x32_bf16 a[0:3], v[36:39], v[104:107], a[0:3]
    v_mfma_f32_16x16x32_bf16 a[4:7], v[32:35], v[72:75], a[4:7]
    ds_read_b64_tr_b16 v[8:9], v248 offset:0
    ds_read_b64_tr_b16 v[10:11], v248 offset:4096
    buffer_load_dwordx4 v56, s[12:15], s85 offen offset:2048 lds
    s_waitcnt vmcnt(7)
    v_mfma_f32_16x16x32_bf16 a[4:7], v[36:39], v[112:115], a[4:7]
    ds_read_b64_tr_b16 v[12:13], v248 offset:8192
    ds_read_b64_tr_b16 v[14:15], v248 offset:12288
    v_mfma_f32_16x16x32_bf16 a[8:11], v[32:35], v[80:83], a[8:11]
    v_add_u32 v248, s36, v248
    s_waitcnt vmcnt(6)
    v_mfma_f32_16x16x32_bf16 a[8:11], v[36:39], v[120:123], a[8:11]
    v_mfma_f32_16x16x32_bf16 a[12:15], v[32:35], v[88:91], a[12:15]
    s_waitcnt vmcnt(5)
    v_mfma_f32_16x16x32_bf16 a[12:15], v[36:39], v[128:131], a[12:15]
    buffer_load_dwordx4 v57, s[12:15], s85 offen offset:3072 lds
    v_mfma_f32_16x16x32_bf16 a[16:19], v[32:35], v[96:99], a[16:19]
    s_waitcnt vmcnt(5)
    v_mfma_f32_16x16x32_bf16 a[16:19], v[36:39], v[136:139], a[16:19]
    s_waitcnt lgkmcnt(4)
    v_mfma_f32_16x16x32_bf16 a[20:23], v[40:43], v[64:67], a[20:23]
    s_add_u32 s2, s85, 16384
    v_mfma_f32_16x16x32_bf16 a[20:23], v[44:47], v[104:107], a[20:23]
    s_add_u32 m0, s35, 135168
    v_mfma_f32_16x16x32_bf16 a[24:27], v[40:43], v[72:75], a[24:27]
    ds_read_b64_tr_b16 v[16:17], v249 offset:0
    ds_read_b64_tr_b16 v[18:19], v249 offset:4096
    buffer_load_dwordx4 v54, s[12:15], s2 offen offset:0 lds
    v_mfma_f32_16x16x32_bf16 a[24:27], v[44:47], v[112:115], a[24:27]
    ds_read_b64_tr_b16 v[20:21], v249 offset:8192
    ds_read_b64_tr_b16 v[22:23], v249 offset:12288
    v_mfma_f32_16x16x32_bf16 a[28:31], v[40:43], v[80:83], a[28:31]
    v_add_u32 v249, s36, v249
    v_mfma_f32_16x16x32_bf16 a[28:31], v[44:47], v[120:123], a[28:31]
    v_mfma_f32_16x16x32_bf16 a[32:35], v[40:43], v[88:91], a[32:35]
    v_mfma_f32_16x16x32_bf16 a[32:35], v[44:47], v[128:131], a[32:35]
    buffer_load_dwordx4 v55, s[12:15], s2 offen offset:1024 lds
    v_mfma_f32_16x16x32_bf16 a[36:39], v[40:43], v[96:99], a[36:39]
    v_mfma_f32_16x16x32_bf16 a[36:39], v[44:47], v[136:139], a[36:39]
    s_waitcnt lgkmcnt(4)
    v_mfma_f32_16x16x32_bf16 a[40:43], v[8:11], v[64:67], a[40:43]
    v_mfma_f32_16x16x32_bf16 a[40:43], v[12:15], v[104:107], a[40:43]
    v_mfma_f32_16x16x32_bf16 a[44:47], v[8:11], v[72:75], a[44:47]
    ds_read_b64_tr_b16 v[32:33], v250 offset:0
    ds_read_b64_tr_b16 v[34:35], v250 offset:4096
    buffer_load_dwordx4 v56, s[12:15], s2 offen offset:2048 lds
    v_mfma_f32_16x16x32_bf16 a[44:47], v[12:15], v[112:115], a[44:47]
    ds_read_b64_tr_b16 v[36:37], v250 offset:8192
    ds_read_b64_tr_b16 v[38:39], v250 offset:12288
    v_mfma_f32_16x16x32_bf16 a[48:51], v[8:11], v[80:83], a[48:51]
    v_add_u32 v250, s36, v250
    v_mfma_f32_16x16x32_bf16 a[48:51], v[12:15], v[120:123], a[48:51]
    v_mfma_f32_16x16x32_bf16 a[52:55], v[8:11], v[88:91], a[52:55]
    v_mfma_f32_16x16x32_bf16 a[52:55], v[12:15], v[128:131], a[52:55]
    buffer_load_dwordx4 v57, s[12:15], s2 offen offset:3072 lds
    v_mfma_f32_16x16x32_bf16 a[56:59], v[8:11], v[96:99], a[56:59]
    v_mfma_f32_16x16x32_bf16 a[56:59], v[12:15], v[136:139], a[56:59]
    s_waitcnt lgkmcnt(4)
    v_mfma_f32_16x16x32_bf16 a[60:63], v[16:19], v[64:67], a[60:63]
    s_waitcnt vmcnt(8)
    v_cmp_le_u32 vcc, 2, v244
    s_nop 1
    s_and_b32 s38, vcc_lo, s60
    s_cmp_lg_u32 s38, s60
    s_cbranch_scc1 L_spin_o2
L_back_o2:
    v_mfma_f32_16x16x32_bf16 a[60:63], v[20:23], v[104:107], a[60:63]
    buffer_load_dwordx4 v[144:147], v58, s[16:19], s92 offen offset:0 sc1
    v_mfma_f32_16x16x32_bf16 a[64:67], v[16:19], v[72:75], a[64:67]
    ds_read_b64_tr_b16 v[40:41], v251 offset:0
    ds_read_b64_tr_b16 v[42:43], v251 offset:4096
    v_mfma_f32_16x16x32_bf16 a[64:67], v[20:23], v[112:115], a[64:67]
    ds_read_b64_tr_b16 v[44:45], v251 offset:8192
    ds_read_b64_tr_b16 v[46:47], v251 offset:12288
    v_mfma_f32_16x16x32_bf16 a[68:71], v[16:19], v[80:83], a[68:71]
    v_add_u32 v251, s36, v251
    buffer_load_dwordx4 v[152:155], v58, s[16:19], s92 offen offset:1024 sc1
    v_mfma_f32_16x16x32_bf16 a[68:71], v[20:23], v[120:123], a[68:71]
    v_mfma_f32_16x16x32_bf16 a[72:75], v[16:19], v[88:91], a[72:75]
    v_mfma_f32_16x16x32_bf16 a[72:75], v[20:23], v[128:131], a[72:75]
    v_mfma_f32_16x16x32_bf16 a[76:79], v[16:19], v[96:99], a[76:79]
    buffer_load_dwordx4 v[160:163], v58, s[16:19], s92 offen offset:2048 sc1
    v_mfma_f32_16x16x32_bf16 a[76:79], v[20:23], v[136:139], a[76:79]
    s_waitcnt lgkmcnt(4)
    v_mfma_f32_16x16x32_bf16 a[80:83], v[32:35], v[64:67], a[80:83]
    v_mfma_f32_16x16x32_bf16 a[80:83], v[36:39], v[104:107], a[80:83]
    v_mfma_f32_16x16x32_bf16 a[84:87], v[32:35], v[72:75], a[84:87]
    ds_read_b64_tr_b16 v[8:9], v252 offset:0
    ds_read_b64_tr_b16 v[10:11], v252 offset:4096
    buffer_load_dwordx4 v[168:171], v58, s[16:19], s92 offen offset:3072 sc1
    v_mfma_f32_16x16x32_bf16 a[84:87], v[36:39], v[112:115], a[84:87]
    ds_read_b64_tr_b16 v[12:13], v252 offset:8192
    ds_read_b64_tr_b16 v[14:15], v252 offset:12288
    v_mfma_f32_16x16x32_bf16 a[88:91], v[32:35], v[80:83], a[88:91]
    v_add_u32 v252, s36, v252
    v_mfma_f32_16x16x32_bf16 a[88:91], v[36:39], v[120:123], a[88:91]
    buffer_load_dwordx4 v[176:179], v59, s[16:19], s92 offen offset:0 sc1
    v_mfma_f32_16x16x32_bf16 a[92:95], v[32:35], v[88:91], a[92:95]
    v_mfma_f32_16x16x32_bf16 a[92:95], v[36:39], v[128:131], a[92:95]
    v_mfma_f32_16x16x32_bf16 a[96:99], v[32:35], v[96:99], a[96:99]
    v_mfma_f32_16x16x32_bf16 a[96:99], v[36:39], v[136:139], a[96:99]
    s_waitcnt lgkmcnt(4)
    buffer_load_dwordx4 v[184:187], v60, s[16:19], s92 offen offset:0 sc1
    v_mfma_f32_16x16x32_bf16 a[100:103], v[40:43], v[64:67], a[100:103]
    v_mfma_f32_16x16x32_bf16 a[100:103], v[44:47], v[104:107], a[100:103]
    v_mfma_f32_16x16x32_bf16 a[104:107], v[40:43], v[72:75], a[104:107]
    ds_read_b64_tr_b16 v[16:17], v253 offset:0
    ds_read_b64_tr_b16 v[18:19], v253 offset:4096
    v_mfma_f32_16x16x32_bf16 a[104:107], v[44:47], v[112:115], a[104:107]
    ds_read_b64_tr_b16 v[20:21], v253 offset:8192
    ds_read_b64_tr_b16 v[22:23], v253 offset:12288
    buffer_load_dwordx4 v[192:195], v60, s[16:19], s92 offen offset:1024 sc1
    v_mfma_f32_16x16x32_bf16 a[108:111], v[40:43], v[80:83], a[108:111]
    v_add_u32 v253, s36, v253
    v_mfma_f32_16x16x32_bf16 a[108:111], v[44:47], v[120:123], a[108:111]
    v_mfma_f32_16x16x32_bf16 a[112:115], v[40:43], v[88:91], a[112:115]
    buffer_load_dwordx4 v[200:203], v60, s[16:19], s92 offen offset:2048 sc1
    v_mfma_f32_16x16x32_bf16 a[112:115], v[44:47], v[128:131], a[112:115]
    v_mfma_f32_16x16x32_bf16 a[116:119], v[40:43], v[96:99], a[116:119]
    v_mfma_f32_16x16x32_bf16 a[116:119], v[44:47], v[136:139], a[116:119]
    s_waitcnt lgkmcnt(4)
    v_mfma_f32_16x16x32_bf16 a[120:123], v[8:11], v[64:67], a[120:123]
    buffer_load_dwordx4 v[208:211], v60, s[16:19], s92 offen offset:3072 sc1
    v_mfma_f32_16x16x32_bf16 a[120:123], v[12:15], v[104:107], a[120:123]
    v_mfma_f32_16x16x32_bf16 a[124:127], v[8:11], v[72:75], a[124:127]
    v_mfma_f32_16x16x32_bf16 a[124:127], v[12:15], v[112:115], a[124:127]
    v_mfma_f32_16x16x32_bf16 a[128:131], v[8:11], v[80:83], a[128:131]
    buffer_load_dwordx4 v[216:219], v61, s[16:19], s92 offen offset:0 sc1
    v_mfma_f32_16x16x32_bf16 a[128:131], v[12:15], v[120:123], a[128:131]
    v_mfma_f32_16x16x32_bf16 a[132:135], v[8:11], v[88:91], a[132:135]
    s_waitcnt lgkmcnt(0)
    s_waitcnt vmcnt(10)
    s_barrier
    v_mfma_f32_16x16x32_bf16 a[132:135], v[12:15], v[128:131], a[132:135]
    ds_read_b64_tr_b16 v[32:33], v246 offset:0
    ds_read_b64_tr_b16 v[34:35], v246 offset:4096
    v_mfma_f32_16x16x32_bf16 a[136:139], v[8:11], v[96:99], a[136:139]
    ds_read_b64_tr_b16 v[36:37], v246 offset:8192
    ds_read_b64_tr_b16 v[38:39], v246 offset:12288
    s_add_u32 m0, s35, 0
    v_mfma_f32_16x16x32_bf16 a[136:139], v[12:15], v[136:139], a[136:139]
    v_add_u32 v246, s37, v246
    buffer_load_dwordx4 v54, s[12:15], s86 offen offset:0 lds
    v_mfma_f32_16x16x32_bf16 a[140:143], v[16:19], v[64:67], a[140:143]
    v_mfma_f32_16x16x32_bf16 a[140:143], v[20:23], v[104:107], a[140:143]
    v_mfma_f32_16x16x32_bf16 a[144:147], v[16:19], v[72:75], a[144:147]
    ds_read_b64_tr_b16 v[40:41], v247 offset:0
    ds_read_b64_tr_b16 v[42:43], v247 offset:4096
    buffer_load_dwordx4 v55, s[12:15], s86 offen offset:1024 lds
    v_mfma_f32_16x16x32_bf16 a[144:147], v[20:23], v[112:115], a[144:147]
    ds_read_b64_tr_b16 v[44:45], v247 offset:8192
    ds_read_b64_tr_b16 v[46:47], v247 offset:12288
    v_mfma_f32_16x16x32_bf16 a[148:151], v[16:19], v[80:83], a[148:151]
    v_add_u32 v247, s37, v247
    v_mfma_f32_16x16x32_bf16 a[148:151], v[20:23], v[120:123], a[148:151]
    buffer_load_dwordx4 v56, s[12:15], s86 offen offset:2048 lds
    v_mfma_f32_16x16x32_bf16 a[152:155], v[16:19], v[88:91], a[152:155]
    v_mfma_f32_16x16x32_bf16 a[152:155], v[20:23], v[128:131], a[152:155]
    v_mfma_f32_16x16x32_bf16 a[156:159], v[16:19], v[96:99], a[156:159]
    buffer_load_dwordx4 v57, s[12:15], s86 offen offset:3072 lds
    v_mfma_f32_16x16x32_bf16 a[156:159], v[20:23], v[136:139], a[156:159]
    s_waitcnt lgkmcnt(4)
    s_add_u32 s2, s86, 16384
    s_waitcnt vmcnt(13)
    v_mfma_f32_16x16x32_bf16 a[0:3], v[32:35], v[144:147], a[0:3]
    s_add_u32 m0, s35, 4096
    s_waitcnt vmcnt(8)
    v_mfma_f32_16x16x32_bf16 a[0:3], v[36:39], v[184:187], a[0:3]
    buffer_load_dwordx4 v54, s[12:15], s2 offen offset:0 lds
    v_mfma_f32_16x16x32_bf16 a[4:7], v[32:35], v[152:155], a[4:7]
    ds_read_b64_tr_b16 v[8:9], v248 offset:0
    ds_read_b64_tr_b16 v[10:11], v248 offset:4096
    s_waitcnt vmcnt(8)
    v_mfma_f32_16x16x32_bf16 a[4:7], v[36:39], v[192:195], a[4:7]
    ds_read_b64_tr_b16 v[12:13], v248 offset:8192
    ds_read_b64_tr_b16 v[14:15], v248 offset:12288
    v_mfma_f32_16x16x32_bf16 a[8:11], v[32:35], v[160:163], a[8:11]
    v_add_u32 v248, s37, v248
    buffer_load_dwordx4 v55, s[12:15], s2 offen offset:1024 lds
    s_waitcnt vmcnt(8)
    v_mfma_f32_16x16x32_bf16 a[8:11], v[36:39], v[200:203], a[8:11]
    v_mfma_f32_16x16x32_bf16 a[12:15], v[32:35], v[168:171], a[12:15]
    s_waitcnt vmcnt(7)
    v_mfma_f32_16x16x32_bf16 a[12:15], v[36:39], v[208:211], a[12:15]
    buffer_load_dwordx4 v56, s[12:15], s2 offen offset:2048 lds
    v_mfma_f32_16x16x32_bf16 a[16:19], v[32:35], v[176:179], a[16:19]
    s_waitcnt vmcnt(7)
    v_mfma_f32_16x16x32_bf16 a[16:19], v[36:39], v[216:219], a[16:19]
    s_waitcnt lgkmcnt(4)
    v_mfma_f32_16x16x32_bf16 a[20:23], v[40:43], v[144:147], a[20:23]
    buffer_load_dwordx4 v57, s[12:15], s2 offen offset:3072 lds
    v_mfma_f32_16x16x32_bf16 a[20:23], v[44:47], v[184:187], a[20:23]
    v_mfma_f32_16x16x32_bf16 a[24:27], v[40:43], v[152:155], a[24:27]
    ds_read_b64_tr_b16 v[16:17], v249 offset:0
    ds_read_b64_tr_b16 v[18:19], v249 offset:4096
    v_mfma_f32_16x16x32_bf16 a[24:27], v[44:47], v[192:195], a[24:27]
    ds_read_b64_tr_b16 v[20:21], v249 offset:8192
    ds_read_b64_tr_b16 v[22:23], v249 offset:12288
    s_add_u32 m0, s35, 32768
    v_mfma_f32_16x16x32_bf16 a[28:31], v[40:43], v[160:163], a[28:31]
    v_add_u32 v249, s37, v249
    buffer_load_dwordx4 v54, s[12:15], s87 offen offset:0 lds
    v_mfma_f32_16x16x32_bf16 a[28:31], v[44:47], v[200:203], a[28:31]
    v_mfma_f32_16x16x32_bf16 a[32:35], v[40:43], v[168:171], a[32:35]
    v_mfma_f32_16x16x32_bf16 a[32:35], v[44:47], v[208:211], a[32:35]
    buffer_load_dwordx4 v55, s[12:15], s87 offen offset:1024 lds
    v_mfma_f32_16x16x32_bf16 a[36:39], v[40:43], v[176:179], a[36:39]
    v_mfma_f32_16x16x32_bf16 a[36:39], v[44:47], v[216:219], a[36:39]
    s_waitcnt lgkmcnt(4)
    v_mfma_f32_16x16x32_bf16 a[40:43], v[8:11], v[144:147], a[40:43]
    buffer_load_dwordx4 v56, s[12:15], s87 offen offset:2048 lds
    v_mfma_f32_16x16x32_bf16 a[40:43], v[12:15], v[184:187], a[40:43]
    v_mfma_f32_16x16x32_bf16 a[44:47], v[8:11], v[152:155], a[44:47]
    ds_read_b64_tr_b16 v[32:33], v250 offset:0
    ds_read_b64_tr_b16 v[34:35], v250 offset:4096
    v_mfma_f32_16x16x32_bf16 a[44:47], v[12:15], v[192:195], a[44:47]
    ds_read_b64_tr_b16 v[36:37], v250 offset:8192
    ds_read_b64_tr_b16 v[38:39], v250 offset:12288
    buffer_load_dwordx4 v57, s[12:15], s87 offen offset:3072 lds
    v_mfma_f32_16x16x32_bf16 a[48:51], v[8:11], v[160:163], a[48:51]
    v_add_u32 v250, s37, v250
    s_add_u32 s2, s87, 16384
    v_mfma_f32_16x16x32_bf16 a[48:51], v[12:15], v[200:203], a[48:51]
    s_add_u32 m0, s35, 36864
    v_mfma_f32_16x16x32_bf16 a[52:55], v[8:11], v[168:171], a[52:55]
    buffer_load_dwordx4 v54, s[12:15], s2 offen offset:0 lds
    v_mfma_f32_16x16x32_bf16 a[52:55], v[12:15], v[208:211], a[52:55]
    v_mfma_f32_16x16x32_bf16 a[56:59], v[8:11], v[176:179], a[56:59]
    v_mfma_f32_16x16x32_bf16 a[56:59], v[12:15], v[216:219], a[56:59]
    s_waitcnt lgkmcnt(4)
    buffer_load_dwordx4 v55, s[12:15], s2 offen offset:1024 lds
    v_mfma_f32_16x16x32_bf16 a[60:63], v[16:19], v[144:147], a[60:63]
    buffer_load_dword v244, v28, s[44:47], 0 offen sc1
    v_mfma_f32_16x16x32_bf16 a[60:63], v[20:23], v[184:187], a[60:63]
    v_mfma_f32_16x16x32_bf16 a[64:67], v[16:19], v[152:155], a[64:67]
    ds_read_b64_tr_b16 v[40:41], v251 offset:0
    ds_read_b64_tr_b16 v[42:43], v251 offset:4096
    buffer_load_dwordx4 v56, s[12:15], s2 offen offset:2048 lds
    v_mfma_f32_16x16x32_bf16 a[64:67], v[20:23], v[192:195], a[64:67]
    ds_read_b64_tr_b16 v[44:45], v251 offset:8192
    ds_read_b64_tr_b16 v[46:47], v251 offset:12288
    v_mfma_f32_16x16x32_bf16 a[68:71], v[16:19], v[160:163], a[68:71]
    v_add_u32 v251, s37, v251
    v_mfma_f32_16x16x32_bf16 a[68:71], v[20:23], v[200:203], a[68:71]
    v_mfma_f32_16x16x32_bf16 a[72:75], v[16:19], v[168:171], a[72:75]
    buffer_load_dwordx4 v57, s[12:15], s2 offen offset:3072 lds
    v_mfma_f32_16x16x32_bf16 a[72:75], v[20:23], v[208:211], a[72:75]
    v_mfma_f32_16x16x32_bf16 a[76:79], v[16:19], v[176:179], a[76:79]
    v_mfma_f32_16x16x32_bf16 a[76:79], v[20:23], v[216:219], a[76:79]
    s_waitcnt lgkmcnt(4)
    buffer_load_dwordx4 v[68:71], v58, s[16:19], s93 offen offset:0 sc1
    v_mfma_f32_16x16x32_bf16 a[80:83], v[32:35], v[144:147], a[80:83]
    v_mfma_f32_16x16x32_bf16 a[80:83], v[36:39], v[184:187], a[80:83]
    v_mfma_f32_16x16x32_bf16 a[84:87], v[32:35], v[152:155], a[84:87]
    ds_read_b64_tr_b16 v[8:9], v252 offset:0
    ds_read_b64_tr_b16 v[10:11], v252 offset:4096
    buffer_load_dwordx4 v[76:79], v58, s[16:19], s93 offen offset:1024 sc1
    v_mfma_f32_16x16x32_bf16 a[84:87], v[36:39], v[192:195], a[84:87]
    ds_read_b64_tr_b16 v[12:13], v252 offset:8192
    ds_read_b64_tr_b16 v[14:15], v252 offset:12288
    v_mfma_f32_16x16x32_bf16 a[88:91], v[32:35], v[160:163], a[88:91]
    v_add_u32 v252, s37, v252
    v_mfma_f32_16x16x32_bf16 a[88:91], v[36:39], v[200:203], a[88:91]
    buffer_load_dwordx4 v[84:87], v58, s[16:19], s93 offen offset:2048 sc1
    v_mfma_f32_16x16x32_bf16 a[92:95], v[32:35], v[168:171], a[92:95]
    v_mfma_f32_16x16x32_bf16 a[92:95], v[36:39], v[208:211], a[92:95]
    v_mfma_f32_16x16x32_bf16 a[96:99], v[32:35], v[176:179], a[96:99]
    buffer_load_dwordx4 v[92:95], v58, s[16:19], s93 offen offset:3072 sc1
    v_mfma_f32_16x16x32_bf16 a[96:99], v[36:39], v[216:219], a[96:99]
    s_waitcnt lgkmcnt(4)
    v_mfma_f32_16x16x32_bf16 a[100:103], v[40:43], v[144:147], a[100:103]
    v_mfma_f32_16x16x32_bf16 a[100:103], v[44:47], v[184:187], a[100:103]
    buffer_load_dwordx4 v[100:103], v59, s[16:19], s93 offen offset:0 sc1
    v_mfma_f32_16x16x32_bf16 a[104:107], v[40:43], v[152:155], a[104:107]
    ds_read_b64_tr_b16 v[16:17], v253 offset:0
    ds_read_b64_tr_b16 v[18:19], v253 offset:4096
    v_mfma_f32_16x16x32_bf16 a[104:107], v[44:47], v[192:195], a[104:107]
    ds_read_b64_tr_b16 v[20:21], v253 offset:8192
    ds_read_b64_tr_b16 v[22:23], v253 offset:12288
    v_mfma_f32_16x16x32_bf16 a[108:111], v[40:43], v[160:163], a[108:111]
    v_add_u32 v253, s37, v253
    buffer_load_dwordx4 v[108:111], v60, s[16:19], s93 offen offset:0 sc1
    v_mfma_f32_16x16x32_bf16 a[108:111], v[44:47], v[200:203], a[108:111]
    v_mfma_f32_16x16x32_bf16 a[112:115], v[40:43], v[168:171], a[112:115]
    v_mfma_f32_16x16x32_bf16 a[112:115], v[44:47], v[208:211], a[112:115]
    buffer_load_dwordx4 v[116:119], v60, s[16:19], s93 offen offset:1024 sc1
    v_mfma_f32_16x16x32_bf16 a[116:119], v[40:43], v[176:179], a[116:119]
    v_mfma_f32_16x16x32_bf16 a[116:119], v[44:47], v[216:219], a[116:119]
    s_waitcnt lgkmcnt(4)
    v_mfma_f32_16x16x32_bf16 a[120:123], v[8:11], v[144:147], a[120:123]
    buffer_load_dwordx4 v[124:127], v60, s[16:19], s93 offen offset:2048 sc1
    v_mfma_f32_16x16x32_bf16 a[120:123], v[12:15], v[184:187], a[120:123]
    v_mfma_f32_16x16x32_bf16 a[124:127], v[8:11], v[152:155], a[124:127]
    ds_read_b64_tr_b16 v[32:33], v246 offset:0
    ds_read_b64_tr_b16 v[34:35], v246 offset:4096
    v_mfma_f32_16x16x32_bf16 a[124:127], v[12:15], v[192:195], a[124:127]
    ds_read_b64_tr_b16 v[36:37], v246 offset:8192
    ds_read_b64_tr_b16 v[38:39], v246 offset:12288
    buffer_load_dwordx4 v[132:135], v60, s[16:19], s93 offen offset:3072 sc1
    v_mfma_f32_16x16x32_bf16 a[128:131], v[8:11], v[160:163], a[128:131]
    v_add_u32 v246, s34, v246
    v_mfma_f32_16x16x32_bf16 a[128:131], v[12:15], v[200:203], a[128:131]
    v_mfma_f32_16x16x32_bf16 a[132:135], v[8:11], v[168:171], a[132:135]
    v_mfma_f32_16x16x32_bf16 a[132:135], v[12:15], v[208:211], a[132:135]
    buffer_load_dwordx4 v[140:143], v61, s[16:19], s93 offen offset:0 sc1
    v_mfma_f32_16x16x32_bf16 a[136:139], v[8:11], v[176:179], a[136:139]
    v_mfma_f32_16x16x32_bf16 a[136:139], v[12:15], v[216:219], a[136:139]
    s_waitcnt lgkmcnt(4)
    v_mfma_f32_16x16x32_bf16 a[140:143], v[16:19], v[144:147], a[140:143]
    s_waitcnt vmcnt(12)
    v_cmp_le_u32 vcc, 2, v244
    s_nop 1
    s_and_b32 s38, vcc_lo, s61
    s_cmp_lg_u32 s38, s61
    s_cbranch_scc1 L_spin_o3
L_back_o3:
    v_mfma_f32_16x16x32_bf16 a[140:143], v[20:23], v[184:187], a[140:143]
    buffer_load_dwordx4 v[64:67], v58, s[16:19], s94 offen offset:0 sc1
    v_mfma_f32_16x16x32_bf16 a[144:147], v[16:19], v[152:155], a[144:147]
    ds_read_b64_tr_b16 v[40:41], v247 offset:0
    ds_read_b64_tr_b16 v[42:43], v247 offset:4096
    v_mfma_f32_16x16x32_bf16 a[144:147], v[20:23], v[192:195], a[144:147]
    ds_read_b64_tr_b16 v[44:45], v247 offset:8192
    ds_read_b64_tr_b16 v[46:47], v247 offset:12288
    buffer_load_dwordx4 v[72:75], v58, s[16:19], s94 offen offset:1024 sc1
    v_mfma_f32_16x16x32_bf16 a[148:151], v[16:19], v[160:163], a[148:151]
    v_add_u32 v247, s34, v247
    v_mfma_f32_16x16x32_bf16 a[148:151], v[20:23], v[200:203], a[148:151]
    v_mfma_f32_16x16x32_bf16 a[152:155], v[16:19], v[168:171], a[152:155]
    buffer_load_dwordx4 v[80:83], v58, s[16:19], s94 offen offset:2048 sc1
    v_mfma_f32_16x16x32_bf16 a[152:155], v[20:23], v[208:211], a[152:155]
    v_mfma_f32_16x16x32_bf16 a[156:159], v[16:19], v[176:179], a[156:159]
    buffer_load_dwordx4 v[88:91], v58, s[16:19], s94 offen offset:3072 sc1
    v_mfma_f32_16x16x32_bf16 a[156:159], v[20:23], v[216:219], a[156:159]
    s_waitcnt lgkmcnt(4)
    s_waitcnt vmcnt(13)
    v_mfma_f32_16x16x32_bf16 a[0:3], v[32:35], v[68:71], a[0:3]
    s_waitcnt vmcnt(8)
    v_mfma_f32_16x16x32_bf16 a[0:3], v[36:39], v[108:111], a[0:3]
    buffer_load_dwordx4 v[96:99], v59, s[16:19], s94 offen offset:0 sc1
    v_mfma_f32_16x16x32_bf16 a[4:7], v[32:35], v[76:79], a[4:7]
    ds_read_b64_tr_b16 v[8:9], v248 offset:0
    ds_read_b64_tr_b16 v[10:11], v248 offset:4096
    s_waitcnt vmcnt(8)
    v_mfma_f32_16x16x32_bf16 a[4:7], v[36:39], v[116:119], a[4:7]
    ds_read_b64_tr_b16 v[12:13], v248 offset:8192
    ds_read_b64_tr_b16 v[14:15], v248 offset:12288
    buffer_load_dwordx4 v[104:107], v60, s[16:19], s94 offen offset:0 sc1
    v_mfma_f32_16x16x32_bf16 a[8:11], v[32:35], v[84:87], a[8:11]
    v_add_u32 v248, s34, v248
    s_waitcnt vmcnt(8)
    v_mfma_f32_16x16x32_bf16 a[8:11], v[36:39], v[124:127], a[8:11]
    v_mfma_f32_16x16x32_bf16 a[12:15], v[32:35], v[92:95], a[12:15]
    buffer_load_dwordx4 v[112:115], v60, s[16:19], s94 offen offset:1024 sc1
    s_waitcnt vmcnt(8)
    v_mfma_f32_16x16x32_bf16 a[12:15], v[36:39], v[132:135], a[12:15]
    v_mfma_f32_16x16x32_bf16 a[16:19], v[32:35], v[100:103], a[16:19]
    buffer_load_dwordx4 v[120:123], v60, s[16:19], s94 offen offset:2048 sc1
    s_waitcnt vmcnt(8)
    v_mfma_f32_16x16x32_bf16 a[16:19], v[36:39], v[140:143], a[16:19]
    s_waitcnt lgkmcnt(4)
    v_mfma_f32_16x16x32_bf16 a[20:23], v[40:43], v[68:71], a[20:23]
    v_mfma_f32_16x16x32_bf16 a[20:23], v[44:47], v[108:111], a[20:23]
    buffer_load_dwordx4 v[128:131], v60, s[16:19], s94 offen offset:3072 sc1
    v_mfma_f32_16x16x32_bf16 a[24:27], v[40:43], v[76:79], a[24:27]
    ds_read_b64_tr_b16 v[16:17], v249 offset:0
    ds_read_b64_tr_b16 v[18:19], v249 offset:4096
    v_mfma_f32_16x16x32_bf16 a[24:27], v[44:47], v[116:119], a[24:27]
    ds_read_b64_tr_b16 v[20:21], v249 offset:8192
    ds_read_b64_tr_b16 v[22:23], v249 offset:12288
    v_mfma_f32_16x16x32_bf16 a[28:31], v[40:43], v[84:87], a[28:31]
    v_add_u32 v249, s34, v249
    buffer_load_dwordx4 v[136:139], v61, s[16:19], s94 offen offset:0 sc1
    v_mfma_f32_16x16x32_bf16 a[28:31], v[44:47], v[124:127], a[28:31]
    v_mfma_f32_16x16x32_bf16 a[32:35], v[40:43], v[92:95], a[32:35]
    v_mfma_f32_16x16x32_bf16 a[32:35], v[44:47], v[132:135], a[32:35]
    buffer_load_dwordx4 v[144:147], v58, s[16:19], s95 offen offset:0 sc1
    v_mfma_f32_16x16x32_bf16 a[36:39], v[40:43], v[100:103], a[36:39]
    v_mfma_f32_16x16x32_bf16 a[36:39], v[44:47], v[140:143], a[36:39]
    s_waitcnt lgkmcnt(4)
    buffer_load_dwordx4 v[152:155], v58, s[16:19], s95 offen offset:1024 sc1
    v_mfma_f32_16x16x32_bf16 a[40:43], v[8:11], v[68:71], a[40:43]
    v_mfma_f32_16x16x32_bf16 a[40:43], v[12:15], v[108:111], a[40:43]
    v_mfma_f32_16x16x32_bf16 a[44:47], v[8:11], v[76:79], a[44:47]
    ds_read_b64_tr_b16 v[32:33], v250 offset:0
    ds_read_b64_tr_b16 v[34:35], v250 offset:4096
    buffer_load_dwordx4 v[160:163], v58, s[16:19], s95 offen offset:2048 sc1
    v_mfma_f32_16x16x32_bf16 a[44:47], v[12:15], v[116:119], a[44:47]
    ds_read_b64_tr_b16 v[36:37], v250 offset:8192
    ds_read_b64_tr_b16 v[38:39], v250 offset:12288
    v_mfma_f32_16x16x32_bf16 a[48:51], v[8:11], v[84:87], a[48:51]
    v_add_u32 v250, s34, v250
    buffer_load_dwordx4 v[168:171], v58, s[16:19], s95 offen offset:3072 sc1
    v_mfma_f32_16x16x32_bf16 a[48:51], v[12:15], v[124:127], a[48:51]
    v_mfma_f32_16x16x32_bf16 a[52:55], v[8:11], v[92:95], a[52:55]
    v_mfma_f32_16x16x32_bf16 a[52:55], v[12:15], v[132:135], a[52:55]
    buffer_load_dwordx4 v[176:179], v59, s[16:19], s95 offen offset:0 sc1
    v_mfma_f32_16x16x32_bf16 a[56:59], v[8:11], v[100:103], a[56:59]
    v_mfma_f32_16x16x32_bf16 a[56:59], v[12:15], v[140:143], a[56:59]
    s_waitcnt lgkmcnt(4)
    buffer_load_dwordx4 v[184:187], v60, s[16:19], s95 offen offset:0 sc1
    v_mfma_f32_16x16x32_bf16 a[60:63], v[16:19], v[68:71], a[60:63]
    v_mfma_f32_16x16x32_bf16 a[60:63], v[20:23], v[108:111], a[60:63]
    v_mfma_f32_16x16x32_bf16 a[64:67], v[16:19], v[76:79], a[64:67]
    ds_read_b64_tr_b16 v[40:41], v251 offset:0
    ds_read_b64_tr_b16 v[42:43], v251 offset:4096
    buffer_load_dwordx4 v[192:195], v60, s[16:19], s95 offen offset:1024 sc1
    v_mfma_f32_16x16x32_bf16 a[64:67], v[20:23], v[116:119], a[64:67]
    ds_read_b64_tr_b16 v[44:45], v251 offset:8192
    ds_read_b64_tr_b16 v[46:47], v251 offset:12288
    v_mfma_f32_16x16x32_bf16 a[68:71], v[16:19], v[84:87], a[68:71]
    v_add_u32 v251, s34, v251
    buffer_load_dwordx4 v[200:203], v60, s[16:19], s95 offen offset:2048 sc1
    v_mfma_f32_16x16x32_bf16 a[68:71], v[20:23], v[124:127], a[68:71]
    v_mfma_f32_16x16x32_bf16 a[72:75], v[16:19], v[92:95], a[72:75]
    v_mfma_f32_16x16x32_bf16 a[72:75], v[20:23], v[132:135], a[72:75]
    buffer_load_dwordx4 v[208:211], v60, s[16:19], s95 offen offset:3072 sc1
    v_mfma_f32_16x16x32_bf16 a[76:79], v[16:19], v[100:103], a[76:79]
    v_mfma_f32_16x16x32_bf16 a[76:79], v[20:23], v[140:143], a[76:79]
    s_waitcnt lgkmcnt(4)
    v_mfma_f32_16x16x32_bf16 a[80:83], v[32:35], v[68:71], a[80:83]
    buffer_load_dwordx4 v[216:219], v61, s[16:19], s95 offen offset:0 sc1
    v_mfma_f32_16x16x32_bf16 a[80:83], v[36:39], v[108:111], a[80:83]
    v_mfma_f32_16x16x32_bf16 a[84:87], v[32:35], v[76:79], a[84:87]
    ds_read_b64_tr_b16 v[8:9], v252 offset:0
    ds_read_b64_tr_b16 v[10:11], v252 offset:4096
    v_mfma_f32_16x16x32_bf16 a[84:87], v[36:39], v[116:119], a[84:87]
    ds_read_b64_tr_b16 v[12:13], v252 offset:8192
    ds_read_b64_tr_b16 v[14:15], v252 offset:12288
    v_mfma_f32_16x16x32_bf16 a[88:91], v[32:35], v[84:87], a[88:91]
    v_add_u32 v252, s34, v252
    v_mfma_f32_16x16x32_bf16 a[88:91], v[36:39], v[124:127], a[88:91]
    v_mfma_f32_16x16x32_bf16 a[92:95], v[32:35], v[92:95], a[92:95]
    v_mfma_f32_16x16x32_bf16 a[92:95], v[36:39], v[132:135], a[92:95]
    v_mfma_f32_16x16x32_bf16 a[96:99], v[32:35], v[100:103], a[96:99]
    v_mfma_f32_16x16x32_bf16 a[96:99], v[36:39], v[140:143], a[96:99]
    s_waitcnt lgkmcnt(4)
    v_mfma_f32_16x16x32_bf16 a[100:103], v[40:43], v[68:71], a[100:103]
    v_mfma_f32_16x16x32_bf16 a[100:103], v[44:47], v[108:111], a[100:103]
    v_mfma_f32_16x16x32_bf16 a[104:107], v[40:43], v[76:79], a[104:107]
    ds_read_b64_tr_b16 v[16:17], v253 offset:0
    ds_read_b64_tr_b16 v[18:19], v253 offset:4096
    v_mfma_f32_16x16x32_bf16 a[104:107], v[44:47], v[116:119], a[104:107]
    ds_read_b64_tr_b16 v[20:21], v253 offset:8192
    ds_read_b64_tr_b16 v[22:23], v253 offset:12288
    v_mfma_f32_16x16x32_bf16 a[108:111], v[40:43], v[84:87], a[108:111]
    v_add_u32 v253, s34, v253
    v_mfma_f32_16x16x32_bf16 a[108:111], v[44:47], v[124:127], a[108:111]
    v_mfma_f32_16x16x32_bf16 a[112:115], v[40:43], v[92:95], a[112:115]
    v_mfma_f32_16x16x32_bf16 a[112:115], v[44:47], v[132:135], a[112:115]
    v_mfma_f32_16x16x32_bf16 a[116:119], v[40:43], v[100:103], a[116:119]
    v_mfma_f32_16x16x32_bf16 a[116:119], v[44:47], v[140:143], a[116:119]
    s_waitcnt lgkmcnt(4)
    v_mfma_f32_16x16x32_bf16 a[120:123], v[8:11], v[68:71], a[120:123]
    v_mfma_f32_16x16x32_bf16 a[120:123], v[12:15], v[108:111], a[120:123]
    v_mfma_f32_16x16x32_bf16 a[124:127], v[8:11], v[76:79], a[124:127]
    v_mfma_f32_16x16x32_bf16 a[124:127], v[12:15], v[116:119], a[124:127]
    v_mfma_f32_16x16x32_bf16 a[128:131], v[8:11], v[84:87], a[128:131]
    v_mfma_f32_16x16x32_bf16 a[128:131], v[12:15], v[124:127], a[128:131]
    v_mfma_f32_16x16x32_bf16 a[132:135], v[8:11], v[92:95], a[132:135]
    s_waitcnt lgkmcnt(0)
    s_barrier
    v_mfma_f32_16x16x32_bf16 a[132:135], v[12:15], v[132:135], a[132:135]
    ds_read_b64_tr_b16 v[32:33], v250 offset:0
    ds_read_b64_tr_b16 v[34:35], v250 offset:4096
    v_mfma_f32_16x16x32_bf16 a[136:139], v[8:11], v[100:103], a[136:139]
    ds_read_b64_tr_b16 v[36:37], v250 offset:8192
    ds_read_b64_tr_b16 v[38:39], v250 offset:12288
    v_mfma_f32_16x16x32_bf16 a[136:139], v[12:15], v[140:143], a[136:139]
    ds_read_b64_tr_b16 v[40:41], v250 offset:32768
    ds_read_b64_tr_b16 v[42:43], v250 offset:36864
    v_mfma_f32_16x16x32_bf16 a[140:143], v[16:19], v[68:71], a[140:143]
    ds_read_b64_tr_b16 v[44:45], v250 offset:40960
    ds_read_b64_tr_b16 v[46:47], v250 offset:45056
    v_mfma_f32_16x16x32_bf16 a[140:143], v[20:23], v[108:111], a[140:143]
    v_mfma_f32_16x16x32_bf16 a[144:147], v[16:19], v[76:79], a[144:147]
    v_mfma_f32_16x16x32_bf16 a[144:147], v[20:23], v[116:119], a[144:147]
    v_mfma_f32_16x16x32_bf16 a[148:151], v[16:19], v[84:87], a[148:151]
    v_mfma_f32_16x16x32_bf16 a[148:151], v[20:23], v[124:127], a[148:151]
    v_mfma_f32_16x16x32_bf16 a[152:155], v[16:19], v[92:95], a[152:155]
    v_mfma_f32_16x16x32_bf16 a[152:155], v[20:23], v[132:135], a[152:155]
    v_mfma_f32_16x16x32_bf16 a[156:159], v[16:19], v[100:103], a[156:159]
    ds_read_b64_tr_b16 v[8:9], v251 offset:0
    ds_read_b64_tr_b16 v[10:11], v251 offset:4096
    v_mfma_f32_16x16x32_bf16 a[156:159], v[20:23], v[140:143], a[156:159]
    s_waitcnt lgkmcnt(2)
    s_waitcnt vmcnt(19)
    v_mfma_f32_16x16x32_bf16 a[80:83], v[32:35], v[64:67], a[80:83]
    s_waitcnt vmcnt(14)
    v_mfma_f32_16x16x32_bf16 a[80:83], v[36:39], v[104:107], a[80:83]
    s_waitcnt vmcnt(9)
    v_mfma_f32_16x16x32_bf16 a[80:83], v[40:43], v[144:147], a[80:83]
    ds_read_b64_tr_b16 v[12:13], v251 offset:8192
    ds_read_b64_tr_b16 v[14:15], v251 offset:12288
    s_waitcnt vmcnt(4)
    v_mfma_f32_16x16x32_bf16 a[80:83], v[44:47], v[184:187], a[80:83]
    v_mfma_f32_16x16x32_bf16 a[84:87], v[32:35], v[72:75], a[84:87]
    v_mfma_f32_16x16x32_bf16 a[84:87], v[36:39], v[112:115], a[84:87]
    v_mfma_f32_16x16x32_bf16 a[84:87], v[40:43], v[152:155], a[84:87]
    ds_read_b64_tr_b16 v[16:17], v251 offset:32768
    ds_read_b64_tr_b16 v[18:19], v251 offset:36864
    s_waitcnt vmcnt(3)
    v_mfma_f32_16x16x32_bf16 a[84:87], v[44:47], v[192:195], a[84:87]
    s_nop 0
    ds_write_b128 v48, a[80:83] offset:0
    v_mfma_f32_16x16x32_bf16 a[88:91], v[32:35], v[80:83], a[88:91]
    v_mfma_f32_16x16x32_bf16 a[88:91], v[36:39], v[120:123], a[88:91]
    v_mfma_f32_16x16x32_bf16 a[88:91], v[40:43], v[160:163], a[88:91]
    ds_read_b64_tr_b16 v[20:21], v251 offset:40960
    ds_read_b64_tr_b16 v[22:23], v251 offset:45056
    s_waitcnt vmcnt(2)
    v_mfma_f32_16x16x32_bf16 a[88:91], v[44:47], v[200:203], a[88:91]
    ds_write_b128 v48, a[84:87] offset:1024
    v_mfma_f32_16x16x32_bf16 a[92:95], v[32:35], v[88:91], a[92:95]
    v_mfma_f32_16x16x32_bf16 a[92:95], v[36:39], v[128:131], a[92:95]
    v_mfma_f32_16x16x32_bf16 a[92:95], v[40:43], v[168:171], a[92:95]
    s_waitcnt vmcnt(1)
    v_mfma_f32_16x16x32_bf16 a[92:95], v[44:47], v[208:211], a[92:95]
    s_nop 1
    ds_write_b128 v48, a[88:91] offset:2048
    v_mfma_f32_16x16x32_bf16 a[96:99], v[32:35], v[96:99], a[96:99]
    v_mfma_f32_16x16x32_bf16 a[96:99], v[36:39], v[136:139], a[96:99]
    v_mfma_f32_16x16x32_bf16 a[96:99], v[40:43], v[176:179], a[96:99]
    ds_read_b64_tr_b16 v[32:33], v252 offset:0
    ds_read_b64_tr_b16 v[34:35], v252 offset:4096
    s_waitcnt vmcnt(0)
    v_mfma_f32_16x16x32_bf16 a[96:99], v[44:47], v[216:219], a[96:99]
    s_waitcnt lgkmcnt(4)
    ds_write_b128 v48, a[92:95] offset:3072
    v_mfma_f32_16x16x32_bf16 a[100:103], v[8:11], v[64:67], a[100:103]
    v_mfma_f32_16x16x32_bf16 a[100:103], v[12:15], v[104:107], a[100:103]
    v_mfma_f32_16x16x32_bf16 a[100:103], v[16:19], v[144:147], a[100:103]
    ds_read_b64_tr_b16 v[36:37], v252 offset:8192
    ds_read_b64_tr_b16 v[38:39], v252 offset:12288
    v_mfma_f32_16x16x32_bf16 a[100:103], v[20:23], v[184:187], a[100:103]
    ds_write_b128 v48, a[96:99] offset:4096
    v_mfma_f32_16x16x32_bf16 a[104:107], v[8:11], v[72:75], a[104:107]
    v_mfma_f32_16x16x32_bf16 a[104:107], v[12:15], v[112:115], a[104:107]
    v_mfma_f32_16x16x32_bf16 a[104:107], v[16:19], v[152:155], a[104:107]
    ds_read_b64_tr_b16 v[40:41], v252 offset:32768
    ds_read_b64_tr_b16 v[42:43], v252 offset:36864
    v_mfma_f32_16x16x32_bf16 a[104:107], v[20:23], v[192:195], a[104:107]
    s_nop 0
    ds_write_b128 v48, a[100:103] offset:5120
    v_mfma_f32_16x16x32_bf16 a[108:111], v[8:11], v[80:83], a[108:111]
    v_mfma_f32_16x16x32_bf16 a[108:111], v[12:15], v[120:123], a[108:111]
    v_mfma_f32_16x16x32_bf16 a[108:111], v[16:19], v[160:163], a[108:111]
    ds_read_b64_tr_b16 v[44:45], v252 offset:40960
    ds_read_b64_tr_b16 v[46:47], v252 offset:45056
    v_mfma_f32_16x16x32_bf16 a[108:111], v[20:23], v[200:203], a[108:111]
    ds_write_b128 v48, a[104:107] offset:6144
    v_mfma_f32_16x16x32_bf16 a[112:115], v[8:11], v[88:91], a[112:115]
    v_mfma_f32_16x16x32_bf16 a[112:115], v[12:15], v[128:131], a[112:115]
    v_mfma_f32_16x16x32_bf16 a[112:115], v[16:19], v[168:171], a[112:115]
    v_mfma_f32_16x16x32_bf16 a[112:115], v[20:23], v[208:211], a[112:115]
    s_nop 2
    ds_write_b128 v48, a[108:111] offset:7168
    v_mfma_f32_16x16x32_bf16 a[116:119], v[8:11], v[96:99], a[116:119]
    v_mfma_f32_16x16x32_bf16 a[116:119], v[12:15], v[136:139], a[116:119]
    v_mfma_f32_16x16x32_bf16 a[116:119], v[16:19], v[176:179], a[116:119]
    ds_read_b64_tr_b16 v[8:9], v253 offset:0
    ds_read_b64_tr_b16 v[10:11], v253 offset:4096
    v_mfma_f32_16x16x32_bf16 a[116:119], v[20:23], v[216:219], a[116:119]
    s_waitcnt lgkmcnt(4)
    ds_write_b128 v48, a[112:115] offset:8192
    v_mfma_f32_16x16x32_bf16 a[120:123], v[32:35], v[64:67], a[120:123]
    v_mfma_f32_16x16x32_bf16 a[120:123], v[36:39], v[104:107], a[120:123]
    v_mfma_f32_16x16x32_bf16 a[120:123], v[40:43], v[144:147], a[120:123]
    ds_read_b64_tr_b16 v[12:13], v253 offset:8192
    ds_read_b64_tr_b16 v[14:15], v253 offset:12288
    v_mfma_f32_16x16x32_bf16 a[120:123], v[44:47], v[184:187], a[120:123]
    ds_write_b128 v48, a[116:119] offset:9216
    v_mfma_f32_16x16x32_bf16 a[124:127], v[32:35], v[72:75], a[124:127]
    v_mfma_f32_16x16x32_bf16 a[124:127], v[36:39], v[112:115], a[124:127]
    v_mfma_f32_16x16x32_bf16 a[124:127], v[40:43], v[152:155], a[124:127]
    ds_read_b64_tr_b16 v[16:17], v253 offset:32768
    ds_read_b64_tr_b16 v[18:19], v253 offset:36864
    v_mfma_f32_16x16x32_bf16 a[124:127], v[44:47], v[192:195], a[124:127]
    s_nop 0
    ds_write_b128 v48, a[120:123] offset:10240
    v_mfma_f32_16x16x32_bf16 a[128:131], v[32:35], v[80:83], a[128:131]
    v_mfma_f32_16x16x32_bf16 a[128:131], v[36:39], v[120:123], a[128:131]
    v_mfma_f32_16x16x32_bf16 a[128:131], v[40:43], v[160:163], a[128:131]
    ds_read_b64_tr_b16 v[20:21], v253 offset:40960
    ds_read_b64_tr_b16 v[22:23], v253 offset:45056
    v_mfma_f32_16x16x32_bf16 a[128:131], v[44:47], v[200:203], a[128:131]
    ds_write_b128 v48, a[124:127] offset:11264
    v_mfma_f32_16x16x32_bf16 a[132:135], v[32:35], v[88:91], a[132:135]
    v_mfma_f32_16x16x32_bf16 a[132:135], v[36:39], v[128:131], a[132:135]
    v_mfma_f32_16x16x32_bf16 a[132:135], v[40:43], v[168:171], a[132:135]
    v_mfma_f32_16x16x32_bf16 a[132:135], v[44:47], v[208:211], a[132:135]
    s_nop 2
    ds_write_b128 v48, a[128:131] offset:12288
    v_mfma_f32_16x16x32_bf16 a[136:139], v[32:35], v[96:99], a[136:139]
    v_mfma_f32_16x16x32_bf16 a[136:139], v[36:39], v[136:139], a[136:139]
    v_mfma_f32_16x16x32_bf16 a[136:139], v[40:43], v[176:179], a[136:139]
    ds_read_b64_tr_b16 v[32:33], v247 offset:0
    ds_read_b64_tr_b16 v[34:35], v247 offset:4096
    v_mfma_f32_16x16x32_bf16 a[136:139], v[44:47], v[216:219], a[136:139]
    s_waitcnt lgkmcnt(4)
    ds_write_b128 v48, a[132:135] offset:13312
    v_mfma_f32_16x16x32_bf16 a[140:143], v[8:11], v[64:67], a[140:143]
    v_mfma_f32_16x16x32_bf16 a[140:143], v[12:15], v[104:107], a[140:143]
    v_mfma_f32_16x16x32_bf16 a[140:143], v[16:19], v[144:147], a[140:143]
    ds_read_b64_tr_b16 v[36:37], v247 offset:8192
    ds_read_b64_tr_b16 v[38:39], v247 offset:12288
    v_mfma_f32_16x16x32_bf16 a[140:143], v[20:23], v[184:187], a[140:143]
    ds_write_b128 v48, a[136:139] offset:14336
    v_mfma_f32_16x16x32_bf16 a[144:147], v[8:11], v[72:75], a[144:147]
    v_mfma_f32_16x16x32_bf16 a[144:147], v[12:15], v[112:115], a[144:147]
    v_mfma_f32_16x16x32_bf16 a[144:147], v[16:19], v[152:155], a[144:147]
    ds_read_b64_tr_b16 v[40:41], v247 offset:32768
    ds_read_b64_tr_b16 v[42:43], v247 offset:36864
    v_mfma_f32_16x16x32_bf16 a[144:147], v[20:23], v[192:195], a[144:147]
    s_nop 0
    ds_write_b128 v48, a[140:143] offset:15360
    v_mfma_f32_16x16x32_bf16 a[148:151], v[8:11], v[80:83], a[148:151]
    v_mfma_f32_16x16x32_bf16 a[148:151], v[12:15], v[120:123], a[148:151]
    v_mfma_f32_16x16x32_bf16 a[148:151], v[16:19], v[160:163], a[148:151]
    ds_read_b64_tr_b16 v[44:45], v247 offset:40960
    ds_read_b64_tr_b16 v[46:47], v247 offset:45056
    v_mfma_f32_16x16x32_bf16 a[148:151], v[20:23], v[200:203], a[148:151]
    ds_write_b128 v48, a[144:147] offset:16384
    v_mfma_f32_16x16x32_bf16 a[152:155], v[8:11], v[88:91], a[152:155]
    v_mfma_f32_16x16x32_bf16 a[152:155], v[12:15], v[128:131], a[152:155]
    v_mfma_f32_16x16x32_bf16 a[152:155], v[16:19], v[168:171], a[152:155]
    v_mfma_f32_16x16x32_bf16 a[152:155], v[20:23], v[208:211], a[152:155]
    s_nop 2
    ds_write_b128 v48, a[148:151] offset:17408
    v_mfma_f32_16x16x32_bf16 a[156:159], v[8:11], v[96:99], a[156:159]
    v_mfma_f32_16x16x32_bf16 a[156:159], v[12:15], v[136:139], a[156:159]
    v_mfma_f32_16x16x32_bf16 a[156:159], v[16:19], v[176:179], a[156:159]
    ds_read_b64_tr_b16 v[8:9], v248 offset:0
    ds_read_b64_tr_b16 v[10:11], v248 offset:4096
    v_mfma_f32_16x16x32_bf16 a[156:159], v[20:23], v[216:219], a[156:159]
    s_waitcnt lgkmcnt(4)
    ds_write_b128 v48, a[152:155] offset:18432
    v_mfma_f32_16x16x32_bf16 a[20:23], v[32:35], v[64:67], a[20:23]
    v_mfma_f32_16x16x32_bf16 a[20:23], v[36:39], v[104:107], a[20:23]
    v_mfma_f32_16x16x32_bf16 a[20:23], v[40:43], v[144:147], a[20:23]
    ds_read_b64_tr_b16 v[12:13], v248 offset:8192
    ds_read_b64_tr_b16 v[14:15], v248 offset:12288
    v_mfma_f32_16x16x32_bf16 a[20:23], v[44:47], v[184:187], a[20:23]
    ds_write_b128 v48, a[156:159] offset:19456
    v_mfma_f32_16x16x32_bf16 a[24:27], v[32:35], v[72:75], a[24:27]
    v_mfma_f32_16x16x32_bf16 a[24:27], v[36:39], v[112:115], a[24:27]
    v_mfma_f32_16x16x32_bf16 a[24:27], v[40:43], v[152:155], a[24:27]
    ds_read_b64_tr_b16 v[16:17], v248 offset:32768
    ds_read_b64_tr_b16 v[18:19], v248 offset:36864
    v_mfma_f32_16x16x32_bf16 a[24:27], v[44:47], v[192:195], a[24:27]
    v_mfma_f32_16x16x32_bf16 a[28:31], v[32:35], v[80:83], a[28:31]
    v_mfma_f32_16x16x32_bf16 a[28:31], v[36:39], v[120:123], a[28:31]
    v_mfma_f32_16x16x32_bf16 a[28:31], v[40:43], v[160:163], a[28:31]
    ds_read_b64_tr_b16 v[20:21], v248 offset:40960
    ds_read_b64_tr_b16 v[22:23], v248 offset:45056
    s_waitcnt lgkmcnt(4)
    s_barrier
    v_mfma_f32_16x16x32_bf16 a[28:31], v[44:47], v[200:203], a[28:31]
    ds_read_b128 v[108:111], v49 offset:5120
    v_mfma_f32_16x16x32_bf16 a[32:35], v[32:35], v[88:91], a[32:35]
    ds_read_b128 v[116:119], v49 offset:6144
    v_mfma_f32_16x16x32_bf16 a[32:35], v[36:39], v[128:131], a[32:35]
    ds_read_b128 v[124:127], v49 offset:7168
    v_mfma_f32_16x16x32_bf16 a[32:35], v[40:43], v[168:171], a[32:35]
    ds_read_b128 v[132:135], v49 offset:8192
    v_mfma_f32_16x16x32_bf16 a[32:35], v[44:47], v[208:211], a[32:35]
    ds_read_b128 v[140:143], v49 offset:9216
    v_mfma_f32_16x16x32_bf16 a[36:39], v[32:35], v[96:99], a[36:39]
    ds_read_b128 v[148:151], v49 offset:10240
    v_mfma_f32_16x16x32_bf16 a[36:39], v[36:39], v[136:139], a[36:39]
    ds_read_b128 v[156:159], v49 offset:11264
    v_mfma_f32_16x16x32_bf16 a[36:39], v[40:43], v[176:179], a[36:39]
    ds_read_b64_tr_b16 v[32:33], v249 offset:0
    ds_read_b64_tr_b16 v[34:35], v249 offset:4096
    ds_read_b128 v[164:167], v49 offset:12288
    v_mfma_f32_16x16x32_bf16 a[36:39], v[44:47], v[216:219], a[36:39]
    s_waitcnt lgkmcnt(10)
    ds_read_b128 v[172:175], v49 offset:13312
    v_mfma_f32_16x16x32_bf16 a[40:43], v[8:11], v[64:67], a[40:43]
    ds_read_b128 v[180:183], v49 offset:14336
    v_accvgpr_read_b32 v224, a20
    v_accvgpr_read_b32 v225, a21
    v_mfma_f32_16x16x32_bf16 a[40:43], v[12:15], v[104:107], a[40:43]
    ds_read_b128 v[188:191], v49 offset:15360
    v_accvgpr_read_b32 v226, a22
    v_accvgpr_read_b32 v227, a23
    v_mfma_f32_16x16x32_bf16 a[40:43], v[16:19], v[144:147], a[40:43]
    ds_read_b64_tr_b16 v[36:37], v249 offset:8192
    ds_read_b64_tr_b16 v[38:39], v249 offset:12288
    ds_read_b128 v[196:199], v49 offset:16384
    v_mfma_f32_16x16x32_bf16 a[40:43], v[20:23], v[184:187], a[40:43]
    ds_read_b128 v[204:207], v49 offset:17408
    s_waitcnt lgkmcnt(14)
    v_add_f32 v108, v108, v224
    v_add_f32 v109, v109, v225
    v_mfma_f32_16x16x32_bf16 a[44:47], v[8:11], v[72:75], a[44:47]
    ds_read_b128 v[212:215], v49 offset:18432
    v_add_f32 v110, v110, v226
    v_add_f32 v111, v111, v227
    v_mfma_f32_16x16x32_bf16 a[44:47], v[12:15], v[112:115], a[44:47]
    ds_read_b128 v[220:223], v49 offset:19456
    v_cvt_pk_bf16_f32 v108, v108, v109
    v_cvt_pk_bf16_f32 v109, v110, v111
    v_mfma_f32_16x16x32_bf16 a[44:47], v[16:19], v[152:155], a[44:47]
    ds_read_b64_tr_b16 v[40:41], v249 offset:32768
    ds_read_b64_tr_b16 v[42:43], v249 offset:36864
    ds_read_b128 v[68:71], v49 offset:0
    v_mfma_f32_16x16x32_bf16 a[44:47], v[20:23], v[192:195], a[44:47]
    ds_read_b128 v[76:79], v49 offset:1024
    v_accvgpr_read_b32 v228, a24
    v_accvgpr_read_b32 v229, a25
    v_mfma_f32_16x16x32_bf16 a[48:51], v[8:11], v[80:83], a[48:51]
    ds_read_b128 v[84:87], v49 offset:2048
    v_accvgpr_read_b32 v230, a26
    v_accvgpr_read_b32 v231, a27
    v_mfma_f32_16x16x32_bf16 a[48:51], v[12:15], v[120:123], a[48:51]
    ds_read_b128 v[92:95], v49 offset:3072
    v_add_f32 v116, v116, v228
    v_add_f32 v117, v117, v229
    v_mfma_f32_16x16x32_bf16 a[48:51], v[16:19], v[160:163], a[48:51]
    ds_read_b64_tr_b16 v[44:45], v249 offset:40960
    ds_read_b64_tr_b16 v[46:47], v249 offset:45056
    ds_read_b128 v[100:103], v49 offset:4096
    v_mfma_f32_16x16x32_bf16 a[48:51], v[20:23], v[200:203], a[48:51]
    v_add_f32 v118, v118, v230
    v_add_f32 v119, v119, v231
    v_cvt_pk_bf16_f32 v110, v116, v117
    v_mfma_f32_16x16x32_bf16 a[52:55], v[8:11], v[88:91], a[52:55]
    v_cvt_pk_bf16_f32 v111, v118, v119
    buffer_store_dwordx4 v[108:111], v58, s[64:67], s96 offen offset:0 sc1
    v_accvgpr_read_b32 v232, a28
    v_mfma_f32_16x16x32_bf16 a[52:55], v[12:15], v[128:131], a[52:55]
    v_accvgpr_read_b32 v233, a29
    v_accvgpr_read_b32 v234, a30
    v_accvgpr_read_b32 v235, a31
    v_mfma_f32_16x16x32_bf16 a[52:55], v[16:19], v[168:171], a[52:55]
    v_add_f32 v124, v124, v232
    v_add_f32 v125, v125, v233
    v_add_f32 v126, v126, v234
    v_mfma_f32_16x16x32_bf16 a[52:55], v[20:23], v[208:211], a[52:55]
    v_add_f32 v127, v127, v235
    v_cvt_pk_bf16_f32 v124, v124, v125
    v_cvt_pk_bf16_f32 v125, v126, v127
    v_mfma_f32_16x16x32_bf16 a[56:59], v[8:11], v[96:99], a[56:59]
    v_accvgpr_read_b32 v236, a32
    v_accvgpr_read_b32 v237, a33
    v_accvgpr_read_b32 v238, a34
    v_mfma_f32_16x16x32_bf16 a[56:59], v[12:15], v[136:139], a[56:59]
    v_accvgpr_read_b32 v239, a35
    s_waitcnt lgkmcnt(14)
    v_add_f32 v132, v132, v236
    v_add_f32 v133, v133, v237
    v_mfma_f32_16x16x32_bf16 a[56:59], v[16:19], v[176:179], a[56:59]
    ds_read_b64_tr_b16 v[8:9], v246 offset:0
    ds_read_b64_tr_b16 v[10:11], v246 offset:4096
    v_add_f32 v134, v134, v238
    v_mfma_f32_16x16x32_bf16 a[56:59], v[20:23], v[216:219], a[56:59]
    s_waitcnt lgkmcnt(3)
    v_add_f32 v135, v135, v239
    v_cvt_pk_bf16_f32 v126, v132, v133
    v_mfma_f32_16x16x32_bf16 a[60:63], v[32:35], v[64:67], a[60:63]
    v_cvt_pk_bf16_f32 v127, v134, v135
    buffer_store_dwordx4 v[124:127], v58, s[64:67], s96 offen offset:1024 sc1
    v_accvgpr_read_b32 v224, a36
    v_mfma_f32_16x16x32_bf16 a[60:63], v[36:39], v[104:107], a[60:63]
    v_accvgpr_read_b32 v225, a37
    v_accvgpr_read_b32 v226, a38
    v_accvgpr_read_b32 v227, a39
    v_mfma_f32_16x16x32_bf16 a[60:63], v[40:43], v[144:147], a[60:63]
    ds_read_b64_tr_b16 v[12:13], v246 offset:8192
    ds_read_b64_tr_b16 v[14:15], v246 offset:12288
    v_add_f32 v140, v140, v224
    v_mfma_f32_16x16x32_bf16 a[60:63], v[44:47], v[184:187], a[60:63]
    v_add_f32 v141, v141, v225
    v_add_f32 v142, v142, v226
    v_add_f32 v143, v143, v227
    v_mfma_f32_16x16x32_bf16 a[64:67], v[32:35], v[72:75], a[64:67]
    v_cvt_pk_bf16_f32 v140, v140, v141
    v_cvt_pk_bf16_f32 v141, v142, v143
    buffer_store_dwordx4 v[140:143], v58, s[64:67], s96 offen offset:2048 sc1
    v_mfma_f32_16x16x32_bf16 a[64:67], v[36:39], v[112:115], a[64:67]
    v_accvgpr_read_b32 v228, a40
    v_accvgpr_read_b32 v229, a41
    v_accvgpr_read_b32 v230, a42
    v_mfma_f32_16x16x32_bf16 a[64:67], v[40:43], v[152:155], a[64:67]
    ds_read_b64_tr_b16 v[16:17], v246 offset:32768
    ds_read_b64_tr_b16 v[18:19], v246 offset:36864
    v_accvgpr_read_b32 v231, a43
    v_mfma_f32_16x16x32_bf16 a[64:67], v[44:47], v[192:195], a[64:67]
    v_add_f32 v148, v148, v228
    v_add_f32 v149, v149, v229
    v_add_f32 v150, v150, v230
    v_mfma_f32_16x16x32_bf16 a[68:71], v[32:35], v[80:83], a[68:71]
    v_add_f32 v151, v151, v231
    v_cvt_pk_bf16_f32 v148, v148, v149
    v_cvt_pk_bf16_f32 v149, v150, v151
    v_accvgpr_read_b32 v232, a44
    v_mfma_f32_16x16x32_bf16 a[68:71], v[36:39], v[120:123], a[68:71]
    v_accvgpr_read_b32 v233, a45
    v_accvgpr_read_b32 v234, a46
    v_accvgpr_read_b32 v235, a47
    v_add_f32 v156, v156, v232
    v_mfma_f32_16x16x32_bf16 a[68:71], v[40:43], v[160:163], a[68:71]
    ds_read_b64_tr_b16 v[20:21], v246 offset:40960
    ds_read_b64_tr_b16 v[22:23], v246 offset:45056
    v_add_f32 v157, v157, v233
    v_add_f32 v158, v158, v234
    v_mfma_f32_16x16x32_bf16 a[68:71], v[44:47], v[200:203], a[68:71]
    v_add_f32 v159, v159, v235
    v_cvt_pk_bf16_f32 v150, v156, v157
    v_cvt_pk_bf16_f32 v151, v158, v159
    buffer_store_dwordx4 v[148:151], v58, s[64:67], s97 offen offset:0 sc1
    v_mfma_f32_16x16x32_bf16 a[72:75], v[32:35], v[88:91], a[72:75]
    v_accvgpr_read_b32 v236, a48
    v_accvgpr_read_b32 v237, a49
    v_accvgpr_read_b32 v238, a50
    v_accvgpr_read_b32 v239, a51
    v_mfma_f32_16x16x32_bf16 a[72:75], v[36:39], v[128:131], a[72:75]
    v_add_f32 v164, v164, v236
    v_add_f32 v165, v165, v237
    v_add_f32 v166, v166, v238
    v_add_f32 v167, v167, v239
    v_mfma_f32_16x16x32_bf16 a[72:75], v[40:43], v[168:171], a[72:75]
    v_cvt_pk_bf16_f32 v164, v164, v165
    v_cvt_pk_bf16_f32 v165, v166, v167
    v_accvgpr_read_b32 v224, a52
    v_mfma_f32_16x16x32_bf16 a[72:75], v[44:47], v[208:211], a[72:75]
    v_accvgpr_read_b32 v225, a53
    v_accvgpr_read_b32 v226, a54
    v_accvgpr_read_b32 v227, a55
    v_mfma_f32_16x16x32_bf16 a[76:79], v[32:35], v[96:99], a[76:79]
    v_add_f32 v172, v172, v224
    v_add_f32 v173, v173, v225
    v_add_f32 v174, v174, v226
    v_mfma_f32_16x16x32_bf16 a[76:79], v[36:39], v[136:139], a[76:79]
    v_add_f32 v175, v175, v227
    v_cvt_pk_bf16_f32 v166, v172, v173
    v_cvt_pk_bf16_f32 v167, v174, v175
    v_mfma_f32_16x16x32_bf16 a[76:79], v[40:43], v[176:179], a[76:79]
    buffer_store_dwordx4 v[164:167], v58, s[64:67], s97 offen offset:1024 sc1
    v_accvgpr_read_b32 v228, a56
    v_accvgpr_read_b32 v229, a57
    v_mfma_f32_16x16x32_bf16 a[76:79], v[44:47], v[216:219], a[76:79]
    s_waitcnt lgkmcnt(0)
    v_accvgpr_read_b32 v230, a58
    v_accvgpr_read_b32 v231, a59
    v_mfma_f32_16x16x32_bf16 a[0:3], v[8:11], v[64:67], a[0:3]
    v_add_f32 v180, v180, v228
    v_add_f32 v181, v181, v229
    v_add_f32 v182, v182, v230
    v_mfma_f32_16x16x32_bf16 a[0:3], v[12:15], v[104:107], a[0:3]
    v_add_f32 v183, v183, v231
    v_cvt_pk_bf16_f32 v180, v180, v181
    v_cvt_pk_bf16_f32 v181, v182, v183
    v_mfma_f32_16x16x32_bf16 a[0:3], v[16:19], v[144:147], a[0:3]
    buffer_store_dwordx4 v[180:183], v58, s[64:67], s97 offen offset:2048 sc1
    v_accvgpr_read_b32 v232, a60
    v_accvgpr_read_b32 v233, a61
    v_mfma_f32_16x16x32_bf16 a[0:3], v[20:23], v[184:187], a[0:3]
    v_accvgpr_read_b32 v234, a62
    v_accvgpr_read_b32 v235, a63
    v_add_f32 v188, v188, v232
    v_mfma_f32_16x16x32_bf16 a[4:7], v[8:11], v[72:75], a[4:7]
    v_add_f32 v189, v189, v233
    v_add_f32 v190, v190, v234
    v_add_f32 v191, v191, v235
    v_mfma_f32_16x16x32_bf16 a[4:7], v[12:15], v[112:115], a[4:7]
    v_cvt_pk_bf16_f32 v188, v188, v189
    v_cvt_pk_bf16_f32 v189, v190, v191
    v_accvgpr_read_b32 v236, a64
    v_mfma_f32_16x16x32_bf16 a[4:7], v[16:19], v[152:155], a[4:7]
    v_accvgpr_read_b32 v237, a65
    v_accvgpr_read_b32 v238, a66
    v_accvgpr_read_b32 v239, a67
    v_mfma_f32_16x16x32_bf16 a[4:7], v[20:23], v[192:195], a[4:7]
    v_add_f32 v196, v196, v236
    v_add_f32 v197, v197, v237
    v_add_f32 v198, v198, v238
    v_mfma_f32_16x16x32_bf16 a[8:11], v[8:11], v[80:83], a[8:11]
    v_add_f32 v199, v199, v239
    v_cvt_pk_bf16_f32 v190, v196, v197
    v_cvt_pk_bf16_f32 v191, v198, v199
    v_mfma_f32_16x16x32_bf16 a[8:11], v[12:15], v[120:123], a[8:11]
    buffer_store_dwordx4 v[188:191], v58, s[64:67], s98 offen offset:0 sc1
    v_accvgpr_read_b32 v224, a68
    v_accvgpr_read_b32 v225, a69
    v_mfma_f32_16x16x32_bf16 a[8:11], v[16:19], v[160:163], a[8:11]
    v_accvgpr_read_b32 v226, a70
    v_accvgpr_read_b32 v227, a71
    v_add_f32 v204, v204, v224
    v_mfma_f32_16x16x32_bf16 a[8:11], v[20:23], v[200:203], a[8:11]
    v_add_f32 v205, v205, v225
    v_add_f32 v206, v206, v226
    v_add_f32 v207, v207, v227
    v_mfma_f32_16x16x32_bf16 a[12:15], v[8:11], v[88:91], a[12:15]
    v_cvt_pk_bf16_f32 v204, v204, v205
    v_cvt_pk_bf16_f32 v205, v206, v207
    v_accvgpr_read_b32 v228, a72
    v_mfma_f32_16x16x32_bf16 a[12:15], v[12:15], v[128:131], a[12:15]
    v_accvgpr_read_b32 v229, a73
    v_accvgpr_read_b32 v230, a74
    v_accvgpr_read_b32 v231, a75
    v_mfma_f32_16x16x32_bf16 a[12:15], v[16:19], v[168:171], a[12:15]
    v_add_f32 v212, v212, v228
    v_add_f32 v213, v213, v229
    v_add_f32 v214, v214, v230
    v_mfma_f32_16x16x32_bf16 a[12:15], v[20:23], v[208:211], a[12:15]
    v_add_f32 v215, v215, v231
    v_cvt_pk_bf16_f32 v206, v212, v213
    v_cvt_pk_bf16_f32 v207, v214, v215
    v_mfma_f32_16x16x32_bf16 a[16:19], v[8:11], v[96:99], a[16:19]
    buffer_store_dwordx4 v[204:207], v58, s[64:67], s98 offen offset:1024 sc1
    v_accvgpr_read_b32 v232, a76
    v_accvgpr_read_b32 v233, a77
    v_mfma_f32_16x16x32_bf16 a[16:19], v[12:15], v[136:139], a[16:19]
    v_accvgpr_read_b32 v234, a78
    v_accvgpr_read_b32 v235, a79
    v_add_f32 v220, v220, v232
    v_mfma_f32_16x16x32_bf16 a[16:19], v[16:19], v[176:179], a[16:19]
    v_add_f32 v221, v221, v233
    v_add_f32 v222, v222, v234
    v_add_f32 v223, v223, v235
    v_mfma_f32_16x16x32_bf16 a[16:19], v[20:23], v[216:219], a[16:19]
    v_cvt_pk_bf16_f32 v220, v220, v221
    v_cvt_pk_bf16_f32 v221, v222, v223
    buffer_store_dwordx4 v[220:223], v58, s[64:67], s98 offen offset:2048 sc1
    v_accvgpr_read_b32 v236, a0
    v_accvgpr_read_b32 v237, a1
    v_accvgpr_read_b32 v238, a2
    v_accvgpr_read_b32 v239, a3
    v_add_f32 v68, v68, v236
    v_add_f32 v69, v69, v237
    v_add_f32 v70, v70, v238
    v_add_f32 v71, v71, v239
    v_accvgpr_read_b32 v224, a4
    v_accvgpr_read_b32 v225, a5
    v_accvgpr_read_b32 v226, a6
    v_accvgpr_read_b32 v227, a7
    v_add_f32 v76, v76, v224
    v_add_f32 v77, v77, v225
    v_add_f32 v78, v78, v226
    v_add_f32 v79, v79, v227
    v_accvgpr_read_b32 v228, a8
    v_accvgpr_read_b32 v229, a9
    v_accvgpr_read_b32 v230, a10
    v_accvgpr_read_b32 v231, a11
    v_add_f32 v84, v84, v228
    v_add_f32 v85, v85, v229
    v_add_f32 v86, v86, v230
    v_add_f32 v87, v87, v231
    v_accvgpr_read_b32 v232, a12
    v_accvgpr_read_b32 v233, a13
    v_accvgpr_read_b32 v234, a14
    v_accvgpr_read_b32 v235, a15
    v_add_f32 v92, v92, v232
    v_add_f32 v93, v93, v233
    v_add_f32 v94, v94, v234
    v_add_f32 v95, v95, v235
    v_accvgpr_read_b32 v236, a16
    v_accvgpr_read_b32 v237, a17
    v_accvgpr_read_b32 v238, a18
    v_accvgpr_read_b32 v239, a19
    v_add_f32 v100, v100, v236
    v_add_f32 v101, v101, v237
    v_add_f32 v102, v102, v238
    v_add_f32 v103, v103, v239
    s_waitcnt vmcnt(0)
    buffer_store_dword v245, v52, s[44:47], 0 offen sc1
    buffer_load_dword v244, v29, s[44:47], 0 offen sc1
    s_waitcnt vmcnt(0)
    v_cmp_le_u32 vcc, 1, v244
    s_nop 1
    s_and_b32 s38, vcc_lo, s43
    s_cmp_lg_u32 s38, s43
    s_cbranch_scc1 L_spin_p
L_back_p:
    buffer_load_dwordx4 v[108:111], v58, s[64:67], s99 offen offset:0 sc1
    buffer_load_dwordx4 v[148:151], v58, s[64:67], s100 offen offset:0 sc1
    buffer_load_dwordx4 v[188:191], v58, s[64:67], s101 offen offset:0 sc1
    buffer_load_dwordx4 v[124:127], v58, s[64:67], s99 offen offset:1024 sc1
    buffer_load_dwordx4 v[164:167], v58, s[64:67], s100 offen offset:1024 sc1
    buffer_load_dwordx4 v[204:207], v58, s[64:67], s101 offen offset:1024 sc1
    buffer_load_dwordx4 v[140:143], v58, s[64:67], s99 offen offset:2048 sc1
    buffer_load_dwordx4 v[180:183], v58, s[64:67], s100 offen offset:2048 sc1
    buffer_load_dwordx4 v[220:223], v58, s[64:67], s101 offen offset:2048 sc1
    s_mov_b32 s39, 0xffff0000
    s_waitcnt vmcnt(8)
    v_lshlrev_b32 v116, 16, v108
    v_and_b32 v117, s39, v108
    v_lshlrev_b32 v118, 16, v109
    v_and_b32 v119, s39, v109
    s_waitcnt vmcnt(7)
    v_lshlrev_b32 v156, 16, v148
    v_and_b32 v157, s39, v148
    v_lshlrev_b32 v158, 16, v149
    v_and_b32 v159, s39, v149
    s_waitcnt vmcnt(6)
    v_lshlrev_b32 v196, 16, v188
    v_and_b32 v197, s39, v188
    v_lshlrev_b32 v198, 16, v189
    v_and_b32 v199, s39, v189
    v_add_f32 v68, v68, v116
    v_add_f32 v156, v156, v196
    v_add_f32 v69, v69, v117
    v_add_f32 v157, v157, v197
    v_add_f32 v70, v70, v118
    v_add_f32 v158, v158, v198
    v_add_f32 v71, v71, v119
    v_add_f32 v159, v159, v199
    v_add_f32 v68, v68, v156
    v_add_f32 v69, v69, v157
    v_add_f32 v70, v70, v158
    v_add_f32 v71, v71, v159
    v_cvt_pk_bf16_f32 v68, v68, v69
    v_cvt_pk_bf16_f32 v69, v70, v71
    s_mov_b32 s38, 0
    buffer_store_dwordx2 v[68:69], v50, s[68:71], s38 offen
    v_lshlrev_b32 v116, 16, v110
    v_and_b32 v117, s39, v110
    v_lshlrev_b32 v118, 16, v111
    v_and_b32 v119, s39, v111
    v_lshlrev_b32 v156, 16, v150
    v_and_b32 v157, s39, v150
    v_lshlrev_b32 v158, 16, v151
    v_and_b32 v159, s39, v151
    v_lshlrev_b32 v196, 16, v190
    v_and_b32 v197, s39, v190
    v_lshlrev_b32 v198, 16, v191
    v_and_b32 v199, s39, v191
    v_add_f32 v76, v76, v116
    v_add_f32 v156, v156, v196
    v_add_f32 v77, v77, v117
    v_add_f32 v157, v157, v197
    v_add_f32 v78, v78, v118
    v_add_f32 v158, v158, v198
    v_add_f32 v79, v79, v119
    v_add_f32 v159, v159, v199
    v_add_f32 v76, v76, v156
    v_add_f32 v77, v77, v157
    v_add_f32 v78, v78, v158
    v_add_f32 v79, v79, v159
    v_cvt_pk_bf16_f32 v76, v76, v77
    v_cvt_pk_bf16_f32 v77, v78, v79
    s_mov_b32 s38, 32768
    buffer_store_dwordx2 v[76:77], v50, s[68:71], s38 offen
    s_waitcnt vmcnt(7)
    v_lshlrev_b32 v116, 16, v124
    v_and_b32 v117, s39, v124
    v_lshlrev_b32 v118, 16, v125
    v_and_b32 v119, s39, v125
    s_waitcnt vmcnt(6)
    v_lshlrev_b32 v156, 16, v164
    v_and_b32 v157, s39, v164
    v_lshlrev_b32 v158, 16, v165
    v_and_b32 v159, s39, v165
    s_waitcnt vmcnt(5)
    v_lshlrev_b32 v196, 16, v204
    v_and_b32 v197, s39, v204
    v_lshlrev_b32 v198, 16, v205
    v_and_b32 v199, s39, v205
    v_add_f32 v84, v84, v116
    v_add_f32 v156, v156, v196
    v_add_f32 v85, v85, v117
    v_add_f32 v157, v157, v197
    v_add_f32 v86, v86, v118
    v_add_f32 v158, v158, v198
    v_add_f32 v87, v87, v119
    v_add_f32 v159, v159, v199
    v_add_f32 v84, v84, v156
    v_add_f32 v85, v85, v157
    v_add_f32 v86, v86, v158
    v_add_f32 v87, v87, v159
    v_cvt_pk_bf16_f32 v84, v84, v85
    v_cvt_pk_bf16_f32 v85, v86, v87
    s_mov_b32 s38, 65536
    buffer_store_dwordx2 v[84:85], v50, s[68:71], s38 offen
    v_lshlrev_b32 v116, 16, v126
    v_and_b32 v117, s39, v126
    v_lshlrev_b32 v118, 16, v127
    v_and_b32 v119, s39, v127
    v_lshlrev_b32 v156, 16, v166
    v_and_b32 v157, s39, v166
    v_lshlrev_b32 v158, 16, v167
    v_and_b32 v159, s39, v167
    v_lshlrev_b32 v196, 16, v206
    v_and_b32 v197, s39, v206
    v_lshlrev_b32 v198, 16, v207
    v_and_b32 v199, s39, v207
    v_add_f32 v92, v92, v116
    v_add_f32 v156, v156, v196
    v_add_f32 v93, v93, v117
    v_add_f32 v157, v157, v197
    v_add_f32 v94, v94, v118
    v_add_f32 v158, v158, v198
    v_add_f32 v95, v95, v119
    v_add_f32 v159, v159, v199
    v_add_f32 v92, v92, v156
    v_add_f32 v93, v93, v157
    v_add_f32 v94, v94, v158
    v_add_f32 v95, v95, v159
    v_cvt_pk_bf16_f32 v92, v92, v93
    v_cvt_pk_bf16_f32 v93, v94, v95
    s_mov_b32 s38, 98304
    buffer_store_dwordx2 v[92:93], v50, s[68:71], s38 offen
    s_waitcnt vmcnt(6)
    v_lshlrev_b32 v116, 16, v140
    v_and_b32 v117, s39, v140
    v_lshlrev_b32 v118, 16, v141
    v_and_b32 v119, s39, v141
    s_waitcnt vmcnt(5)
    v_lshlrev_b32 v156, 16, v180
    v_and_b32 v157, s39, v180
    v_lshlrev_b32 v158, 16, v181
    v_and_b32 v159, s39, v181
    s_waitcnt vmcnt(4)
    v_lshlrev_b32 v196, 16, v220
    v_and_b32 v197, s39, v220
    v_lshlrev_b32 v198, 16, v221
    v_and_b32 v199, s39, v221
    v_add_f32 v100, v100, v116
    v_add_f32 v156, v156, v196
    v_add_f32 v101, v101, v117
    v_add_f32 v157, v157, v197
    v_add_f32 v102, v102, v118
    v_add_f32 v158, v158, v198
    v_add_f32 v103, v103, v119
    v_add_f32 v159, v159, v199
    v_add_f32 v100, v100, v156
    v_add_f32 v101, v101, v157
    v_add_f32 v102, v102, v158
    v_add_f32 v103, v103, v159
    v_cvt_pk_bf16_f32 v100, v100, v101
    v_cvt_pk_bf16_f32 v101, v102, v103
    s_mov_b32 s38, 131072
    buffer_store_dwordx2 v[100:101], v50, s[68:71], s38 offen
    s_endpgm
L_spin_o1:
    s_mov_b32 s40, 524288
L_spin_o12:
    s_sleep 1
    buffer_load_dword v244, v28, s[44:47], 0 offen sc1
    s_waitcnt vmcnt(0)
    v_cmp_le_u32 vcc, 2, v244
    s_nop 1
    s_and_b32 s38, vcc_lo, s42
    s_cmp_lg_u32 s38, s42
    s_cbranch_scc0 L_back_o1
    s_sub_u32 s40, s40, 1
    s_cmp_lg_u32 s40, 0
    s_cbranch_scc1 L_spin_o12
    s_branch L_back_o1
L_spin_o2:
    s_mov_b32 s40, 524288
L_spin_o22:
    s_sleep 1
    buffer_load_dword v244, v28, s[44:47], 0 offen sc1
    s_waitcnt vmcnt(0)
    v_cmp_le_u32 vcc, 2, v244
    s_nop 1
    s_and_b32 s38, vcc_lo, s60
    s_cmp_lg_u32 s38, s60
    s_cbranch_scc0 L_back_o2
    s_sub_u32 s40, s40, 1
    s_cmp_lg_u32 s40, 0
    s_cbranch_scc1 L_spin_o22
    s_branch L_back_o2
L_spin_o3:
    s_mov_b32 s40, 524288
L_spin_o32:
    s_sleep 1
    buffer_load_dword v244, v28, s[44:47], 0 offen sc1
    s_waitcnt vmcnt(0)
    v_cmp_le_u32 vcc, 2, v244
    s_nop 1
    s_and_b32 s38, vcc_lo, s61
    s_cmp_lg_u32 s38, s61
    s_cbranch_scc0 L_back_o3
    s_sub_u32 s40, s40, 1
    s_cmp_lg_u32 s40, 0
    s_cbranch_scc1 L_spin_o32
    s_branch L_back_o3
L_spin_p:
    s_mov_b32 s40, 524288
L_spin_p2:
    s_sleep 1
    buffer_load_dword v244, v29, s[44:47], 0 offen sc1
    s_waitcnt vmcnt(0)
    v_cmp_le_u32 vcc, 1, v244
    s_nop 1
    s_and_b32 s38, vcc_lo, s43
    s_cmp_lg_u32 s38, s43
    s_cbranch_scc0 L_back_p
    s_sub_u32 s40, s40, 1
    s_cmp_lg_u32 s40, 0
    s_cbranch_scc1 L_spin_p2
    s_branch L_back_p
L_spin_d:
    s_mov_b32 s40, 524288
L_spin_d2:
    s_sleep 4
    buffer_load_dword v244, v30, s[48:51], 0 offen sc1
    s_waitcnt vmcnt(0)
    v_readlane_b32 s38, v244, 0
    v_readlane_b32 s39, v244, 1
    s_nop 0
    s_and_b32 s38, s38, 0xffff
    s_lshr_b32 s39, s39, 16
    s_min_u32 s38, s38, s39
    s_cmp_ge_u32 s38, 4
    s_cbranch_scc1 L_back_d
    s_sub_u32 s40, s40, 1
    s_cmp_lg_u32 s40, 0
    s_cbranch_scc1 L_spin_d2
    s_branch L_back_d
L_fallback:
    s_waitcnt vmcnt(0) lgkmcnt(0)
    s_nop 15
    s_barrier
    v_and_b32 v1, 15, v26
    v_lshrrev_b32 v2, 4, v26
    v_lshlrev_b32 v2, 4, v2
    v_lshl_add_u32 v58, v1, 8, v2
    v_mov_b32 v48, 0xff800000
    v_mov_b32 v50, 0xff800000
    v_mov_b32 v52, 0xff800000
    v_mov_b32 v54, 0xff800000
    v_mov_b32 v56, 0xff800000
    s_mov_b32 s39, 0
L_fb_loop:
    buffer_load_dwordx4 v[32:35], v58, s[4:7], s39 offen offset:0
    buffer_load_dwordx4 v[36:39], v58, s[4:7], s39 offen offset:64
    buffer_load_dwordx4 v[40:43], v58, s[4:7], s39 offen offset:128
    buffer_load_dwordx4 v[44:47], v58, s[4:7], s39 offen offset:192
    s_waitcnt vmcnt(0)
    v_mfma_f32_16x16x32_bf16 v[68:71], v[32:35], v[64:67], 0
    v_mfma_f32_16x16x32_bf16 v[76:79], v[32:35], v[72:75], 0
    v_mfma_f32_16x16x32_bf16 v[84:87], v[32:35], v[80:83], 0
    v_mfma_f32_16x16x32_bf16 v[92:95], v[32:35], v[88:91], 0
    v_mfma_f32_16x16x32_bf16 v[100:103], v[32:35], v[96:99], 0
    v_mfma_f32_16x16x32_bf16 v[68:71], v[36:39], v[104:107], v[68:71]
    v_mfma_f32_16x16x32_bf16 v[76:79], v[36:39], v[112:115], v[76:79]
    v_mfma_f32_16x16x32_bf16 v[84:87], v[36:39], v[120:123], v[84:87]
    v_mfma_f32_16x16x32_bf16 v[92:95], v[36:39], v[128:131], v[92:95]
    v_mfma_f32_16x16x32_bf16 v[100:103], v[36:39], v[136:139], v[100:103]
    v_mfma_f32_16x16x32_bf16 v[68:71], v[40:43], v[144:147], v[68:71]
    v_mfma_f32_16x16x32_bf16 v[76:79], v[40:43], v[152:155], v[76:79]
    v_mfma_f32_16x16x32_bf16 v[84:87], v[40:43], v[160:163], v[84:87]
    v_mfma_f32_16x16x32_bf16 v[92:95], v[40:43], v[168:171], v[92:95]
    v_mfma_f32_16x16x32_bf16 v[100:103], v[40:43], v[176:179], v[100:103]
    v_mfma_f32_16x16x32_bf16 v[68:71], v[44:47], v[184:187], v[68:71]
    v_mfma_f32_16x16x32_bf16 v[76:79], v[44:47], v[192:195], v[76:79]
    v_mfma_f32_16x16x32_bf16 v[84:87], v[44:47], v[200:203], v[84:87]
    v_mfma_f32_16x16x32_bf16 v[92:95], v[44:47], v[208:211], v[92:95]
    v_mfma_f32_16x16x32_bf16 v[100:103], v[44:47], v[216:219], v[100:103]
    s_nop 15
    v_max3_f32 v48, v48, v68, v69
    v_max3_f32 v48, v48, v70, v71
    v_max3_f32 v50, v50, v76, v77
    v_max3_f32 v50, v50, v78, v79
    v_max3_f32 v52, v52, v84, v85
    v_max3_f32 v52, v52, v86, v87
    v_max3_f32 v54, v54, v92, v93
    v_max3_f32 v54, v54, v94, v95
    v_max3_f32 v56, v56, v100, v101
    v_max3_f32 v56, v56, v102, v103
    s_add_u32 s39, s39, 4096
    s_cmp_lt_u32 s39, 262144
    s_cbranch_scc1 L_fb_loop
    v_mov_b32 v49, v48
    v_mov_b32 v51, v50
    v_mov_b32 v53, v52
    v_mov_b32 v55, v54
    v_mov_b32 v57, v56
    v_permlane16_swap_b32 v48, v49
    v_permlane16_swap_b32 v50, v51
    v_permlane16_swap_b32 v52, v53
    v_permlane16_swap_b32 v54, v55
    v_permlane16_swap_b32 v56, v57
    v_max_f32 v48, v48, v49
    v_max_f32 v50, v50, v51
    v_max_f32 v52, v52, v53
    v_max_f32 v54, v54, v55
    v_max_f32 v56, v56, v57
    v_mov_b32 v49, v48
    v_mov_b32 v51, v50
    v_mov_b32 v53, v52
    v_mov_b32 v55, v54
    v_mov_b32 v57, v56
    v_permlane32_swap_b32 v48, v49
    v_permlane32_swap_b32 v50, v51
    v_permlane32_swap_b32 v52, v53
    v_permlane32_swap_b32 v54, v55
    v_permlane32_swap_b32 v56, v57
    v_max_f32 v48, v48, v49
    v_max_f32 v50, v50, v51
    v_max_f32 v52, v52, v53
    v_max_f32 v54, v54, v55
    v_max_f32 v56, v56, v57
    v_sub_f32 v224, 0, v48
    v_sub_f32 v225, 0, v48
    v_sub_f32 v226, 0, v48
    v_sub_f32 v227, 0, v48
    v_sub_f32 v228, 0, v50
    v_sub_f32 v229, 0, v50
    v_sub_f32 v230, 0, v50
    v_sub_f32 v231, 0, v50
    v_sub_f32 v232, 0, v52
    v_sub_f32 v233, 0, v52
    v_sub_f32 v234, 0, v52
    v_sub_f32 v235, 0, v52
    v_sub_f32 v236, 0, v54
    v_sub_f32 v237, 0, v54
    v_sub_f32 v238, 0, v54
    v_sub_f32 v239, 0, v54
    v_sub_f32 v240, 0, v56
    v_sub_f32 v241, 0, v56
    v_sub_f32 v242, 0, v56
    v_sub_f32 v243, 0, v56
    v_accvgpr_write_b32 a0, 0
    v_accvgpr_write_b32 a1, 0
    v_accvgpr_write_b32 a2, 0
    v_accvgpr_write_b32 a3, 0
    v_accvgpr_write_b32 a4, 0
    v_accvgpr_write_b32 a5, 0
    v_accvgpr_write_b32 a6, 0
    v_accvgpr_write_b32 a7, 0
    v_accvgpr_write_b32 a8, 0
    v_accvgpr_write_b32 a9, 0
    v_accvgpr_write_b32 a10, 0
    v_accvgpr_write_b32 a11, 0
    v_accvgpr_write_b32 a12, 0
    v_accvgpr_write_b32 a13, 0
    v_accvgpr_write_b32 a14, 0
    v_accvgpr_write_b32 a15, 0
    v_accvgpr_write_b32 a16, 0
    v_accvgpr_write_b32 a17, 0
    v_accvgpr_write_b32 a18, 0
    v_accvgpr_write_b32 a19, 0
    v_accvgpr_write_b32 a20, 0
    v_accvgpr_write_b32 a21, 0
    v_accvgpr_write_b32 a22, 0
    v_accvgpr_write_b32 a23, 0
    v_accvgpr_write_b32 a24, 0
    v_accvgpr_write_b32 a25, 0
    v_accvgpr_write_b32 a26, 0
    v_accvgpr_write_b32 a27, 0
    v_accvgpr_write_b32 a28, 0
    v_accvgpr_write_b32 a29, 0
    v_accvgpr_write_b32 a30, 0
    v_accvgpr_write_b32 a31, 0
    v_accvgpr_write_b32 a32, 0
    v_accvgpr_write_b32 a33, 0
    v_accvgpr_write_b32 a34, 0
    v_accvgpr_write_b32 a35, 0
    v_accvgpr_write_b32 a36, 0
    v_accvgpr_write_b32 a37, 0
    v_accvgpr_write_b32 a38, 0
    v_accvgpr_write_b32 a39, 0
    v_accvgpr_write_b32 a40, 0
    v_accvgpr_write_b32 a41, 0
    v_accvgpr_write_b32 a42, 0
    v_accvgpr_write_b32 a43, 0
    v_accvgpr_write_b32 a44, 0
    v_accvgpr_write_b32 a45, 0
    v_accvgpr_write_b32 a46, 0
    v_accvgpr_write_b32 a47, 0
    v_accvgpr_write_b32 a48, 0
    v_accvgpr_write_b32 a49, 0
    v_accvgpr_write_b32 a50, 0
    v_accvgpr_write_b32 a51, 0
    v_accvgpr_write_b32 a52, 0
    v_accvgpr_write_b32 a53, 0
    v_accvgpr_write_b32 a54, 0
    v_accvgpr_write_b32 a55, 0
    v_accvgpr_write_b32 a56, 0
    v_accvgpr_write_b32 a57, 0
    v_accvgpr_write_b32 a58, 0
    v_accvgpr_write_b32 a59, 0
    v_accvgpr_write_b32 a60, 0
    v_accvgpr_write_b32 a61, 0
    v_accvgpr_write_b32 a62, 0
    v_accvgpr_write_b32 a63, 0
    v_accvgpr_write_b32 a64, 0
    v_accvgpr_write_b32 a65, 0
    v_accvgpr_write_b32 a66, 0
    v_accvgpr_write_b32 a67, 0
    v_accvgpr_write_b32 a68, 0
    v_accvgpr_write_b32 a69, 0
    v_accvgpr_write_b32 a70, 0
    v_accvgpr_write_b32 a71, 0
    v_accvgpr_write_b32 a72, 0
    v_accvgpr_write_b32 a73, 0
    v_accvgpr_write_b32 a74, 0
    v_accvgpr_write_b32 a75, 0
    v_accvgpr_write_b32 a76, 0
    v_accvgpr_write_b32 a77, 0
    v_accvgpr_write_b32 a78, 0
    v_accvgpr_write_b32 a79, 0
    v_accvgpr_write_b32 a80, 0
    v_accvgpr_write_b32 a81, 0
    v_accvgpr_write_b32 a82, 0
    v_accvgpr_write_b32 a83, 0
    v_accvgpr_write_b32 a84, 0
    v_accvgpr_write_b32 a85, 0
    v_accvgpr_write_b32 a86, 0
    v_accvgpr_write_b32 a87, 0
    v_accvgpr_write_b32 a88, 0
    v_accvgpr_write_b32 a89, 0
    v_accvgpr_write_b32 a90, 0
    v_accvgpr_write_b32 a91, 0
    v_accvgpr_write_b32 a92, 0
    v_accvgpr_write_b32 a93, 0
    v_accvgpr_write_b32 a94, 0
    v_accvgpr_write_b32 a95, 0
    v_accvgpr_write_b32 a96, 0
    v_accvgpr_write_b32 a97, 0
    v_accvgpr_write_b32 a98, 0
    v_accvgpr_write_b32 a99, 0
    v_accvgpr_write_b32 a100, 0
    v_accvgpr_write_b32 a101, 0
    v_accvgpr_write_b32 a102, 0
    v_accvgpr_write_b32 a103, 0
    v_accvgpr_write_b32 a104, 0
    v_accvgpr_write_b32 a105, 0
    v_accvgpr_write_b32 a106, 0
    v_accvgpr_write_b32 a107, 0
    v_accvgpr_write_b32 a108, 0
    v_accvgpr_write_b32 a109, 0
    v_accvgpr_write_b32 a110, 0
    v_accvgpr_write_b32 a111, 0
    v_accvgpr_write_b32 a112, 0
    v_accvgpr_write_b32 a113, 0
    v_accvgpr_write_b32 a114, 0
    v_accvgpr_write_b32 a115, 0
    v_accvgpr_write_b32 a116, 0
    v_accvgpr_write_b32 a117, 0
    v_accvgpr_write_b32 a118, 0
    v_accvgpr_write_b32 a119, 0
    v_accvgpr_write_b32 a120, 0
    v_accvgpr_write_b32 a121, 0
    v_accvgpr_write_b32 a122, 0
    v_accvgpr_write_b32 a123, 0
    v_accvgpr_write_b32 a124, 0
    v_accvgpr_write_b32 a125, 0
    v_accvgpr_write_b32 a126, 0
    v_accvgpr_write_b32 a127, 0
    v_accvgpr_write_b32 a128, 0
    v_accvgpr_write_b32 a129, 0
    v_accvgpr_write_b32 a130, 0
    v_accvgpr_write_b32 a131, 0
    v_accvgpr_write_b32 a132, 0
    v_accvgpr_write_b32 a133, 0
    v_accvgpr_write_b32 a134, 0
    v_accvgpr_write_b32 a135, 0
    v_accvgpr_write_b32 a136, 0
    v_accvgpr_write_b32 a137, 0
    v_accvgpr_write_b32 a138, 0
    v_accvgpr_write_b32 a139, 0
    v_accvgpr_write_b32 a140, 0
    v_accvgpr_write_b32 a141, 0
    v_accvgpr_write_b32 a142, 0
    v_accvgpr_write_b32 a143, 0
    v_accvgpr_write_b32 a144, 0
    v_accvgpr_write_b32 a145, 0
    v_accvgpr_write_b32 a146, 0
    v_accvgpr_write_b32 a147, 0
    v_accvgpr_write_b32 a148, 0
    v_accvgpr_write_b32 a149, 0
    v_accvgpr_write_b32 a150, 0
    v_accvgpr_write_b32 a151, 0
    v_accvgpr_write_b32 a152, 0
    v_accvgpr_write_b32 a153, 0
    v_accvgpr_write_b32 a154, 0
    v_accvgpr_write_b32 a155, 0
    v_accvgpr_write_b32 a156, 0
    v_accvgpr_write_b32 a157, 0
    v_accvgpr_write_b32 a158, 0
    v_accvgpr_write_b32 a159, 0
    v_accvgpr_write_b32 a160, 0
    v_accvgpr_write_b32 a161, 0
    v_accvgpr_write_b32 a162, 0
    v_accvgpr_write_b32 a163, 0
    v_accvgpr_write_b32 a164, 0
    v_accvgpr_write_b32 a165, 0
    v_accvgpr_write_b32 a166, 0
    v_accvgpr_write_b32 a167, 0
    v_accvgpr_write_b32 a168, 0
    v_accvgpr_write_b32 a169, 0
    v_accvgpr_write_b32 a170, 0
    v_accvgpr_write_b32 a171, 0
    v_accvgpr_write_b32 a172, 0
    v_accvgpr_write_b32 a173, 0
    v_accvgpr_write_b32 a174, 0
    v_accvgpr_write_b32 a175, 0
    v_accvgpr_write_b32 a176, 0
    v_accvgpr_write_b32 a177, 0
    v_accvgpr_write_b32 a178, 0
    v_accvgpr_write_b32 a179, 0
    s_and_b32 s40, s24, 1
    s_lshl_b32 s26, s40, 12
    s_mov_b32 s27, s26
    s_add_u32 m0, s25, 0
    s_nop 0
    buffer_load_dwordx4 v20, s[4:7], s26 offen offset:0 nt lds
    buffer_load_dwordx4 v21, s[4:7], s26 offen offset:1024 nt lds
    buffer_load_dwordx4 v22, s[4:7], s26 offen offset:2048 nt lds
    buffer_load_dwordx4 v23, s[4:7], s26 offen offset:3072 nt lds
    s_add_u32 s26, s26, 8192
    s_add_u32 m0, s25, 16384
    s_nop 0
    buffer_load_dwordx4 v20, s[4:7], s26 offen offset:0 nt lds
    buffer_load_dwordx4 v21, s[4:7], s26 offen offset:1024 nt lds
    buffer_load_dwordx4 v22, s[4:7], s26 offen offset:2048 nt lds
    buffer_load_dwordx4 v23, s[4:7], s26 offen offset:3072 nt lds
    s_add_u32 s26, s26, 8192
    s_add_u32 m0, s25, 32768
    s_nop 0
    buffer_load_dwordx4 v20, s[4:7], s26 offen offset:0 nt lds
    buffer_load_dwordx4 v21, s[4:7], s26 offen offset:1024 nt lds
    buffer_load_dwordx4 v22, s[4:7], s26 offen offset:2048 nt lds
    buffer_load_dwordx4 v23, s[4:7], s26 offen offset:3072 nt lds
    s_add_u32 s26, s26, 8192
    s_add_u32 m0, s25, 49152
    s_nop 0
    buffer_load_dwordx4 v20, s[4:7], s26 offen offset:0 nt lds
    buffer_load_dwordx4 v21, s[4:7], s26 offen offset:1024 nt lds
    buffer_load_dwordx4 v22, s[4:7], s26 offen offset:2048 nt lds
    buffer_load_dwordx4 v23, s[4:7], s26 offen offset:3072 nt lds
    s_add_u32 s26, s26, 8192
    s_add_u32 m0, s25, 65536
    s_nop 0
    buffer_load_dwordx4 v24, s[8:11], s27 offen offset:0 nt lds
    buffer_load_dwordx4 v25, s[8:11], s27 offen offset:1024 nt lds
    buffer_load_dwordx4 v24, s[8:11], s27 offen offset:2048 nt lds
    buffer_load_dwordx4 v25, s[8:11], s27 offen offset:3072 nt lds
    s_add_u32 s27, s27, 8192
    s_add_u32 m0, s25, 81920
    s_nop 0
    buffer_load_dwordx4 v24, s[8:11], s27 offen offset:0 nt lds
    buffer_load_dwordx4 v25, s[8:11], s27 offen offset:1024 nt lds
    buffer_load_dwordx4 v24, s[8:11], s27 offen offset:2048 nt lds
    buffer_load_dwordx4 v25, s[8:11], s27 offen offset:3072 nt lds
    s_add_u32 s27, s27, 8192
    s_add_u32 m0, s25, 98304
    s_nop 0
    buffer_load_dwordx4 v24, s[8:11], s27 offen offset:0 nt lds
    buffer_load_dwordx4 v25, s[8:11], s27 offen offset:1024 nt lds
    buffer_load_dwordx4 v24, s[8:11], s27 offen offset:2048 nt lds
    buffer_load_dwordx4 v25, s[8:11], s27 offen offset:3072 nt lds
    s_add_u32 s27, s27, 8192
    s_mov_b32 s29, 1
    s_waitcnt vmcnt(0)
    s_barrier
    ds_read_b128 v[32:35], v8 offset:0
    ds_read_b128 v[36:39], v8 offset:4096
    ds_read_b128 v[40:43], v9 offset:0
    ds_read_b128 v[44:47], v9 offset:4096
    s_waitcnt lgkmcnt(3)
    v_mfma_f32_16x16x32_bf16 v[68:71], v[32:35], v[64:67], 0
    v_mfma_f32_16x16x32_bf16 v[76:79], v[32:35], v[72:75], 0
    v_mfma_f32_16x16x32_bf16 v[84:87], v[32:35], v[80:83], 0
    v_mfma_f32_16x16x32_bf16 v[92:95], v[32:35], v[88:91], 0
    v_mfma_f32_16x16x32_bf16 v[100:103], v[32:35], v[96:99], 0
    ds_read_b128 v[32:35], v10 offset:0
    s_waitcnt lgkmcnt(3)
    v_mfma_f32_16x16x32_bf16 v[108:111], v[36:39], v[64:67], 0
    v_mfma_f32_16x16x32_bf16 v[116:119], v[36:39], v[72:75], 0
    v_mfma_f32_16x16x32_bf16 v[124:127], v[36:39], v[80:83], 0
    v_mfma_f32_16x16x32_bf16 v[132:135], v[36:39], v[88:91], 0
    v_mfma_f32_16x16x32_bf16 v[140:143], v[36:39], v[96:99], 0
    ds_read_b128 v[36:39], v10 offset:4096
    s_waitcnt lgkmcnt(3)
    v_mfma_f32_16x16x32_bf16 v[68:71], v[40:43], v[104:107], v[68:71]
    v_mfma_f32_16x16x32_bf16 v[76:79], v[40:43], v[112:115], v[76:79]
    v_mfma_f32_16x16x32_bf16 v[84:87], v[40:43], v[120:123], v[84:87]
    v_mfma_f32_16x16x32_bf16 v[92:95], v[40:43], v[128:131], v[92:95]
    v_mfma_f32_16x16x32_bf16 v[100:103], v[40:43], v[136:139], v[100:103]
    ds_read_b128 v[40:43], v11 offset:0
    s_waitcnt lgkmcnt(3)
    v_mfma_f32_16x16x32_bf16 v[108:111], v[44:47], v[104:107], v[108:111]
    v_mfma_f32_16x16x32_bf16 v[116:119], v[44:47], v[112:115], v[116:119]
    v_mfma_f32_16x16x32_bf16 v[124:127], v[44:47], v[120:123], v[124:127]
    v_mfma_f32_16x16x32_bf16 v[132:135], v[44:47], v[128:131], v[132:135]
    v_mfma_f32_16x16x32_bf16 v[140:143], v[44:47], v[136:139], v[140:143]
    ds_read_b128 v[44:47], v11 offset:4096
    s_waitcnt lgkmcnt(3)
    v_mfma_f32_16x16x32_bf16 v[68:71], v[32:35], v[144:147], v[68:71]
    v_mfma_f32_16x16x32_bf16 v[76:79], v[32:35], v[152:155], v[76:79]
    v_mfma_f32_16x16x32_bf16 v[84:87], v[32:35], v[160:163], v[84:87]
    v_mfma_f32_16x16x32_bf16 v[92:95], v[32:35], v[168:171], v[92:95]
    v_mfma_f32_16x16x32_bf16 v[100:103], v[32:35], v[176:179], v[100:103]
    s_waitcnt lgkmcnt(2)
    v_mfma_f32_16x16x32_bf16 v[108:111], v[36:39], v[144:147], v[108:111]
    v_mfma_f32_16x16x32_bf16 v[116:119], v[36:39], v[152:155], v[116:119]
    v_mfma_f32_16x16x32_bf16 v[124:127], v[36:39], v[160:163], v[124:127]
    v_mfma_f32_16x16x32_bf16 v[132:135], v[36:39], v[168:171], v[132:135]
    v_mfma_f32_16x16x32_bf16 v[140:143], v[36:39], v[176:179], v[140:143]
    s_waitcnt lgkmcnt(1)
    v_mfma_f32_16x16x32_bf16 v[68:71], v[40:43], v[184:187], v[68:71]
    v_mfma_f32_16x16x32_bf16 v[76:79], v[40:43], v[192:195], v[76:79]
    v_mfma_f32_16x16x32_bf16 v[84:87], v[40:43], v[200:203], v[84:87]
    v_mfma_f32_16x16x32_bf16 v[92:95], v[40:43], v[208:211], v[92:95]
    v_mfma_f32_16x16x32_bf16 v[100:103], v[40:43], v[216:219], v[100:103]
    s_waitcnt lgkmcnt(0)
    v_mfma_f32_16x16x32_bf16 v[108:111], v[44:47], v[184:187], v[108:111]
    v_mfma_f32_16x16x32_bf16 v[116:119], v[44:47], v[192:195], v[116:119]
    v_mfma_f32_16x16x32_bf16 v[124:127], v[44:47], v[200:203], v[124:127]
    v_mfma_f32_16x16x32_bf16 v[132:135], v[44:47], v[208:211], v[132:135]
    v_mfma_f32_16x16x32_bf16 v[140:143], v[44:47], v[216:219], v[140:143]
    s_nop 7
    s_branch L_start
L_k1_end:
    s_endpgm
.section .rodata,"a"
.p2align 6
.amdhsa_kernel concat_heads__gqa_block_cached__gqa_block_cached__near_ridge_kernel
  .amdhsa_next_free_vgpr 512
  .amdhsa_next_free_sgpr 102
  .amdhsa_accum_offset 256
  .amdhsa_group_segment_fixed_size 0
  .amdhsa_kernarg_size 104
  .amdhsa_user_sgpr_count 2
  .amdhsa_user_sgpr_kernarg_segment_ptr 1
  .amdhsa_system_sgpr_workgroup_id_x 1
.end_amdhsa_kernel
```
